```python
import torch

def _softmax(x, axis=-1):
    return torch.softmax(x, dim=axis)
def _gelu(x):
    return torch.nn.functional.gelu(x, approximate="tanh")
def _silu(x):
    return torch.nn.functional.silu(x)
def _sigmoid(x):
    return torch.sigmoid(x)
def _layernorm(x, axis=-1, eps=1e-5):
    m = x.mean(dim=axis, keepdim=True)
    v = x.var(dim=axis, keepdim=True, unbiased=False)
    return (x - m) / torch.sqrt(v + eps)
def _scatter_add(tgt, idx, src, axis=0):
    return tgt.clone().index_add_(axis, idx, src)
def _segment_sum(src, seg, n):
    out = torch.zeros((n,) + src.shape[1:], dtype=src.dtype)
    return out.index_add_(0, seg, src)
def _pad(x, pw):
    flat = tuple(v for pair in reversed(pw) for v in pair)
    return torch.nn.functional.pad(x, flat)

kernel_name = 'gated_mix__linear_attn_block__dense_activation_mish__prompt'

def setup_inputs():

    _w = (lambda a: (lambda t: t.to(torch.bfloat16) if t.is_floating_point() else t)(torch.as_tensor(a)))
    def _A_setup():
        B, S, D = 1, 2048, 640
        return {
            "x": _w((lambda *s: torch.randn(*s, dtype=torch.bfloat16) * 0.05)(B, S, D)),
            "wqkv": _w((lambda *s: torch.randn(*s, dtype=torch.bfloat16) * 0.8)(D, 3 * D)),
            "wo": _w((lambda *s: torch.randn(*s, dtype=torch.bfloat16) * 0.1)(D, D)),
        }
    _A_in = _A_setup()

    def _B_setup():
        B, S, D, F = 1, 2048, 640, 1536
        return {
            "x": _w((lambda *s: torch.randn(*s, dtype=torch.bfloat16) * 0.05)(B, S, D)),
            "w1": _w((lambda *s: torch.randn(*s, dtype=torch.bfloat16) * 12.8)(D, F) * (D ** -0.5)),
            "b1": _w((lambda *s: torch.randn(*s, dtype=torch.bfloat16) * 0.2)(F)),
            "w2": _w((lambda *s: torch.randn(*s, dtype=torch.bfloat16) * 0.1)(F, D) * (F ** -0.5)),
        }
    _B_in = _B_setup()

    return {
        "A_x": _A_in["x"],
        "A_wqkv": _A_in["wqkv"],
        "A_wo": _A_in["wo"],
        "B_x": _B_in["x"],
        "B_w1": _B_in["w1"],
        "B_b1": _B_in["b1"],
        "B_w2": _B_in["w2"],
        "gate_w": _w((lambda *s: torch.randn(*s, dtype=torch.bfloat16) * 0.05)(640) * 16.0),
    }

def reference(A_x, A_wqkv, A_wo, B_x, B_w1, B_b1, B_w2, gate_w):
    def _A_ref(x, wqkv, wo):
        B, S, D = x.shape
        H = 32; Dh = D // H
        qkv = (lambda x, *d: x.permute(*d))((x @ wqkv).reshape(B, S, 3, H, Dh), 2, 0, 3, 1, 4)
        q, k, v = qkv[0], qkv[1], qkv[2]
        phi = lambda t: torch.where(t > 0, t + 1, torch.exp(t)) + 1e-6
        pq, pk = phi(q), phi(k)
        kv = torch.einsum("bhsd,bhse->bhde", pk, v)
        z = torch.einsum("bhsd->bhd", pk)
        num = torch.einsum("bhqd,bhde->bhqe", pq, kv)
        den = torch.einsum("bhqd,bhd->bhq", pq, z)[..., None] + 1e-6
        o = num / den
        return (lambda x, *d: x.permute(*d))(o, 0, 2, 1, 3).reshape(B, S, D) @ wo

    def _B_ref(x, w1, b1, w2):
        h = torch.einsum("bsd,df->bsf", x, w1) + b1
        sp = torch.log1p(torch.exp(-torch.abs(h))) + torch.where(h > 0, h, torch.zeros_like(h))
        act = h * torch.tanh(sp)
        return torch.einsum("bsf,fd->bsd", act, w2)

    x = A_x
    g = _sigmoid((x * gate_w).sum(-1, keepdims=True))
    a = _A_ref(x, A_wqkv, A_wo)
    b = _B_ref(x, B_w1, B_b1, B_w2)
    return g * a + (1 - g) * b
```

```asm
; @launch grid=(256,1,1) block=(256,1,1) lds=163840
.amdgcn_target "amdgcn-amd-amdhsa--gfx950"
.text
.globl gated_mix__linear_attn_block__dense_activation_mish__prompt_kernel
.p2align 8
.type gated_mix__linear_attn_block__dense_activation_mish__prompt_kernel,@function
gated_mix__linear_attn_block__dense_activation_mish__prompt_kernel:
L_begin:
    s_load_dwordx16 s[40:55], s[0:1], 0
    s_load_dwordx4 s[56:59], s[0:1], 64
    s_load_dwordx2 s[60:61], s[0:1], 80
    s_cmp_ge_u32 s2, 256
    s_cbranch_scc1 L_end
    s_getpc_b64 s[62:63]
L_pc0:
    s_lshr_b32 s7, s2, 3
    v_lshrrev_b32 v232, 4, v0
    v_and_b32 v233, 3, v0
    v_or_b32 v232, v232, v233
    v_lshl_add_u32 v232, s7, 4, v232
    s_sub_u32 s62, s62, L_pc0-L_begin
    s_subb_u32 s63, s63, 0
    v_lshlrev_b32 v232, 7, v232
    v_min_u32 v232, L_end-L_begin, v232
    v_mov_b32 v233, s63
    v_add_co_u32 v232, vcc, s62, v232
    s_mov_b64 exec, 15
    s_nop 0
    v_addc_co_u32 v233, vcc, 0, v233, vcc
    global_load_dword v234, v[232:233], off
    s_mov_b64 exec, -1
    v_lshrrev_b32 v1, 6, v0
    v_and_b32 v20, 63, v0
    v_readfirstlane_b32 s3, v1
    s_and_b32 s7, s2, 7
    s_lshr_b32 s38, s2, 3
    s_and_b32 s4, s7, 1
    s_lshl_b32 s4, s4, 3
    s_and_b32 s33, s38, 7
    s_add_u32 s4, s4, s33
    s_bfe_u32 s39, s38, 0x10003
    s_and_b32 s5, s7, 6
    s_add_u32 s5, s5, s39
    s_and_b32 s32, s7, 6
    s_lshl_b32 s32, s32, 1
    s_bfe_u32 s62, s38, 0x20002
    s_add_u32 s32, s32, s62
    s_and_b32 s33, s7, 1
    s_lshl_b32 s33, s33, 2
    s_and_b32 s62, s38, 3
    s_add_u32 s33, s33, s62
    s_lshr_b32 s38, s38, 4
    s_add_u32 s6, s4, s5
    s_mul_hi_u32 s39, s6, 0x2aaaaaab
    s_mul_i32 s39, s39, 6
    s_sub_u32 s6, s6, s39
    s_mul_i32 s6, s6, 427
    s_lshr_b32 s6, s6, 8
    v_lshrrev_b32 v4, 3, v20
    v_and_b32 v5, 7, v20
    v_lshrrev_b32 v6, 1, v4
    v_mul_u32_u24 v7, 1280, v4
    v_xor_b32 v8, v5, v6
    v_lshl_add_u32 v1, v8, 4, v7
    v_xor_b32 v8, 4, v8
    v_lshl_add_u32 v2, v8, 4, v7
    v_add_u32 v2, 9216, v2
    v_add_u32 v30, 18432, v1
    v_add_u32 v31, 18432, v2
    s_lshl_b32 s36, s4, 7
    s_lshl_b32 s39, s3, 5
    s_add_u32 s36, s36, s39
    s_mul_i32 s36, s36, 1280
    s_add_u32 s34, s36, 1280
    s_lshl_b32 s39, s6, 7
    s_add_u32 s36, s36, s39
    s_lshl_b32 s96, s3, 12
    s_cmp_eq_u32 s38, 1
    s_cbranch_scc1 L_h
    s_mov_b32 m0, s96
    s_mov_b32 s38, 0x1999999a
    s_lshr_b32 s63, s3, 1
    s_and_b32 s39, s3, 1
    s_mul_i32 s35, s5, 160
    s_mul_i32 s62, s39, 122880
    s_add_u32 s100, s35, s62
    s_add_u32 s101, s6, s63
    s_mul_i32 s62, s63, 1280
    s_add_u32 s35, s100, s62
    s_add_u32 s35, s35, 1280
    s_mul_i32 s37, s6, 245760
    s_add_u32 s37, s37, s35
    s_mul_i32 s97, s3, 5120
    s_add_u32 s97, s97, 49152
    v_add_u32 v26, 0, v20
    v_mul_hi_u32 v27, v26, s38
    v_mul_u32_u24 v28, 10, v27
    v_sub_u32 v28, v26, v28
    v_bfe_u32 v29, v27, 2, 2
    v_lshrrev_b32 v26, 4, v27
    v_and_b32 v27, 3, v27
    v_lshl_add_u32 v27, v29, 3, v27
    v_lshl_add_u32 v27, v26, 2, v27
    v_mul_u32_u24 v27, 3840, v27
    v_lshl_add_u32 v3, v28, 4, v27
    s_waitcnt lgkmcnt(0)
    s_mov_b64 s[8:9], s[40:41]
    s_mov_b32 s10, 2621440
    s_mov_b32 s11, 0x20000
    buffer_load_dwordx4 v1, s[8:11], s36 offen offset:0 lds
    buffer_load_dwordx4 v2, s[8:11], s36 offen offset:1024 lds
    buffer_load_dwordx4 v30, s[8:11], s36 offen offset:2048 lds
    buffer_load_dwordx4 v31, s[8:11], s36 offen offset:3072 lds
    s_mov_b64 s[12:13], s[42:43]
    s_mov_b32 s14, 2457600
    s_mov_b32 s15, 0x20000
    s_mov_b32 m0, s97
    s_lshr_b32 s46, s3, 1
    buffer_load_dwordx4 v3, s[12:15], s37 offen offset:0 lds
    v_add_u32 v26, 64, v20
    v_mul_hi_u32 v27, v26, s38
    v_mul_u32_u24 v28, 10, v27
    v_sub_u32 v28, v26, v28
    v_bfe_u32 v29, v27, 2, 2
    v_lshrrev_b32 v26, 4, v27
    v_and_b32 v27, 3, v27
    v_lshl_add_u32 v27, v29, 3, v27
    v_lshl_add_u32 v27, v26, 2, v27
    v_mul_u32_u24 v27, 3840, v27
    v_lshl_add_u32 v4, v28, 4, v27
    v_subrev_u32 v4, 1024, v4
    buffer_load_dwordx4 v4, s[12:15], s37 offen offset:1024 lds
    v_add_u32 v26, 128, v20
    v_mul_hi_u32 v27, v26, s38
    v_mul_u32_u24 v28, 10, v27
    v_sub_u32 v28, v26, v28
    v_bfe_u32 v29, v27, 2, 2
    v_lshrrev_b32 v26, 4, v27
    v_and_b32 v27, 3, v27
    v_lshl_add_u32 v27, v29, 3, v27
    v_lshl_add_u32 v27, v26, 2, v27
    v_mul_u32_u24 v27, 3840, v27
    v_lshl_add_u32 v5, v28, 4, v27
    v_subrev_u32 v5, 2048, v5
    buffer_load_dwordx4 v5, s[12:15], s37 offen offset:2048 lds
    v_add_u32 v26, 192, v20
    v_mul_hi_u32 v27, v26, s38
    v_mul_u32_u24 v28, 10, v27
    v_sub_u32 v28, v26, v28
    v_bfe_u32 v29, v27, 2, 2
    v_lshrrev_b32 v26, 4, v27
    v_and_b32 v27, 3, v27
    v_lshl_add_u32 v27, v29, 3, v27
    v_lshl_add_u32 v27, v26, 2, v27
    v_mul_u32_u24 v27, 3840, v27
    v_lshl_add_u32 v6, v28, 4, v27
    v_subrev_u32 v6, 3072, v6
    buffer_load_dwordx4 v6, s[12:15], s37 offen offset:3072 lds
    v_add_u32 v26, 256, v20
    v_mul_hi_u32 v27, v26, s38
    v_mul_u32_u24 v28, 10, v27
    v_sub_u32 v28, v26, v28
    v_bfe_u32 v29, v27, 2, 2
    v_lshrrev_b32 v26, 4, v27
    v_and_b32 v27, 3, v27
    v_lshl_add_u32 v27, v29, 3, v27
    v_lshl_add_u32 v27, v26, 2, v27
    v_mul_u32_u24 v27, 3840, v27
    v_lshl_add_u32 v7, v28, 4, v27
    s_add_u32 m0, s97, 4096
    s_nop 0
    buffer_load_dwordx4 v7, s[12:15], s37 offen offset:0 lds
    s_mul_i32 s62, s3, 20
    v_add_u32 v26, s62, v20
    v_lshrrev_b32 v29, 3, v26
    v_add_u32 v27, s6, v29
    v_subrev_u32 v28, 10, v27
    v_cmp_gt_u32 vcc, 10, v27
    s_nop 1
    v_cndmask_b32 v27, v28, v27, vcc
    v_and_b32 v26, 7, v26
    v_lshlrev_b32 v26, 4, v26
    v_lshl_add_u32 v29, v27, 7, v26
    s_mov_b64 s[20:21], s[54:55]
    s_mov_b32 s22, 1280
    s_mov_b32 s23, 0x20000
    s_mul_i32 s7, s3, 320
    s_add_u32 m0, s7, 161792
    s_mov_b64 exec, 0xfffff
    buffer_load_dwordx4 v29, s[20:23], 0 offen lds
    s_mov_b64 exec, -1
    s_mov_b64 s[16:17], s[60:61]
    s_mov_b32 s18, 268435456
    s_mov_b32 s19, 0x20000
    s_mov_b64 s[28:29], s[58:59]
    s_mov_b32 s30, 256
    s_mov_b32 s31, 0x20000
    v_lshlrev_b32 v21, 4, v20
    v_mov_b32 v22, 1
    v_mov_b32 v23, 0
    s_mul_i32 s63, s33, 68
    s_mul_i32 s44, s3, 12
    s_add_u32 s44, s44, s63
    s_mul_i32 s44, s44, 5120
    s_add_u32 s44, s44, 1048576
    s_mul_i32 s45, s3, 5
    s_add_u32 s45, s45, s63
    s_mul_i32 s45, s45, 5120
    s_add_u32 s45, s45, 1294336
    s_mul_i32 s48, s3, 40960
    s_mul_i32 s7, s33, 5
    s_lshr_b32 s7, s7, 2
    s_mul_i32 s38, s3, 10
    s_add_u32 s7, s7, s38
    s_mul_i32 s7, s7, 384
    s_add_u32 s7, s7, 49152
    v_min_u32 v231, 5, v20
    v_lshl_add_u32 v231, v231, 7, s7
    v_and_b32 v26, 15, v20
    v_lshrrev_b32 v27, 4, v20
    v_lshrrev_b32 v28, 1, v26
    v_xor_b32 v28, v28, v27
    v_lshl_add_u32 v29, v26, 7, s96
    v_lshl_add_u32 v8, v28, 4, v29
    v_xor_b32 v28, 4, v28
    v_lshl_add_u32 v9, v28, 4, v29
    v_lshrrev_b32 v28, 2, v20
    v_mul_u32_u24 v28, 160, v28
    v_and_b32 v29, 3, v20
    v_lshl_add_u32 v10, v29, 3, v28
    v_add_u32 v11, 0x10000, v10
    v_add_u32 v12, 0x20000, v10
    v_lshlrev_b32 v13, 4, v27
    v_add_u32 v13, 161792, v13
    s_and_b32 s7, s3, 1
    s_mul_i32 s7, s7, 7168
    s_mul_i32 s38, s46, 49152
    s_add_u32 s7, s7, s38
    v_mul_u32_u24 v28, 80, v26
    v_add_u32 v28, s7, v28
    v_lshl_add_u32 v29, v27, 2, 0
    v_subrev_u32 v25, 20, v29
    v_min_u32 v29, v29, v25
    v_lshl_add_u32 v14, v29, 2, v28
    v_lshl_add_u32 v29, v27, 2, 16
    v_subrev_u32 v25, 20, v29
    v_min_u32 v29, v29, v25
    v_lshl_add_u32 v15, v29, 2, v28
    v_lshl_add_u32 v29, v27, 2, 12
    v_subrev_u32 v25, 20, v29
    v_min_u32 v29, v29, v25
    v_lshl_add_u32 v16, v29, 2, v28
    v_lshl_add_u32 v29, v27, 2, 8
    v_subrev_u32 v25, 20, v29
    v_min_u32 v29, v29, v25
    v_lshl_add_u32 v17, v29, 2, v28
    v_lshl_add_u32 v29, v27, 2, 4
    v_subrev_u32 v25, 20, v29
    v_min_u32 v29, v29, v25
    v_lshl_add_u32 v18, v29, 2, v28
    s_add_u32 s7, s7, 6400
    v_lshl_add_u32 v19, v27, 4, s7
    v_mov_b32 v160, 897988541
    v_mov_b32 v161, 897988541
    v_mov_b32 v162, 897988541
    v_mov_b32 v163, 897988541
    v_and_b32 v24, 7, v20
    v_lshlrev_b32 v24, 5, v24
    s_mov_b32 s64, 0xffffffff
    s_mov_b32 s65, 0xffffffff
    s_mov_b32 s66, 0xf000f
    s_mov_b32 s67, 0xf000f
    s_mov_b32 s68, 0x10001
    s_mov_b32 s69, 0x10001
    s_mov_b32 s70, 0xffff
    s_mov_b32 s71, 0x0
    s_mov_b32 s72, 0xfff0000f
    s_mov_b32 s73, 0xfff0fff0
    s_mov_b32 s74, 0xff0000
    s_mov_b32 s75, 0xff00ff
    s_mov_b32 s76, 0xfff0fff0
    s_mov_b32 s77, 0x0
    s_mov_b32 s78, 0xff00ff
    s_mov_b32 s79, 0xff00ff00
    s_mov_b32 s80, 0x0
    s_mov_b32 s81, 0xfff0fff
    s_mov_b32 s82, 0xff00ff00
    s_mov_b32 s83, 0xff00
    s_mov_b32 s84, 0xfff0fff
    s_mov_b32 s85, 0xf0000fff
    s_mov_b32 s86, 0x0
    s_mov_b32 s87, 0xffff0000
    s_mov_b32 s88, 0xf000f000
    s_mov_b32 s89, 0xf000f000
    s_add_u32 s36, s36, 128
    s_add_u32 s37, s37, 245760
    s_cmp_eq_u32 s36, s34
    s_cselect_b32 s37, s35, s37
    s_cselect_b32 s7, 1280, 0
    s_sub_u32 s36, s36, s7
    s_add_u32 m0, s96, 16384
    s_nop 0
    buffer_load_dwordx4 v1, s[8:11], s36 offen offset:0 lds
    buffer_load_dwordx4 v2, s[8:11], s36 offen offset:1024 lds
    buffer_load_dwordx4 v30, s[8:11], s36 offen offset:2048 lds
    buffer_load_dwordx4 v31, s[8:11], s36 offen offset:3072 lds
    s_add_u32 m0, s97, 20480
    s_nop 0
    buffer_load_dwordx4 v3, s[12:15], s37 offen offset:0 lds
    buffer_load_dwordx4 v4, s[12:15], s37 offen offset:1024 lds
    buffer_load_dwordx4 v5, s[12:15], s37 offen offset:2048 lds
    buffer_load_dwordx4 v6, s[12:15], s37 offen offset:3072 lds
    s_add_u32 m0, s97, 24576
    s_nop 0
    buffer_load_dwordx4 v7, s[12:15], s37 offen offset:0 lds
    s_and_b32 s54, s3, 1
    s_mul_i32 s54, s54, 5120
    s_waitcnt vmcnt(9)
    s_barrier
    ds_read_b128 a[0:3], v8 offset:0
    ds_read_b128 a[4:7], v8 offset:2048
    ds_read_b64_tr_b16 v[120:121], v10 offset:49152
    ds_read_b64_tr_b16 v[122:123], v10 offset:51712
    ds_read_b64_tr_b16 v[124:125], v10 offset:59392
    ds_read_b64_tr_b16 v[126:127], v10 offset:61952
    ds_read_b64_tr_b16 v[128:129], v10 offset:49184
    ds_read_b64_tr_b16 v[130:131], v10 offset:51744
    ds_read_b64_tr_b16 v[132:133], v10 offset:59424
    ds_read_b64_tr_b16 v[134:135], v10 offset:61984
    ds_read_b64_tr_b16 v[136:137], v10 offset:49216
    ds_read_b64_tr_b16 v[138:139], v10 offset:51776
    ds_read_b64_tr_b16 v[140:141], v10 offset:59456
    ds_read_b64_tr_b16 v[142:143], v10 offset:62016
    s_waitcnt lgkmcnt(8)
    v_mfma_f32_16x16x32_bf16 v[32:35], a[0:3], v[120:123], v[160:163]
    ds_read_b64_tr_b16 v[144:145], v10 offset:49248
    s_add_u32 s36, s36, 128
    v_mfma_f32_16x16x32_bf16 v[36:39], a[4:7], v[120:123], v[160:163]
    ds_read_b64_tr_b16 v[146:147], v10 offset:51808
    s_add_u32 s37, s37, 245760
    v_mfma_f32_16x16x32_bf16 v[72:75], a[0:3], v[124:127], 0
    ds_read_b64_tr_b16 v[148:149], v10 offset:59488
    s_cmp_eq_u32 s36, s34
    v_mfma_f32_16x16x32_bf16 v[76:79], a[4:7], v[124:127], 0
    ds_read_b64_tr_b16 v[150:151], v10 offset:62048
    s_waitcnt lgkmcnt(8)
    v_mfma_f32_16x16x32_bf16 v[40:43], a[0:3], v[128:131], v[160:163]
    ds_read_b64_tr_b16 v[120:121], v10 offset:49280
    s_cselect_b32 s37, s35, s37
    v_mfma_f32_16x16x32_bf16 v[44:47], a[4:7], v[128:131], v[160:163]
    ds_read_b64_tr_b16 v[122:123], v10 offset:51840
    s_cselect_b32 s7, 1280, 0
    v_mfma_f32_16x16x32_bf16 v[80:83], a[0:3], v[132:135], 0
    ds_read_b64_tr_b16 v[124:125], v10 offset:59520
    s_sub_u32 s36, s36, s7
    v_mfma_f32_16x16x32_bf16 v[84:87], a[4:7], v[132:135], 0
    ds_read_b64_tr_b16 v[126:127], v10 offset:62080
    s_waitcnt lgkmcnt(8)
    v_mfma_f32_16x16x32_bf16 v[48:51], a[0:3], v[136:139], v[160:163]
    ds_read_b128 a[8:11], v9 offset:0
    ds_read_b128 a[12:15], v9 offset:2048
    v_mfma_f32_16x16x32_bf16 v[52:55], a[4:7], v[136:139], v[160:163]
    ds_read_b64_tr_b16 v[128:129], v10 offset:54272
    ds_read_b64_tr_b16 v[130:131], v10 offset:56832
    v_mfma_f32_16x16x32_bf16 v[88:91], a[0:3], v[140:143], 0
    ds_read_b64_tr_b16 v[132:133], v10 offset:64512
    s_add_u32 m0, s96, 32768
    v_mfma_f32_16x16x32_bf16 v[92:95], a[4:7], v[140:143], 0
    ds_read_b64_tr_b16 v[134:135], v11 offset:1536
    s_waitcnt lgkmcnt(10)
    v_mfma_f32_16x16x32_bf16 v[56:59], a[0:3], v[144:147], v[160:163]
    ds_read_b64_tr_b16 v[136:137], v10 offset:54304
    buffer_load_dwordx4 v1, s[8:11], s36 offen offset:0 lds
    v_mfma_f32_16x16x32_bf16 v[60:63], a[4:7], v[144:147], v[160:163]
    ds_read_b64_tr_b16 v[138:139], v10 offset:56864
    buffer_load_dwordx4 v2, s[8:11], s36 offen offset:1024 lds
    v_mfma_f32_16x16x32_bf16 v[96:99], a[0:3], v[148:151], 0
    ds_read_b64_tr_b16 v[140:141], v10 offset:64544
    buffer_load_dwordx4 v30, s[8:11], s36 offen offset:2048 lds
    v_mfma_f32_16x16x32_bf16 v[100:103], a[4:7], v[148:151], 0
    ds_read_b64_tr_b16 v[142:143], v11 offset:1568
    s_waitcnt lgkmcnt(10)
    v_mfma_f32_16x16x32_bf16 v[64:67], a[0:3], v[120:123], v[160:163]
    ds_read_b64_tr_b16 v[144:145], v10 offset:54336
    buffer_load_dwordx4 v31, s[8:11], s36 offen offset:3072 lds
    v_mfma_f32_16x16x32_bf16 v[68:71], a[4:7], v[120:123], v[160:163]
    ds_read_b64_tr_b16 v[146:147], v10 offset:56896
    s_add_u32 m0, s97, 40960
    v_mfma_f32_16x16x32_bf16 v[104:107], a[0:3], v[124:127], 0
    ds_read_b64_tr_b16 v[148:149], v10 offset:64576
    buffer_load_dwordx4 v3, s[12:15], s37 offen offset:0 lds
    v_mfma_f32_16x16x32_bf16 v[108:111], a[4:7], v[124:127], 0
    ds_read_b64_tr_b16 v[150:151], v11 offset:1600
    s_waitcnt lgkmcnt(8)
    v_mfma_f32_16x16x32_bf16 v[32:35], a[8:11], v[128:131], v[32:35]
    ds_read_b64_tr_b16 v[120:121], v10 offset:54368
    buffer_load_dwordx4 v4, s[12:15], s37 offen offset:1024 lds
    v_mfma_f32_16x16x32_bf16 v[36:39], a[12:15], v[128:131], v[36:39]
    ds_read_b64_tr_b16 v[122:123], v10 offset:56928
    buffer_load_dwordx4 v5, s[12:15], s37 offen offset:2048 lds
    v_mfma_f32_16x16x32_bf16 v[72:75], a[8:11], v[132:135], v[72:75]
    ds_read_b64_tr_b16 v[124:125], v10 offset:64608
    buffer_load_dwordx4 v6, s[12:15], s37 offen offset:3072 lds
    v_mfma_f32_16x16x32_bf16 v[76:79], a[12:15], v[132:135], v[76:79]
    ds_read_b64_tr_b16 v[126:127], v11 offset:1632
    s_waitcnt lgkmcnt(8)
    v_mfma_f32_16x16x32_bf16 v[40:43], a[8:11], v[136:139], v[40:43]
    ds_read_b64_tr_b16 v[128:129], v10 offset:54400
    s_add_u32 m0, s97, 45056
    v_mfma_f32_16x16x32_bf16 v[44:47], a[12:15], v[136:139], v[44:47]
    ds_read_b64_tr_b16 v[130:131], v10 offset:56960
    buffer_load_dwordx4 v7, s[12:15], s37 offen offset:0 lds
    v_mfma_f32_16x16x32_bf16 v[80:83], a[8:11], v[140:143], v[80:83]
    ds_read_b64_tr_b16 v[132:133], v10 offset:64640
    v_mfma_f32_16x16x32_bf16 v[84:87], a[12:15], v[140:143], v[84:87]
    ds_read_b64_tr_b16 v[134:135], v11 offset:1664
    s_waitcnt vmcnt(9) lgkmcnt(0)
    s_barrier
    v_mfma_f32_16x16x32_bf16 v[48:51], a[8:11], v[144:147], v[48:51]
    ds_read_b128 a[16:19], v8 offset:16384
    ds_read_b128 a[20:23], v8 offset:18432
    v_mfma_f32_16x16x32_bf16 v[52:55], a[12:15], v[144:147], v[52:55]
    ds_read_b64_tr_b16 v[136:137], v11 offset:4096
    ds_read_b64_tr_b16 v[138:139], v11 offset:6656
    v_mfma_f32_16x16x32_bf16 v[88:91], a[8:11], v[148:151], v[88:91]
    ds_read_b64_tr_b16 v[140:141], v11 offset:14336
    s_add_u32 s36, s36, 128
    v_mfma_f32_16x16x32_bf16 v[92:95], a[12:15], v[148:151], v[92:95]
    ds_read_b64_tr_b16 v[142:143], v11 offset:16896
    s_add_u32 s37, s37, 245760
    v_mfma_f32_16x16x32_bf16 v[56:59], a[8:11], v[120:123], v[56:59]
    ds_read_b64_tr_b16 v[144:145], v11 offset:4128
    s_cmp_eq_u32 s36, s34
    v_mfma_f32_16x16x32_bf16 v[60:63], a[12:15], v[120:123], v[60:63]
    ds_read_b64_tr_b16 v[146:147], v11 offset:6688
    s_cselect_b32 s37, s35, s37
    v_mfma_f32_16x16x32_bf16 v[96:99], a[8:11], v[124:127], v[96:99]
    ds_read_b64_tr_b16 v[148:149], v11 offset:14368
    s_cselect_b32 s7, 1280, 0
    v_mfma_f32_16x16x32_bf16 v[100:103], a[12:15], v[124:127], v[100:103]
    ds_read_b64_tr_b16 v[150:151], v11 offset:16928
    s_sub_u32 s36, s36, s7
    v_mfma_f32_16x16x32_bf16 v[64:67], a[8:11], v[128:131], v[64:67]
    ds_read_b64_tr_b16 v[120:121], v11 offset:4160
    s_add_u32 m0, s96, 0
    v_mfma_f32_16x16x32_bf16 v[68:71], a[12:15], v[128:131], v[68:71]
    ds_read_b64_tr_b16 v[122:123], v11 offset:6720
    buffer_load_dwordx4 v1, s[8:11], s36 offen offset:0 lds
    v_mfma_f32_16x16x32_bf16 v[104:107], a[8:11], v[132:135], v[104:107]
    ds_read_b64_tr_b16 v[124:125], v11 offset:14400
    buffer_load_dwordx4 v2, s[8:11], s36 offen offset:1024 lds
    v_mfma_f32_16x16x32_bf16 v[108:111], a[12:15], v[132:135], v[108:111]
    ds_read_b64_tr_b16 v[126:127], v11 offset:16960
    s_waitcnt lgkmcnt(8)
    v_mfma_f32_16x16x32_bf16 v[32:35], a[16:19], v[136:139], v[32:35]
    ds_read_b64_tr_b16 v[128:129], v11 offset:4192
    buffer_load_dwordx4 v30, s[8:11], s36 offen offset:2048 lds
    v_mfma_f32_16x16x32_bf16 v[36:39], a[20:23], v[136:139], v[36:39]
    ds_read_b64_tr_b16 v[130:131], v11 offset:6752
    buffer_load_dwordx4 v31, s[8:11], s36 offen offset:3072 lds
    v_mfma_f32_16x16x32_bf16 v[72:75], a[16:19], v[140:143], v[72:75]
    ds_read_b64_tr_b16 v[132:133], v11 offset:14432
    v_mfma_f32_16x16x32_bf16 v[76:79], a[20:23], v[140:143], v[76:79]
    ds_read_b64_tr_b16 v[134:135], v11 offset:16992
    s_waitcnt lgkmcnt(8)
    v_mfma_f32_16x16x32_bf16 v[40:43], a[16:19], v[144:147], v[40:43]
    ds_read_b64_tr_b16 v[136:137], v11 offset:4224
    s_add_u32 m0, s97, 0
    v_mfma_f32_16x16x32_bf16 v[44:47], a[20:23], v[144:147], v[44:47]
    ds_read_b64_tr_b16 v[138:139], v11 offset:6784
    v_mfma_f32_16x16x32_bf16 v[80:83], a[16:19], v[148:151], v[80:83]
    ds_read_b64_tr_b16 v[140:141], v11 offset:14464
    buffer_load_dwordx4 v3, s[12:15], s37 offen offset:0 lds
    v_mfma_f32_16x16x32_bf16 v[84:87], a[20:23], v[148:151], v[84:87]
    ds_read_b64_tr_b16 v[142:143], v11 offset:17024
    s_waitcnt lgkmcnt(8)
    v_mfma_f32_16x16x32_bf16 v[48:51], a[16:19], v[120:123], v[48:51]
    ds_read_b128 a[24:27], v9 offset:16384
    ds_read_b128 a[28:31], v9 offset:18432
    v_mfma_f32_16x16x32_bf16 v[52:55], a[20:23], v[120:123], v[52:55]
    ds_read_b64_tr_b16 v[144:145], v11 offset:9216
    ds_read_b64_tr_b16 v[146:147], v11 offset:11776
    v_mfma_f32_16x16x32_bf16 v[88:91], a[16:19], v[124:127], v[88:91]
    ds_read_b64_tr_b16 v[148:149], v11 offset:19456
    buffer_load_dwordx4 v4, s[12:15], s37 offen offset:1024 lds
    v_mfma_f32_16x16x32_bf16 v[92:95], a[20:23], v[124:127], v[92:95]
    ds_read_b64_tr_b16 v[150:151], v11 offset:22016
    s_waitcnt lgkmcnt(10)
    v_mfma_f32_16x16x32_bf16 v[56:59], a[16:19], v[128:131], v[56:59]
    ds_read_b64_tr_b16 v[120:121], v11 offset:9248
    buffer_load_dwordx4 v5, s[12:15], s37 offen offset:2048 lds
    v_mfma_f32_16x16x32_bf16 v[60:63], a[20:23], v[128:131], v[60:63]
    ds_read_b64_tr_b16 v[122:123], v11 offset:11808
    v_mfma_f32_16x16x32_bf16 v[96:99], a[16:19], v[132:135], v[96:99]
    ds_read_b64_tr_b16 v[124:125], v11 offset:19488
    v_mfma_f32_16x16x32_bf16 v[100:103], a[20:23], v[132:135], v[100:103]
    ds_read_b64_tr_b16 v[126:127], v11 offset:22048
    s_waitcnt lgkmcnt(10)
    v_mfma_f32_16x16x32_bf16 v[64:67], a[16:19], v[136:139], v[64:67]
    ds_read_b64_tr_b16 v[128:129], v11 offset:9280
    buffer_load_dwordx4 v6, s[12:15], s37 offen offset:3072 lds
    v_mfma_f32_16x16x32_bf16 v[68:71], a[20:23], v[136:139], v[68:71]
    ds_read_b64_tr_b16 v[130:131], v11 offset:11840
    v_mfma_f32_16x16x32_bf16 v[104:107], a[16:19], v[140:143], v[104:107]
    ds_read_b64_tr_b16 v[132:133], v11 offset:19520
    s_add_u32 m0, s97, 4096
    v_mfma_f32_16x16x32_bf16 v[108:111], a[20:23], v[140:143], v[108:111]
    ds_read_b64_tr_b16 v[134:135], v11 offset:22080
    s_waitcnt lgkmcnt(8)
    v_mfma_f32_16x16x32_bf16 v[32:35], a[24:27], v[144:147], v[32:35]
    ds_read_b64_tr_b16 v[136:137], v11 offset:9312
    v_mfma_f32_16x16x32_bf16 v[36:39], a[28:31], v[144:147], v[36:39]
    ds_read_b64_tr_b16 v[138:139], v11 offset:11872
    buffer_load_dwordx4 v7, s[12:15], s37 offen offset:0 lds
    v_mfma_f32_16x16x32_bf16 v[72:75], a[24:27], v[148:151], v[72:75]
    ds_read_b64_tr_b16 v[140:141], v11 offset:19552
    v_mfma_f32_16x16x32_bf16 v[76:79], a[28:31], v[148:151], v[76:79]
    ds_read_b64_tr_b16 v[142:143], v11 offset:22112
    s_waitcnt lgkmcnt(8)
    v_mfma_f32_16x16x32_bf16 v[40:43], a[24:27], v[120:123], v[40:43]
    ds_read_b64_tr_b16 v[144:145], v11 offset:9344
    v_mfma_f32_16x16x32_bf16 v[44:47], a[28:31], v[120:123], v[44:47]
    ds_read_b64_tr_b16 v[146:147], v11 offset:11904
    v_mfma_f32_16x16x32_bf16 v[80:83], a[24:27], v[124:127], v[80:83]
    ds_read_b64_tr_b16 v[148:149], v11 offset:19584
    v_mfma_f32_16x16x32_bf16 v[84:87], a[28:31], v[124:127], v[84:87]
    ds_read_b64_tr_b16 v[150:151], v11 offset:22144
    s_waitcnt vmcnt(9) lgkmcnt(0)
    s_barrier
    v_mfma_f32_16x16x32_bf16 v[48:51], a[24:27], v[128:131], v[48:51]
    ds_read_b128 a[32:35], v8 offset:32768
    ds_read_b128 a[36:39], v8 offset:34816
    v_mfma_f32_16x16x32_bf16 v[52:55], a[28:31], v[128:131], v[52:55]
    ds_read_b64_tr_b16 v[120:121], v11 offset:24576
    ds_read_b64_tr_b16 v[122:123], v11 offset:27136
    v_mfma_f32_16x16x32_bf16 v[88:91], a[24:27], v[132:135], v[88:91]
    ds_read_b64_tr_b16 v[124:125], v11 offset:34816
    s_add_u32 s36, s36, 128
    v_mfma_f32_16x16x32_bf16 v[92:95], a[28:31], v[132:135], v[92:95]
    ds_read_b64_tr_b16 v[126:127], v11 offset:37376
    s_add_u32 s37, s37, 245760
    v_mfma_f32_16x16x32_bf16 v[56:59], a[24:27], v[136:139], v[56:59]
    ds_read_b64_tr_b16 v[128:129], v11 offset:24608
    s_cmp_eq_u32 s36, s34
    v_mfma_f32_16x16x32_bf16 v[60:63], a[28:31], v[136:139], v[60:63]
    ds_read_b64_tr_b16 v[130:131], v11 offset:27168
    s_cselect_b32 s37, s35, s37
    v_mfma_f32_16x16x32_bf16 v[96:99], a[24:27], v[140:143], v[96:99]
    ds_read_b64_tr_b16 v[132:133], v11 offset:34848
    s_cselect_b32 s7, 1280, 0
    v_mfma_f32_16x16x32_bf16 v[100:103], a[28:31], v[140:143], v[100:103]
    ds_read_b64_tr_b16 v[134:135], v11 offset:37408
    s_sub_u32 s36, s36, s7
    v_mfma_f32_16x16x32_bf16 v[64:67], a[24:27], v[144:147], v[64:67]
    ds_read_b64_tr_b16 v[136:137], v11 offset:24640
    s_add_u32 m0, s96, 16384
    v_mfma_f32_16x16x32_bf16 v[68:71], a[28:31], v[144:147], v[68:71]
    ds_read_b64_tr_b16 v[138:139], v11 offset:27200
    buffer_load_dwordx4 v1, s[8:11], s36 offen offset:0 lds
    v_mfma_f32_16x16x32_bf16 v[104:107], a[24:27], v[148:151], v[104:107]
    ds_read_b64_tr_b16 v[140:141], v11 offset:34880
    buffer_load_dwordx4 v2, s[8:11], s36 offen offset:1024 lds
    v_mfma_f32_16x16x32_bf16 v[108:111], a[28:31], v[148:151], v[108:111]
    ds_read_b64_tr_b16 v[142:143], v11 offset:37440
    s_waitcnt lgkmcnt(8)
    v_mfma_f32_16x16x32_bf16 v[32:35], a[32:35], v[120:123], v[32:35]
    ds_read_b64_tr_b16 v[144:145], v11 offset:24672
    buffer_load_dwordx4 v30, s[8:11], s36 offen offset:2048 lds
    v_mfma_f32_16x16x32_bf16 v[36:39], a[36:39], v[120:123], v[36:39]
    ds_read_b64_tr_b16 v[146:147], v11 offset:27232
    buffer_load_dwordx4 v31, s[8:11], s36 offen offset:3072 lds
    v_mfma_f32_16x16x32_bf16 v[72:75], a[32:35], v[124:127], v[72:75]
    ds_read_b64_tr_b16 v[148:149], v11 offset:34912
    v_mfma_f32_16x16x32_bf16 v[76:79], a[36:39], v[124:127], v[76:79]
    ds_read_b64_tr_b16 v[150:151], v11 offset:37472
    s_waitcnt lgkmcnt(8)
    v_mfma_f32_16x16x32_bf16 v[40:43], a[32:35], v[128:131], v[40:43]
    ds_read_b64_tr_b16 v[120:121], v11 offset:24704
    s_add_u32 m0, s97, 20480
    v_mfma_f32_16x16x32_bf16 v[44:47], a[36:39], v[128:131], v[44:47]
    ds_read_b64_tr_b16 v[122:123], v11 offset:27264
    v_mfma_f32_16x16x32_bf16 v[80:83], a[32:35], v[132:135], v[80:83]
    ds_read_b64_tr_b16 v[124:125], v11 offset:34944
    buffer_load_dwordx4 v3, s[12:15], s37 offen offset:0 lds
    v_mfma_f32_16x16x32_bf16 v[84:87], a[36:39], v[132:135], v[84:87]
    ds_read_b64_tr_b16 v[126:127], v11 offset:37504
    s_waitcnt lgkmcnt(8)
    v_mfma_f32_16x16x32_bf16 v[48:51], a[32:35], v[136:139], v[48:51]
    ds_read_b128 a[40:43], v9 offset:32768
    ds_read_b128 a[44:47], v9 offset:34816
    v_mfma_f32_16x16x32_bf16 v[52:55], a[36:39], v[136:139], v[52:55]
    ds_read_b64_tr_b16 v[128:129], v11 offset:29696
    ds_read_b64_tr_b16 v[130:131], v11 offset:32256
    v_mfma_f32_16x16x32_bf16 v[88:91], a[32:35], v[140:143], v[88:91]
    ds_read_b64_tr_b16 v[132:133], v11 offset:39936
    buffer_load_dwordx4 v4, s[12:15], s37 offen offset:1024 lds
    v_mfma_f32_16x16x32_bf16 v[92:95], a[36:39], v[140:143], v[92:95]
    ds_read_b64_tr_b16 v[134:135], v11 offset:42496
    s_waitcnt lgkmcnt(10)
    v_mfma_f32_16x16x32_bf16 v[56:59], a[32:35], v[144:147], v[56:59]
    ds_read_b64_tr_b16 v[136:137], v11 offset:29728
    buffer_load_dwordx4 v5, s[12:15], s37 offen offset:2048 lds
    v_mfma_f32_16x16x32_bf16 v[60:63], a[36:39], v[144:147], v[60:63]
    ds_read_b64_tr_b16 v[138:139], v11 offset:32288
    v_mfma_f32_16x16x32_bf16 v[96:99], a[32:35], v[148:151], v[96:99]
    ds_read_b64_tr_b16 v[140:141], v11 offset:39968
    v_mfma_f32_16x16x32_bf16 v[100:103], a[36:39], v[148:151], v[100:103]
    ds_read_b64_tr_b16 v[142:143], v11 offset:42528
    s_waitcnt lgkmcnt(10)
    v_mfma_f32_16x16x32_bf16 v[64:67], a[32:35], v[120:123], v[64:67]
    ds_read_b64_tr_b16 v[144:145], v11 offset:29760
    buffer_load_dwordx4 v6, s[12:15], s37 offen offset:3072 lds
    v_mfma_f32_16x16x32_bf16 v[68:71], a[36:39], v[120:123], v[68:71]
    ds_read_b64_tr_b16 v[146:147], v11 offset:32320
    v_mfma_f32_16x16x32_bf16 v[104:107], a[32:35], v[124:127], v[104:107]
    ds_read_b64_tr_b16 v[148:149], v11 offset:40000
    s_add_u32 m0, s97, 24576
    v_mfma_f32_16x16x32_bf16 v[108:111], a[36:39], v[124:127], v[108:111]
    ds_read_b64_tr_b16 v[150:151], v11 offset:42560
    s_waitcnt lgkmcnt(8)
    v_mfma_f32_16x16x32_bf16 v[32:35], a[40:43], v[128:131], v[32:35]
    ds_read_b64_tr_b16 v[120:121], v11 offset:29792
    v_mfma_f32_16x16x32_bf16 v[36:39], a[44:47], v[128:131], v[36:39]
    ds_read_b64_tr_b16 v[122:123], v11 offset:32352
    buffer_load_dwordx4 v7, s[12:15], s37 offen offset:0 lds
    v_mfma_f32_16x16x32_bf16 v[72:75], a[40:43], v[132:135], v[72:75]
    ds_read_b64_tr_b16 v[124:125], v11 offset:40032
    v_mfma_f32_16x16x32_bf16 v[76:79], a[44:47], v[132:135], v[76:79]
    ds_read_b64_tr_b16 v[126:127], v11 offset:42592
    s_waitcnt lgkmcnt(8)
    v_mfma_f32_16x16x32_bf16 v[40:43], a[40:43], v[136:139], v[40:43]
    ds_read_b64_tr_b16 v[128:129], v11 offset:29824
    v_mfma_f32_16x16x32_bf16 v[44:47], a[44:47], v[136:139], v[44:47]
    ds_read_b64_tr_b16 v[130:131], v11 offset:32384
    v_mfma_f32_16x16x32_bf16 v[80:83], a[40:43], v[140:143], v[80:83]
    ds_read_b64_tr_b16 v[132:133], v11 offset:40064
    v_mfma_f32_16x16x32_bf16 v[84:87], a[44:47], v[140:143], v[84:87]
    ds_read_b64_tr_b16 v[134:135], v11 offset:42624
    s_waitcnt vmcnt(9) lgkmcnt(0)
    s_barrier
    v_mfma_f32_16x16x32_bf16 v[48:51], a[40:43], v[144:147], v[48:51]
    ds_read_b128 a[48:51], v8 offset:0
    ds_read_b128 a[52:55], v8 offset:2048
    v_mfma_f32_16x16x32_bf16 v[52:55], a[44:47], v[144:147], v[52:55]
    ds_read_b64_tr_b16 v[136:137], v10 offset:49152
    ds_read_b64_tr_b16 v[138:139], v10 offset:51712
    v_mfma_f32_16x16x32_bf16 v[88:91], a[40:43], v[148:151], v[88:91]
    ds_read_b64_tr_b16 v[140:141], v10 offset:59392
    s_add_u32 s36, s36, 128
    v_mfma_f32_16x16x32_bf16 v[92:95], a[44:47], v[148:151], v[92:95]
    ds_read_b64_tr_b16 v[142:143], v10 offset:61952
    s_add_u32 s37, s37, 245760
    v_mfma_f32_16x16x32_bf16 v[56:59], a[40:43], v[120:123], v[56:59]
    ds_read_b64_tr_b16 v[144:145], v10 offset:49184
    s_cmp_eq_u32 s36, s34
    v_mfma_f32_16x16x32_bf16 v[60:63], a[44:47], v[120:123], v[60:63]
    ds_read_b64_tr_b16 v[146:147], v10 offset:51744
    s_cselect_b32 s37, s35, s37
    v_mfma_f32_16x16x32_bf16 v[96:99], a[40:43], v[124:127], v[96:99]
    ds_read_b64_tr_b16 v[148:149], v10 offset:59424
    s_cselect_b32 s7, 1280, 0
    v_mfma_f32_16x16x32_bf16 v[100:103], a[44:47], v[124:127], v[100:103]
    ds_read_b64_tr_b16 v[150:151], v10 offset:61984
    s_sub_u32 s36, s36, s7
    v_mfma_f32_16x16x32_bf16 v[64:67], a[40:43], v[128:131], v[64:67]
    ds_read_b64_tr_b16 v[120:121], v10 offset:49216
    s_add_u32 m0, s96, 32768
    v_mfma_f32_16x16x32_bf16 v[68:71], a[44:47], v[128:131], v[68:71]
    ds_read_b64_tr_b16 v[122:123], v10 offset:51776
    buffer_load_dwordx4 v1, s[8:11], s36 offen offset:0 lds
    v_mfma_f32_16x16x32_bf16 v[104:107], a[40:43], v[132:135], v[104:107]
    ds_read_b64_tr_b16 v[124:125], v10 offset:59456
    buffer_load_dwordx4 v2, s[8:11], s36 offen offset:1024 lds
    v_mfma_f32_16x16x32_bf16 v[108:111], a[44:47], v[132:135], v[108:111]
    ds_read_b64_tr_b16 v[126:127], v10 offset:62016
    s_waitcnt lgkmcnt(8)
    v_mfma_f32_16x16x32_bf16 v[32:35], a[48:51], v[136:139], v[32:35]
    ds_read_b64_tr_b16 v[128:129], v10 offset:49248
    buffer_load_dwordx4 v30, s[8:11], s36 offen offset:2048 lds
    v_mfma_f32_16x16x32_bf16 v[36:39], a[52:55], v[136:139], v[36:39]
    ds_read_b64_tr_b16 v[130:131], v10 offset:51808
    buffer_load_dwordx4 v31, s[8:11], s36 offen offset:3072 lds
    v_mfma_f32_16x16x32_bf16 v[72:75], a[48:51], v[140:143], v[72:75]
    ds_read_b64_tr_b16 v[132:133], v10 offset:59488
    v_mfma_f32_16x16x32_bf16 v[76:79], a[52:55], v[140:143], v[76:79]
    ds_read_b64_tr_b16 v[134:135], v10 offset:62048
    s_waitcnt lgkmcnt(8)
    v_mfma_f32_16x16x32_bf16 v[40:43], a[48:51], v[144:147], v[40:43]
    ds_read_b64_tr_b16 v[136:137], v10 offset:49280
    s_add_u32 m0, s97, 40960
    v_mfma_f32_16x16x32_bf16 v[44:47], a[52:55], v[144:147], v[44:47]
    ds_read_b64_tr_b16 v[138:139], v10 offset:51840
    v_mfma_f32_16x16x32_bf16 v[80:83], a[48:51], v[148:151], v[80:83]
    ds_read_b64_tr_b16 v[140:141], v10 offset:59520
    buffer_load_dwordx4 v3, s[12:15], s37 offen offset:0 lds
    v_mfma_f32_16x16x32_bf16 v[84:87], a[52:55], v[148:151], v[84:87]
    ds_read_b64_tr_b16 v[142:143], v10 offset:62080
    s_waitcnt lgkmcnt(8)
    v_mfma_f32_16x16x32_bf16 v[48:51], a[48:51], v[120:123], v[48:51]
    ds_read_b128 a[56:59], v9 offset:0
    ds_read_b128 a[60:63], v9 offset:2048
    v_mfma_f32_16x16x32_bf16 v[52:55], a[52:55], v[120:123], v[52:55]
    ds_read_b64_tr_b16 v[144:145], v10 offset:54272
    ds_read_b64_tr_b16 v[146:147], v10 offset:56832
    v_mfma_f32_16x16x32_bf16 v[88:91], a[48:51], v[124:127], v[88:91]
    ds_read_b64_tr_b16 v[148:149], v10 offset:64512
    buffer_load_dwordx4 v4, s[12:15], s37 offen offset:1024 lds
    v_mfma_f32_16x16x32_bf16 v[92:95], a[52:55], v[124:127], v[92:95]
    ds_read_b64_tr_b16 v[150:151], v11 offset:1536
    s_waitcnt lgkmcnt(10)
    v_mfma_f32_16x16x32_bf16 v[56:59], a[48:51], v[128:131], v[56:59]
    ds_read_b64_tr_b16 v[120:121], v10 offset:54304
    buffer_load_dwordx4 v5, s[12:15], s37 offen offset:2048 lds
    v_mfma_f32_16x16x32_bf16 v[60:63], a[52:55], v[128:131], v[60:63]
    ds_read_b64_tr_b16 v[122:123], v10 offset:56864
    v_mfma_f32_16x16x32_bf16 v[96:99], a[48:51], v[132:135], v[96:99]
    ds_read_b64_tr_b16 v[124:125], v10 offset:64544
    v_mfma_f32_16x16x32_bf16 v[100:103], a[52:55], v[132:135], v[100:103]
    ds_read_b64_tr_b16 v[126:127], v11 offset:1568
    s_waitcnt lgkmcnt(10)
    v_mfma_f32_16x16x32_bf16 v[64:67], a[48:51], v[136:139], v[64:67]
    ds_read_b64_tr_b16 v[128:129], v10 offset:54336
    buffer_load_dwordx4 v6, s[12:15], s37 offen offset:3072 lds
    v_mfma_f32_16x16x32_bf16 v[68:71], a[52:55], v[136:139], v[68:71]
    ds_read_b64_tr_b16 v[130:131], v10 offset:56896
    v_mfma_f32_16x16x32_bf16 v[104:107], a[48:51], v[140:143], v[104:107]
    ds_read_b64_tr_b16 v[132:133], v10 offset:64576
    s_add_u32 m0, s97, 45056
    v_mfma_f32_16x16x32_bf16 v[108:111], a[52:55], v[140:143], v[108:111]
    ds_read_b64_tr_b16 v[134:135], v11 offset:1600
    s_waitcnt lgkmcnt(8)
    v_mfma_f32_16x16x32_bf16 v[32:35], a[56:59], v[144:147], v[32:35]
    ds_read_b64_tr_b16 v[136:137], v10 offset:54368
    v_mfma_f32_16x16x32_bf16 v[36:39], a[60:63], v[144:147], v[36:39]
    ds_read_b64_tr_b16 v[138:139], v10 offset:56928
    buffer_load_dwordx4 v7, s[12:15], s37 offen offset:0 lds
    v_mfma_f32_16x16x32_bf16 v[72:75], a[56:59], v[148:151], v[72:75]
    ds_read_b64_tr_b16 v[140:141], v10 offset:64608
    v_mfma_f32_16x16x32_bf16 v[76:79], a[60:63], v[148:151], v[76:79]
    ds_read_b64_tr_b16 v[142:143], v11 offset:1632
    s_waitcnt lgkmcnt(8)
    v_mfma_f32_16x16x32_bf16 v[40:43], a[56:59], v[120:123], v[40:43]
    ds_read_b64_tr_b16 v[144:145], v10 offset:54400
    v_mfma_f32_16x16x32_bf16 v[44:47], a[60:63], v[120:123], v[44:47]
    ds_read_b64_tr_b16 v[146:147], v10 offset:56960
    v_mfma_f32_16x16x32_bf16 v[80:83], a[56:59], v[124:127], v[80:83]
    ds_read_b64_tr_b16 v[148:149], v10 offset:64640
    v_mfma_f32_16x16x32_bf16 v[84:87], a[60:63], v[124:127], v[84:87]
    ds_read_b64_tr_b16 v[150:151], v11 offset:1664
    s_waitcnt vmcnt(9) lgkmcnt(0)
    s_barrier
    v_mfma_f32_16x16x32_bf16 v[48:51], a[56:59], v[128:131], v[48:51]
    ds_read_b128 a[64:67], v8 offset:16384
    ds_read_b128 a[68:71], v8 offset:18432
    v_mfma_f32_16x16x32_bf16 v[52:55], a[60:63], v[128:131], v[52:55]
    ds_read_b64_tr_b16 v[120:121], v11 offset:4096
    ds_read_b64_tr_b16 v[122:123], v11 offset:6656
    v_mfma_f32_16x16x32_bf16 v[88:91], a[56:59], v[132:135], v[88:91]
    ds_read_b64_tr_b16 v[124:125], v11 offset:14336
    s_add_u32 s36, s36, 128
    v_mfma_f32_16x16x32_bf16 v[92:95], a[60:63], v[132:135], v[92:95]
    ds_read_b64_tr_b16 v[126:127], v11 offset:16896
    s_add_u32 s37, s37, 245760
    v_mfma_f32_16x16x32_bf16 v[56:59], a[56:59], v[136:139], v[56:59]
    ds_read_b64_tr_b16 v[128:129], v11 offset:4128
    s_cmp_eq_u32 s36, s34
    v_mfma_f32_16x16x32_bf16 v[60:63], a[60:63], v[136:139], v[60:63]
    ds_read_b64_tr_b16 v[130:131], v11 offset:6688
    s_cselect_b32 s37, s35, s37
    v_mfma_f32_16x16x32_bf16 v[96:99], a[56:59], v[140:143], v[96:99]
    ds_read_b64_tr_b16 v[132:133], v11 offset:14368
    s_cselect_b32 s7, 1280, 0
    v_mfma_f32_16x16x32_bf16 v[100:103], a[60:63], v[140:143], v[100:103]
    ds_read_b64_tr_b16 v[134:135], v11 offset:16928
    s_sub_u32 s36, s36, s7
    v_mfma_f32_16x16x32_bf16 v[64:67], a[56:59], v[144:147], v[64:67]
    ds_read_b64_tr_b16 v[136:137], v11 offset:4160
    s_add_u32 m0, s96, 0
    v_mfma_f32_16x16x32_bf16 v[68:71], a[60:63], v[144:147], v[68:71]
    ds_read_b64_tr_b16 v[138:139], v11 offset:6720
    buffer_load_dwordx4 v1, s[8:11], s36 offen offset:0 lds
    v_mfma_f32_16x16x32_bf16 v[104:107], a[56:59], v[148:151], v[104:107]
    ds_read_b64_tr_b16 v[140:141], v11 offset:14400
    buffer_load_dwordx4 v2, s[8:11], s36 offen offset:1024 lds
    v_mfma_f32_16x16x32_bf16 v[108:111], a[60:63], v[148:151], v[108:111]
    ds_read_b64_tr_b16 v[142:143], v11 offset:16960
    s_waitcnt lgkmcnt(8)
    v_mfma_f32_16x16x32_bf16 v[32:35], a[64:67], v[120:123], v[32:35]
    ds_read_b64_tr_b16 v[144:145], v11 offset:4192
    buffer_load_dwordx4 v30, s[8:11], s36 offen offset:2048 lds
    v_mfma_f32_16x16x32_bf16 v[36:39], a[68:71], v[120:123], v[36:39]
    ds_read_b64_tr_b16 v[146:147], v11 offset:6752
    buffer_load_dwordx4 v31, s[8:11], s36 offen offset:3072 lds
    v_mfma_f32_16x16x32_bf16 v[72:75], a[64:67], v[124:127], v[72:75]
    ds_read_b64_tr_b16 v[148:149], v11 offset:14432
    v_mfma_f32_16x16x32_bf16 v[76:79], a[68:71], v[124:127], v[76:79]
    ds_read_b64_tr_b16 v[150:151], v11 offset:16992
    s_waitcnt lgkmcnt(8)
    v_mfma_f32_16x16x32_bf16 v[40:43], a[64:67], v[128:131], v[40:43]
    ds_read_b64_tr_b16 v[120:121], v11 offset:4224
    s_add_u32 m0, s97, 0
    v_mfma_f32_16x16x32_bf16 v[44:47], a[68:71], v[128:131], v[44:47]
    ds_read_b64_tr_b16 v[122:123], v11 offset:6784
    v_mfma_f32_16x16x32_bf16 v[80:83], a[64:67], v[132:135], v[80:83]
    ds_read_b64_tr_b16 v[124:125], v11 offset:14464
    buffer_load_dwordx4 v3, s[12:15], s37 offen offset:0 lds
    v_mfma_f32_16x16x32_bf16 v[84:87], a[68:71], v[132:135], v[84:87]
    ds_read_b64_tr_b16 v[126:127], v11 offset:17024
    s_waitcnt lgkmcnt(8)
    v_mfma_f32_16x16x32_bf16 v[48:51], a[64:67], v[136:139], v[48:51]
    ds_read_b128 a[72:75], v9 offset:16384
    ds_read_b128 a[76:79], v9 offset:18432
    v_mfma_f32_16x16x32_bf16 v[52:55], a[68:71], v[136:139], v[52:55]
    ds_read_b64_tr_b16 v[128:129], v11 offset:9216
    ds_read_b64_tr_b16 v[130:131], v11 offset:11776
    v_mfma_f32_16x16x32_bf16 v[88:91], a[64:67], v[140:143], v[88:91]
    ds_read_b64_tr_b16 v[132:133], v11 offset:19456
    buffer_load_dwordx4 v4, s[12:15], s37 offen offset:1024 lds
    v_mfma_f32_16x16x32_bf16 v[92:95], a[68:71], v[140:143], v[92:95]
    ds_read_b64_tr_b16 v[134:135], v11 offset:22016
    s_waitcnt lgkmcnt(10)
    v_mfma_f32_16x16x32_bf16 v[56:59], a[64:67], v[144:147], v[56:59]
    ds_read_b64_tr_b16 v[136:137], v11 offset:9248
    buffer_load_dwordx4 v5, s[12:15], s37 offen offset:2048 lds
    v_mfma_f32_16x16x32_bf16 v[60:63], a[68:71], v[144:147], v[60:63]
    ds_read_b64_tr_b16 v[138:139], v11 offset:11808
    v_mfma_f32_16x16x32_bf16 v[96:99], a[64:67], v[148:151], v[96:99]
    ds_read_b64_tr_b16 v[140:141], v11 offset:19488
    v_mfma_f32_16x16x32_bf16 v[100:103], a[68:71], v[148:151], v[100:103]
    ds_read_b64_tr_b16 v[142:143], v11 offset:22048
    s_waitcnt lgkmcnt(10)
    v_mfma_f32_16x16x32_bf16 v[64:67], a[64:67], v[120:123], v[64:67]
    ds_read_b64_tr_b16 v[144:145], v11 offset:9280
    buffer_load_dwordx4 v6, s[12:15], s37 offen offset:3072 lds
    v_mfma_f32_16x16x32_bf16 v[68:71], a[68:71], v[120:123], v[68:71]
    ds_read_b64_tr_b16 v[146:147], v11 offset:11840
    v_mfma_f32_16x16x32_bf16 v[104:107], a[64:67], v[124:127], v[104:107]
    ds_read_b64_tr_b16 v[148:149], v11 offset:19520
    s_add_u32 m0, s97, 4096
    v_mfma_f32_16x16x32_bf16 v[108:111], a[68:71], v[124:127], v[108:111]
    ds_read_b64_tr_b16 v[150:151], v11 offset:22080
    s_waitcnt lgkmcnt(8)
    v_mfma_f32_16x16x32_bf16 v[32:35], a[72:75], v[128:131], v[32:35]
    ds_read_b64_tr_b16 v[120:121], v11 offset:9312
    v_mfma_f32_16x16x32_bf16 v[36:39], a[76:79], v[128:131], v[36:39]
    ds_read_b64_tr_b16 v[122:123], v11 offset:11872
    buffer_load_dwordx4 v7, s[12:15], s37 offen offset:0 lds
    v_mfma_f32_16x16x32_bf16 v[72:75], a[72:75], v[132:135], v[72:75]
    ds_read_b64_tr_b16 v[124:125], v11 offset:19552
    v_mfma_f32_16x16x32_bf16 v[76:79], a[76:79], v[132:135], v[76:79]
    ds_read_b64_tr_b16 v[126:127], v11 offset:22112
    s_waitcnt lgkmcnt(8)
    v_mfma_f32_16x16x32_bf16 v[40:43], a[72:75], v[136:139], v[40:43]
    ds_read_b64_tr_b16 v[128:129], v11 offset:9344
    v_mfma_f32_16x16x32_bf16 v[44:47], a[76:79], v[136:139], v[44:47]
    ds_read_b64_tr_b16 v[130:131], v11 offset:11904
    v_mfma_f32_16x16x32_bf16 v[80:83], a[72:75], v[140:143], v[80:83]
    ds_read_b64_tr_b16 v[132:133], v11 offset:19584
    v_mfma_f32_16x16x32_bf16 v[84:87], a[76:79], v[140:143], v[84:87]
    ds_read_b64_tr_b16 v[134:135], v11 offset:22144
    s_waitcnt vmcnt(9) lgkmcnt(0)
    s_barrier
    v_mfma_f32_16x16x32_bf16 v[48:51], a[72:75], v[144:147], v[48:51]
    ds_read_b128 a[80:83], v8 offset:32768
    ds_read_b128 a[84:87], v8 offset:34816
    v_mfma_f32_16x16x32_bf16 v[52:55], a[76:79], v[144:147], v[52:55]
    ds_read_b64_tr_b16 v[136:137], v11 offset:24576
    ds_read_b64_tr_b16 v[138:139], v11 offset:27136
    v_mfma_f32_16x16x32_bf16 v[88:91], a[72:75], v[148:151], v[88:91]
    ds_read_b64_tr_b16 v[140:141], v11 offset:34816
    s_add_u32 s36, s36, 128
    v_mfma_f32_16x16x32_bf16 v[92:95], a[76:79], v[148:151], v[92:95]
    ds_read_b64_tr_b16 v[142:143], v11 offset:37376
    s_add_u32 s37, s37, 245760
    v_mfma_f32_16x16x32_bf16 v[56:59], a[72:75], v[120:123], v[56:59]
    ds_read_b64_tr_b16 v[144:145], v11 offset:24608
    s_cmp_eq_u32 s36, s34
    v_mfma_f32_16x16x32_bf16 v[60:63], a[76:79], v[120:123], v[60:63]
    ds_read_b64_tr_b16 v[146:147], v11 offset:27168
    s_cselect_b32 s37, s35, s37
    v_mfma_f32_16x16x32_bf16 v[96:99], a[72:75], v[124:127], v[96:99]
    ds_read_b64_tr_b16 v[148:149], v11 offset:34848
    s_cselect_b32 s7, 1280, 0
    v_mfma_f32_16x16x32_bf16 v[100:103], a[76:79], v[124:127], v[100:103]
    ds_read_b64_tr_b16 v[150:151], v11 offset:37408
    s_sub_u32 s36, s36, s7
    v_mfma_f32_16x16x32_bf16 v[64:67], a[72:75], v[128:131], v[64:67]
    ds_read_b64_tr_b16 v[120:121], v11 offset:24640
    s_add_u32 m0, s96, 16384
    v_mfma_f32_16x16x32_bf16 v[68:71], a[76:79], v[128:131], v[68:71]
    ds_read_b64_tr_b16 v[122:123], v11 offset:27200
    buffer_load_dwordx4 v1, s[8:11], s36 offen offset:0 lds
    v_mfma_f32_16x16x32_bf16 v[104:107], a[72:75], v[132:135], v[104:107]
    ds_read_b64_tr_b16 v[124:125], v11 offset:34880
    buffer_load_dwordx4 v2, s[8:11], s36 offen offset:1024 lds
    v_mfma_f32_16x16x32_bf16 v[108:111], a[76:79], v[132:135], v[108:111]
    ds_read_b64_tr_b16 v[126:127], v11 offset:37440
    s_waitcnt lgkmcnt(8)
    v_mfma_f32_16x16x32_bf16 v[32:35], a[80:83], v[136:139], v[32:35]
    ds_read_b64_tr_b16 v[128:129], v11 offset:24672
    buffer_load_dwordx4 v30, s[8:11], s36 offen offset:2048 lds
    v_mfma_f32_16x16x32_bf16 v[36:39], a[84:87], v[136:139], v[36:39]
    ds_read_b64_tr_b16 v[130:131], v11 offset:27232
    buffer_load_dwordx4 v31, s[8:11], s36 offen offset:3072 lds
    v_mfma_f32_16x16x32_bf16 v[72:75], a[80:83], v[140:143], v[72:75]
    ds_read_b64_tr_b16 v[132:133], v11 offset:34912
    v_mfma_f32_16x16x32_bf16 v[76:79], a[84:87], v[140:143], v[76:79]
    ds_read_b64_tr_b16 v[134:135], v11 offset:37472
    s_waitcnt lgkmcnt(8)
    v_mfma_f32_16x16x32_bf16 v[40:43], a[80:83], v[144:147], v[40:43]
    ds_read_b64_tr_b16 v[136:137], v11 offset:24704
    s_add_u32 m0, s97, 20480
    v_mfma_f32_16x16x32_bf16 v[44:47], a[84:87], v[144:147], v[44:47]
    ds_read_b64_tr_b16 v[138:139], v11 offset:27264
    v_mfma_f32_16x16x32_bf16 v[80:83], a[80:83], v[148:151], v[80:83]
    ds_read_b64_tr_b16 v[140:141], v11 offset:34944
    buffer_load_dwordx4 v3, s[12:15], s37 offen offset:0 lds
    v_mfma_f32_16x16x32_bf16 v[84:87], a[84:87], v[148:151], v[84:87]
    ds_read_b64_tr_b16 v[142:143], v11 offset:37504
    s_waitcnt lgkmcnt(8)
    v_mfma_f32_16x16x32_bf16 v[48:51], a[80:83], v[120:123], v[48:51]
    ds_read_b128 a[88:91], v9 offset:32768
    ds_read_b128 a[92:95], v9 offset:34816
    v_mfma_f32_16x16x32_bf16 v[52:55], a[84:87], v[120:123], v[52:55]
    ds_read_b64_tr_b16 v[144:145], v11 offset:29696
    ds_read_b64_tr_b16 v[146:147], v11 offset:32256
    v_mfma_f32_16x16x32_bf16 v[88:91], a[80:83], v[124:127], v[88:91]
    ds_read_b64_tr_b16 v[148:149], v11 offset:39936
    buffer_load_dwordx4 v4, s[12:15], s37 offen offset:1024 lds
    v_mfma_f32_16x16x32_bf16 v[92:95], a[84:87], v[124:127], v[92:95]
    ds_read_b64_tr_b16 v[150:151], v11 offset:42496
    s_waitcnt lgkmcnt(10)
    v_mfma_f32_16x16x32_bf16 v[56:59], a[80:83], v[128:131], v[56:59]
    ds_read_b64_tr_b16 v[120:121], v11 offset:29728
    buffer_load_dwordx4 v5, s[12:15], s37 offen offset:2048 lds
    v_mfma_f32_16x16x32_bf16 v[60:63], a[84:87], v[128:131], v[60:63]
    ds_read_b64_tr_b16 v[122:123], v11 offset:32288
    v_mfma_f32_16x16x32_bf16 v[96:99], a[80:83], v[132:135], v[96:99]
    ds_read_b64_tr_b16 v[124:125], v11 offset:39968
    v_mfma_f32_16x16x32_bf16 v[100:103], a[84:87], v[132:135], v[100:103]
    ds_read_b64_tr_b16 v[126:127], v11 offset:42528
    s_waitcnt lgkmcnt(10)
    v_mfma_f32_16x16x32_bf16 v[64:67], a[80:83], v[136:139], v[64:67]
    ds_read_b64_tr_b16 v[128:129], v11 offset:29760
    buffer_load_dwordx4 v6, s[12:15], s37 offen offset:3072 lds
    v_mfma_f32_16x16x32_bf16 v[68:71], a[84:87], v[136:139], v[68:71]
    ds_read_b64_tr_b16 v[130:131], v11 offset:32320
    v_mfma_f32_16x16x32_bf16 v[104:107], a[80:83], v[140:143], v[104:107]
    ds_read_b64_tr_b16 v[132:133], v11 offset:40000
    s_add_u32 m0, s97, 24576
    v_mfma_f32_16x16x32_bf16 v[108:111], a[84:87], v[140:143], v[108:111]
    ds_read_b64_tr_b16 v[134:135], v11 offset:42560
    s_waitcnt lgkmcnt(8)
    v_mfma_f32_16x16x32_bf16 v[32:35], a[88:91], v[144:147], v[32:35]
    ds_read_b64_tr_b16 v[136:137], v11 offset:29792
    v_mfma_f32_16x16x32_bf16 v[36:39], a[92:95], v[144:147], v[36:39]
    ds_read_b64_tr_b16 v[138:139], v11 offset:32352
    buffer_load_dwordx4 v7, s[12:15], s37 offen offset:0 lds
    v_mfma_f32_16x16x32_bf16 v[72:75], a[88:91], v[148:151], v[72:75]
    ds_read_b64_tr_b16 v[140:141], v11 offset:40032
    v_mfma_f32_16x16x32_bf16 v[76:79], a[92:95], v[148:151], v[76:79]
    ds_read_b64_tr_b16 v[142:143], v11 offset:42592
    s_waitcnt lgkmcnt(8)
    v_mfma_f32_16x16x32_bf16 v[40:43], a[88:91], v[120:123], v[40:43]
    ds_read_b64_tr_b16 v[144:145], v11 offset:29824
    v_mfma_f32_16x16x32_bf16 v[44:47], a[92:95], v[120:123], v[44:47]
    ds_read_b64_tr_b16 v[146:147], v11 offset:32384
    v_mfma_f32_16x16x32_bf16 v[80:83], a[88:91], v[124:127], v[80:83]
    ds_read_b64_tr_b16 v[148:149], v11 offset:40064
    v_mfma_f32_16x16x32_bf16 v[84:87], a[92:95], v[124:127], v[84:87]
    ds_read_b64_tr_b16 v[150:151], v11 offset:42624
    s_waitcnt vmcnt(9) lgkmcnt(0)
    s_barrier
    v_mfma_f32_16x16x32_bf16 v[48:51], a[88:91], v[128:131], v[48:51]
    ds_read_b128 a[96:99], v8 offset:0
    ds_read_b128 a[100:103], v8 offset:2048
    v_mfma_f32_16x16x32_bf16 v[52:55], a[92:95], v[128:131], v[52:55]
    ds_read_b64_tr_b16 v[120:121], v10 offset:49152
    ds_read_b64_tr_b16 v[122:123], v10 offset:51712
    v_mfma_f32_16x16x32_bf16 v[88:91], a[88:91], v[132:135], v[88:91]
    ds_read_b64_tr_b16 v[124:125], v10 offset:59392
    s_add_u32 s36, s36, 128
    v_mfma_f32_16x16x32_bf16 v[92:95], a[92:95], v[132:135], v[92:95]
    ds_read_b64_tr_b16 v[126:127], v10 offset:61952
    s_add_u32 s37, s37, 245760
    v_mfma_f32_16x16x32_bf16 v[56:59], a[88:91], v[136:139], v[56:59]
    ds_read_b64_tr_b16 v[128:129], v10 offset:49184
    s_cmp_eq_u32 s36, s34
    v_mfma_f32_16x16x32_bf16 v[60:63], a[92:95], v[136:139], v[60:63]
    ds_read_b64_tr_b16 v[130:131], v10 offset:51744
    s_cselect_b32 s37, s35, s37
    v_mfma_f32_16x16x32_bf16 v[96:99], a[88:91], v[140:143], v[96:99]
    ds_read_b64_tr_b16 v[132:133], v10 offset:59424
    s_cselect_b32 s7, 1280, 0
    v_mfma_f32_16x16x32_bf16 v[100:103], a[92:95], v[140:143], v[100:103]
    ds_read_b64_tr_b16 v[134:135], v10 offset:61984
    s_sub_u32 s36, s36, s7
    v_mfma_f32_16x16x32_bf16 v[64:67], a[88:91], v[144:147], v[64:67]
    ds_read_b64_tr_b16 v[136:137], v10 offset:49216
    s_add_u32 m0, s96, 32768
    v_mfma_f32_16x16x32_bf16 v[68:71], a[92:95], v[144:147], v[68:71]
    ds_read_b64_tr_b16 v[138:139], v10 offset:51776
    buffer_load_dwordx4 v1, s[8:11], s36 offen offset:0 lds
    v_mfma_f32_16x16x32_bf16 v[104:107], a[88:91], v[148:151], v[104:107]
    ds_read_b64_tr_b16 v[140:141], v10 offset:59456
    buffer_load_dwordx4 v2, s[8:11], s36 offen offset:1024 lds
    v_mfma_f32_16x16x32_bf16 v[108:111], a[92:95], v[148:151], v[108:111]
    ds_read_b64_tr_b16 v[142:143], v10 offset:62016
    s_waitcnt lgkmcnt(8)
    v_mfma_f32_16x16x32_bf16 v[32:35], a[96:99], v[120:123], v[32:35]
    ds_read_b64_tr_b16 v[144:145], v10 offset:49248
    buffer_load_dwordx4 v30, s[8:11], s36 offen offset:2048 lds
    v_mfma_f32_16x16x32_bf16 v[36:39], a[100:103], v[120:123], v[36:39]
    ds_read_b64_tr_b16 v[146:147], v10 offset:51808
    buffer_load_dwordx4 v31, s[8:11], s36 offen offset:3072 lds
    v_mfma_f32_16x16x32_bf16 v[72:75], a[96:99], v[124:127], v[72:75]
    ds_read_b64_tr_b16 v[148:149], v10 offset:59488
    v_mfma_f32_16x16x32_bf16 v[76:79], a[100:103], v[124:127], v[76:79]
    ds_read_b64_tr_b16 v[150:151], v10 offset:62048
    s_waitcnt lgkmcnt(8)
    v_mfma_f32_16x16x32_bf16 v[40:43], a[96:99], v[128:131], v[40:43]
    ds_read_b64_tr_b16 v[120:121], v10 offset:49280
    s_add_u32 m0, s97, 40960
    v_mfma_f32_16x16x32_bf16 v[44:47], a[100:103], v[128:131], v[44:47]
    ds_read_b64_tr_b16 v[122:123], v10 offset:51840
    v_mfma_f32_16x16x32_bf16 v[80:83], a[96:99], v[132:135], v[80:83]
    ds_read_b64_tr_b16 v[124:125], v10 offset:59520
    buffer_load_dwordx4 v3, s[12:15], s37 offen offset:0 lds
    v_mfma_f32_16x16x32_bf16 v[84:87], a[100:103], v[132:135], v[84:87]
    ds_read_b64_tr_b16 v[126:127], v10 offset:62080
    s_waitcnt lgkmcnt(8)
    v_mfma_f32_16x16x32_bf16 v[48:51], a[96:99], v[136:139], v[48:51]
    ds_read_b128 a[104:107], v9 offset:0
    ds_read_b128 a[108:111], v9 offset:2048
    v_mfma_f32_16x16x32_bf16 v[52:55], a[100:103], v[136:139], v[52:55]
    ds_read_b64_tr_b16 v[128:129], v10 offset:54272
    ds_read_b64_tr_b16 v[130:131], v10 offset:56832
    v_mfma_f32_16x16x32_bf16 v[88:91], a[96:99], v[140:143], v[88:91]
    ds_read_b64_tr_b16 v[132:133], v10 offset:64512
    buffer_load_dwordx4 v4, s[12:15], s37 offen offset:1024 lds
    v_mfma_f32_16x16x32_bf16 v[92:95], a[100:103], v[140:143], v[92:95]
    ds_read_b64_tr_b16 v[134:135], v11 offset:1536
    s_waitcnt lgkmcnt(10)
    v_mfma_f32_16x16x32_bf16 v[56:59], a[96:99], v[144:147], v[56:59]
    ds_read_b64_tr_b16 v[136:137], v10 offset:54304
    buffer_load_dwordx4 v5, s[12:15], s37 offen offset:2048 lds
    v_mfma_f32_16x16x32_bf16 v[60:63], a[100:103], v[144:147], v[60:63]
    ds_read_b64_tr_b16 v[138:139], v10 offset:56864
    v_mfma_f32_16x16x32_bf16 v[96:99], a[96:99], v[148:151], v[96:99]
    ds_read_b64_tr_b16 v[140:141], v10 offset:64544
    v_mfma_f32_16x16x32_bf16 v[100:103], a[100:103], v[148:151], v[100:103]
    ds_read_b64_tr_b16 v[142:143], v11 offset:1568
    s_waitcnt lgkmcnt(10)
    v_mfma_f32_16x16x32_bf16 v[64:67], a[96:99], v[120:123], v[64:67]
    ds_read_b64_tr_b16 v[144:145], v10 offset:54336
    buffer_load_dwordx4 v6, s[12:15], s37 offen offset:3072 lds
    v_mfma_f32_16x16x32_bf16 v[68:71], a[100:103], v[120:123], v[68:71]
    ds_read_b64_tr_b16 v[146:147], v10 offset:56896
    v_mfma_f32_16x16x32_bf16 v[104:107], a[96:99], v[124:127], v[104:107]
    ds_read_b64_tr_b16 v[148:149], v10 offset:64576
    s_add_u32 m0, s97, 45056
    v_mfma_f32_16x16x32_bf16 v[108:111], a[100:103], v[124:127], v[108:111]
    ds_read_b64_tr_b16 v[150:151], v11 offset:1600
    s_waitcnt lgkmcnt(8)
    v_mfma_f32_16x16x32_bf16 v[32:35], a[104:107], v[128:131], v[32:35]
    ds_read_b64_tr_b16 v[120:121], v10 offset:54368
    v_mfma_f32_16x16x32_bf16 v[36:39], a[108:111], v[128:131], v[36:39]
    ds_read_b64_tr_b16 v[122:123], v10 offset:56928
    buffer_load_dwordx4 v7, s[12:15], s37 offen offset:0 lds
    v_mfma_f32_16x16x32_bf16 v[72:75], a[104:107], v[132:135], v[72:75]
    ds_read_b64_tr_b16 v[124:125], v10 offset:64608
    v_mfma_f32_16x16x32_bf16 v[76:79], a[108:111], v[132:135], v[76:79]
    ds_read_b64_tr_b16 v[126:127], v11 offset:1632
    s_waitcnt lgkmcnt(8)
    v_mfma_f32_16x16x32_bf16 v[40:43], a[104:107], v[136:139], v[40:43]
    ds_read_b64_tr_b16 v[128:129], v10 offset:54400
    v_mfma_f32_16x16x32_bf16 v[44:47], a[108:111], v[136:139], v[44:47]
    ds_read_b64_tr_b16 v[130:131], v10 offset:56960
    v_mfma_f32_16x16x32_bf16 v[80:83], a[104:107], v[140:143], v[80:83]
    ds_read_b64_tr_b16 v[132:133], v10 offset:64640
    v_mfma_f32_16x16x32_bf16 v[84:87], a[108:111], v[140:143], v[84:87]
    ds_read_b64_tr_b16 v[134:135], v11 offset:1664
    s_waitcnt vmcnt(9) lgkmcnt(0)
    s_barrier
    v_mfma_f32_16x16x32_bf16 v[48:51], a[104:107], v[144:147], v[48:51]
    ds_read_b128 a[112:115], v8 offset:16384
    ds_read_b128 a[116:119], v8 offset:18432
    v_mfma_f32_16x16x32_bf16 v[52:55], a[108:111], v[144:147], v[52:55]
    ds_read_b64_tr_b16 v[136:137], v11 offset:4096
    ds_read_b64_tr_b16 v[138:139], v11 offset:6656
    v_mfma_f32_16x16x32_bf16 v[88:91], a[104:107], v[148:151], v[88:91]
    ds_read_b64_tr_b16 v[140:141], v11 offset:14336
    s_add_u32 s36, s36, 128
    v_mfma_f32_16x16x32_bf16 v[92:95], a[108:111], v[148:151], v[92:95]
    ds_read_b64_tr_b16 v[142:143], v11 offset:16896
    s_add_u32 s37, s37, 245760
    v_mfma_f32_16x16x32_bf16 v[56:59], a[104:107], v[120:123], v[56:59]
    ds_read_b64_tr_b16 v[144:145], v11 offset:4128
    s_cmp_eq_u32 s36, s34
    v_mfma_f32_16x16x32_bf16 v[60:63], a[108:111], v[120:123], v[60:63]
    ds_read_b64_tr_b16 v[146:147], v11 offset:6688
    s_cselect_b32 s37, s35, s37
    v_mfma_f32_16x16x32_bf16 v[96:99], a[104:107], v[124:127], v[96:99]
    ds_read_b64_tr_b16 v[148:149], v11 offset:14368
    s_cselect_b32 s7, 1280, 0
    v_mfma_f32_16x16x32_bf16 v[100:103], a[108:111], v[124:127], v[100:103]
    ds_read_b64_tr_b16 v[150:151], v11 offset:16928
    s_sub_u32 s36, s36, s7
    v_mfma_f32_16x16x32_bf16 v[64:67], a[104:107], v[128:131], v[64:67]
    ds_read_b64_tr_b16 v[120:121], v11 offset:4160
    s_add_u32 m0, s96, 0
    v_mfma_f32_16x16x32_bf16 v[68:71], a[108:111], v[128:131], v[68:71]
    ds_read_b64_tr_b16 v[122:123], v11 offset:6720
    buffer_load_dwordx4 v1, s[8:11], s36 offen offset:0 lds
    v_mfma_f32_16x16x32_bf16 v[104:107], a[104:107], v[132:135], v[104:107]
    ds_read_b64_tr_b16 v[124:125], v11 offset:14400
    buffer_load_dwordx4 v2, s[8:11], s36 offen offset:1024 lds
    v_mfma_f32_16x16x32_bf16 v[108:111], a[108:111], v[132:135], v[108:111]
    ds_read_b64_tr_b16 v[126:127], v11 offset:16960
    s_waitcnt lgkmcnt(8)
    v_mfma_f32_16x16x32_bf16 v[32:35], a[112:115], v[136:139], v[32:35]
    ds_read_b64_tr_b16 v[128:129], v11 offset:4192
    buffer_load_dwordx4 v30, s[8:11], s36 offen offset:2048 lds
    v_mfma_f32_16x16x32_bf16 v[36:39], a[116:119], v[136:139], v[36:39]
    ds_read_b64_tr_b16 v[130:131], v11 offset:6752
    buffer_load_dwordx4 v31, s[8:11], s36 offen offset:3072 lds
    v_mfma_f32_16x16x32_bf16 v[72:75], a[112:115], v[140:143], v[72:75]
    ds_read_b64_tr_b16 v[132:133], v11 offset:14432
    v_mfma_f32_16x16x32_bf16 v[76:79], a[116:119], v[140:143], v[76:79]
    ds_read_b64_tr_b16 v[134:135], v11 offset:16992
    s_waitcnt lgkmcnt(8)
    v_mfma_f32_16x16x32_bf16 v[40:43], a[112:115], v[144:147], v[40:43]
    ds_read_b64_tr_b16 v[136:137], v11 offset:4224
    s_add_u32 m0, s97, 0
    v_mfma_f32_16x16x32_bf16 v[44:47], a[116:119], v[144:147], v[44:47]
    ds_read_b64_tr_b16 v[138:139], v11 offset:6784
    v_mfma_f32_16x16x32_bf16 v[80:83], a[112:115], v[148:151], v[80:83]
    ds_read_b64_tr_b16 v[140:141], v11 offset:14464
    buffer_load_dwordx4 v3, s[12:15], s37 offen offset:0 lds
    v_mfma_f32_16x16x32_bf16 v[84:87], a[116:119], v[148:151], v[84:87]
    ds_read_b64_tr_b16 v[142:143], v11 offset:17024
    s_waitcnt lgkmcnt(8)
    v_mfma_f32_16x16x32_bf16 v[48:51], a[112:115], v[120:123], v[48:51]
    ds_read_b128 a[120:123], v9 offset:16384
    ds_read_b128 a[124:127], v9 offset:18432
    v_mfma_f32_16x16x32_bf16 v[52:55], a[116:119], v[120:123], v[52:55]
    ds_read_b64_tr_b16 v[144:145], v11 offset:9216
    ds_read_b64_tr_b16 v[146:147], v11 offset:11776
    v_mfma_f32_16x16x32_bf16 v[88:91], a[112:115], v[124:127], v[88:91]
    ds_read_b64_tr_b16 v[148:149], v11 offset:19456
    buffer_load_dwordx4 v4, s[12:15], s37 offen offset:1024 lds
    v_mfma_f32_16x16x32_bf16 v[92:95], a[116:119], v[124:127], v[92:95]
    ds_read_b64_tr_b16 v[150:151], v11 offset:22016
    s_waitcnt lgkmcnt(10)
    v_mfma_f32_16x16x32_bf16 v[56:59], a[112:115], v[128:131], v[56:59]
    ds_read_b64_tr_b16 v[120:121], v11 offset:9248
    buffer_load_dwordx4 v5, s[12:15], s37 offen offset:2048 lds
    v_mfma_f32_16x16x32_bf16 v[60:63], a[116:119], v[128:131], v[60:63]
    ds_read_b64_tr_b16 v[122:123], v11 offset:11808
    v_mfma_f32_16x16x32_bf16 v[96:99], a[112:115], v[132:135], v[96:99]
    ds_read_b64_tr_b16 v[124:125], v11 offset:19488
    v_mfma_f32_16x16x32_bf16 v[100:103], a[116:119], v[132:135], v[100:103]
    ds_read_b64_tr_b16 v[126:127], v11 offset:22048
    s_waitcnt lgkmcnt(10)
    v_mfma_f32_16x16x32_bf16 v[64:67], a[112:115], v[136:139], v[64:67]
    ds_read_b64_tr_b16 v[128:129], v11 offset:9280
    buffer_load_dwordx4 v6, s[12:15], s37 offen offset:3072 lds
    v_mfma_f32_16x16x32_bf16 v[68:71], a[116:119], v[136:139], v[68:71]
    ds_read_b64_tr_b16 v[130:131], v11 offset:11840
    v_mfma_f32_16x16x32_bf16 v[104:107], a[112:115], v[140:143], v[104:107]
    ds_read_b64_tr_b16 v[132:133], v11 offset:19520
    s_add_u32 m0, s97, 4096
    v_mfma_f32_16x16x32_bf16 v[108:111], a[116:119], v[140:143], v[108:111]
    ds_read_b64_tr_b16 v[134:135], v11 offset:22080
    s_waitcnt lgkmcnt(8)
    v_mfma_f32_16x16x32_bf16 v[32:35], a[120:123], v[144:147], v[32:35]
    ds_read_b64_tr_b16 v[136:137], v11 offset:9312
    v_mfma_f32_16x16x32_bf16 v[36:39], a[124:127], v[144:147], v[36:39]
    ds_read_b64_tr_b16 v[138:139], v11 offset:11872
    buffer_load_dwordx4 v7, s[12:15], s37 offen offset:0 lds
    v_mfma_f32_16x16x32_bf16 v[72:75], a[120:123], v[148:151], v[72:75]
    ds_read_b64_tr_b16 v[140:141], v11 offset:19552
    v_mfma_f32_16x16x32_bf16 v[76:79], a[124:127], v[148:151], v[76:79]
    ds_read_b64_tr_b16 v[142:143], v11 offset:22112
    s_waitcnt lgkmcnt(8)
    v_mfma_f32_16x16x32_bf16 v[40:43], a[120:123], v[120:123], v[40:43]
    ds_read_b64_tr_b16 v[144:145], v11 offset:9344
    v_mfma_f32_16x16x32_bf16 v[44:47], a[124:127], v[120:123], v[44:47]
    ds_read_b64_tr_b16 v[146:147], v11 offset:11904
    v_mfma_f32_16x16x32_bf16 v[80:83], a[120:123], v[124:127], v[80:83]
    ds_read_b64_tr_b16 v[148:149], v11 offset:19584
    v_mfma_f32_16x16x32_bf16 v[84:87], a[124:127], v[124:127], v[84:87]
    ds_read_b64_tr_b16 v[150:151], v11 offset:22144
    s_waitcnt vmcnt(9) lgkmcnt(0)
    s_barrier
    v_mfma_f32_16x16x32_bf16 v[48:51], a[120:123], v[128:131], v[48:51]
    ds_read_b128 a[128:131], v8 offset:32768
    ds_read_b128 a[132:135], v8 offset:34816
    v_mfma_f32_16x16x32_bf16 v[52:55], a[124:127], v[128:131], v[52:55]
    ds_read_b64_tr_b16 v[120:121], v11 offset:24576
    ds_read_b64_tr_b16 v[122:123], v11 offset:27136
    v_mfma_f32_16x16x32_bf16 v[88:91], a[120:123], v[132:135], v[88:91]
    ds_read_b64_tr_b16 v[124:125], v11 offset:34816
    s_add_u32 s7, s101, 0
    v_mfma_f32_16x16x32_bf16 v[92:95], a[124:127], v[132:135], v[92:95]
    ds_read_b64_tr_b16 v[126:127], v11 offset:37376
    s_sub_u32 s37, s7, 10
    v_mfma_f32_16x16x32_bf16 v[56:59], a[120:123], v[136:139], v[56:59]
    ds_read_b64_tr_b16 v[128:129], v11 offset:24608
    s_cmp_ge_u32 s7, 10
    v_mfma_f32_16x16x32_bf16 v[60:63], a[124:127], v[136:139], v[60:63]
    ds_read_b64_tr_b16 v[130:131], v11 offset:27168
    s_cselect_b32 s7, s37, s7
    v_mfma_f32_16x16x32_bf16 v[96:99], a[120:123], v[140:143], v[96:99]
    ds_read_b64_tr_b16 v[132:133], v11 offset:34848
    s_mul_i32 s37, s7, 245760
    v_mfma_f32_16x16x32_bf16 v[100:103], a[124:127], v[140:143], v[100:103]
    ds_read_b64_tr_b16 v[134:135], v11 offset:37408
    s_add_u32 s37, s37, s100
    v_mfma_f32_16x16x32_bf16 v[64:67], a[120:123], v[144:147], v[64:67]
    ds_read_b64_tr_b16 v[136:137], v11 offset:24640
    s_mov_b32 s36, 110592
    v_mfma_f32_16x16x32_bf16 v[68:71], a[124:127], v[144:147], v[68:71]
    ds_read_b64_tr_b16 v[138:139], v11 offset:27200
    s_cmp_eq_u32 s46, 0
    v_mfma_f32_16x16x32_bf16 v[104:107], a[120:123], v[148:151], v[104:107]
    ds_read_b64_tr_b16 v[140:141], v11 offset:34880
    s_cselect_b32 s36, s36, 120832
    v_mfma_f32_16x16x32_bf16 v[108:111], a[124:127], v[148:151], v[108:111]
    ds_read_b64_tr_b16 v[142:143], v11 offset:37440
    s_waitcnt lgkmcnt(8)
    v_mfma_f32_16x16x32_bf16 v[32:35], a[128:131], v[120:123], v[32:35]
    ds_read_b64_tr_b16 v[144:145], v11 offset:24672
    s_add_u32 s36, s36, s54
    v_mfma_f32_16x16x32_bf16 v[36:39], a[132:135], v[120:123], v[36:39]
    ds_read_b64_tr_b16 v[146:147], v11 offset:27232
    s_mov_b32 m0, s36
    v_mfma_f32_16x16x32_bf16 v[72:75], a[128:131], v[124:127], v[72:75]
    ds_read_b64_tr_b16 v[148:149], v11 offset:34912
    buffer_load_dwordx4 v3, s[12:15], s37 offen offset:0 lds
    v_mfma_f32_16x16x32_bf16 v[76:79], a[132:135], v[124:127], v[76:79]
    ds_read_b64_tr_b16 v[150:151], v11 offset:37472
    s_waitcnt lgkmcnt(8)
    v_mfma_f32_16x16x32_bf16 v[40:43], a[128:131], v[128:131], v[40:43]
    ds_read_b64_tr_b16 v[120:121], v11 offset:24704
    buffer_load_dwordx4 v4, s[12:15], s37 offen offset:1024 lds
    v_mfma_f32_16x16x32_bf16 v[44:47], a[132:135], v[128:131], v[44:47]
    ds_read_b64_tr_b16 v[122:123], v11 offset:27264
    buffer_load_dwordx4 v5, s[12:15], s37 offen offset:2048 lds
    v_mfma_f32_16x16x32_bf16 v[80:83], a[128:131], v[132:135], v[80:83]
    ds_read_b64_tr_b16 v[124:125], v11 offset:34944
    buffer_load_dwordx4 v6, s[12:15], s37 offen offset:3072 lds
    v_mfma_f32_16x16x32_bf16 v[84:87], a[132:135], v[132:135], v[84:87]
    ds_read_b64_tr_b16 v[126:127], v11 offset:37504
    s_waitcnt lgkmcnt(8)
    v_mfma_f32_16x16x32_bf16 v[48:51], a[128:131], v[136:139], v[48:51]
    ds_read_b128 a[136:139], v9 offset:32768
    ds_read_b128 a[140:143], v9 offset:34816
    v_mfma_f32_16x16x32_bf16 v[52:55], a[132:135], v[136:139], v[52:55]
    ds_read_b64_tr_b16 v[128:129], v11 offset:29696
    ds_read_b64_tr_b16 v[130:131], v11 offset:32256
    v_mfma_f32_16x16x32_bf16 v[88:91], a[128:131], v[140:143], v[88:91]
    ds_read_b64_tr_b16 v[132:133], v11 offset:39936
    s_add_u32 m0, s36, 4096
    v_mfma_f32_16x16x32_bf16 v[92:95], a[132:135], v[140:143], v[92:95]
    ds_read_b64_tr_b16 v[134:135], v11 offset:42496
    s_waitcnt lgkmcnt(10)
    v_mfma_f32_16x16x32_bf16 v[56:59], a[128:131], v[144:147], v[56:59]
    ds_read_b64_tr_b16 v[136:137], v11 offset:29728
    buffer_load_dwordx4 v7, s[12:15], s37 offen offset:0 lds
    v_mfma_f32_16x16x32_bf16 v[60:63], a[132:135], v[144:147], v[60:63]
    ds_read_b64_tr_b16 v[138:139], v11 offset:32288
    v_add_u32 v250, 0, v0
    v_mfma_f32_16x16x32_bf16 v[96:99], a[128:131], v[148:151], v[96:99]
    ds_read_b64_tr_b16 v[140:141], v11 offset:39968
    s_mov_b32 s7, 0x33333334
    v_mfma_f32_16x16x32_bf16 v[100:103], a[132:135], v[148:151], v[100:103]
    ds_read_b64_tr_b16 v[142:143], v11 offset:42528
    s_waitcnt lgkmcnt(10)
    v_mfma_f32_16x16x32_bf16 v[64:67], a[128:131], v[120:123], v[64:67]
    ds_read_b64_tr_b16 v[144:145], v11 offset:29760
    v_mul_hi_u32 v251, v250, s7
    v_mfma_f32_16x16x32_bf16 v[68:71], a[132:135], v[120:123], v[68:71]
    ds_read_b64_tr_b16 v[146:147], v11 offset:32320
    v_mul_u32_u24 v252, 5, v251
    v_mfma_f32_16x16x32_bf16 v[104:107], a[128:131], v[124:127], v[104:107]
    ds_read_b64_tr_b16 v[148:149], v11 offset:40000
    v_sub_u32 v252, v250, v252
    s_mov_b32 s7, 0xccccccd
    v_mul_hi_u32 v253, v251, s7
    v_mul_u32_u24 v253, 20, v253
    v_lshl_add_u32 v253, v252, 2, v253
    v_lshlrev_b32 v1, 2, v253
    v_add_u32 v1, 6400, v1
    v_lshrrev_b32 v254, 4, v251
    v_lshrrev_b32 v255, 4, v253
    v_lshl_add_u32 v254, v254, 1, v255
    v_lshlrev_b32 v254, 9, v254
    v_bfe_u32 v255, v253, 2, 2
    v_and_b32 v251, 15, v251
    v_lshl_add_u32 v251, v255, 4, v251
    v_lshl_add_u32 v30, v251, 3, v254
    v_add_u32 v250, 256, v0
    s_mov_b32 s7, 0x33333334
    v_mul_hi_u32 v251, v250, s7
    v_mul_u32_u24 v252, 5, v251
    v_sub_u32 v252, v250, v252
    s_mov_b32 s7, 0xccccccd
    v_mul_hi_u32 v253, v251, s7
    v_mul_u32_u24 v253, 20, v253
    v_lshl_add_u32 v253, v252, 2, v253
    v_lshlrev_b32 v2, 2, v253
    v_add_u32 v2, 6400, v2
    v_lshrrev_b32 v254, 4, v251
    v_lshrrev_b32 v255, 4, v253
    v_lshl_add_u32 v254, v254, 1, v255
    v_lshlrev_b32 v254, 9, v254
    v_bfe_u32 v255, v253, 2, 2
    v_and_b32 v251, 15, v251
    v_lshl_add_u32 v251, v255, 4, v251
    v_lshl_add_u32 v31, v251, 3, v254
    v_cmp_gt_u32 vcc, 400, v250
    v_mov_b32 v254, 2147418112
    v_lshlrev_b32 v255, 3, v20
    v_add_u32 v255, 6656, v255
    v_cndmask_b32 v2, v254, v2, vcc
    v_cndmask_b32 v31, v255, v31, vcc
    v_mfma_f32_16x16x32_bf16 v[108:111], a[132:135], v[124:127], v[108:111]
    ds_read_b64_tr_b16 v[150:151], v11 offset:42560
    s_waitcnt lgkmcnt(8)
    v_mfma_f32_16x16x32_bf16 v[32:35], a[136:139], v[128:131], v[32:35]
    v_lshlrev_b32 v28, 2, v0
    v_mov_b32 v29, 2147418112
    ds_read_b64_tr_b16 v[120:121], v11 offset:29792
    v_cmp_gt_u32 vcc, 144, v0
    v_mov_b32 v248, 1069066811
    v_mov_b32 v249, 1069066811
    v_cndmask_b32 v29, v29, v28, vcc
    v_mfma_f32_16x16x32_bf16 v[36:39], a[140:143], v[128:131], v[36:39]
    ds_read_b64_tr_b16 v[122:123], v11 offset:32352
    v_mfma_f32_16x16x32_bf16 v[72:75], a[136:139], v[132:135], v[72:75]
    ds_read_b64_tr_b16 v[124:125], v11 offset:40032
    v_mov_b32 v244, 0x3f803f80
    v_mfma_f32_16x16x32_bf16 v[76:79], a[140:143], v[132:135], v[76:79]
    ds_read_b64_tr_b16 v[126:127], v11 offset:42592
    s_waitcnt lgkmcnt(8)
    v_mfma_f32_16x16x32_bf16 v[40:43], a[136:139], v[136:139], v[40:43]
    ds_read_b64_tr_b16 v[128:129], v11 offset:29824
    v_mov_b32 v245, 0x3f803f80
    v_mfma_f32_16x16x32_bf16 v[44:47], a[140:143], v[136:139], v[44:47]
    ds_read_b64_tr_b16 v[130:131], v11 offset:32384
    v_mov_b32 v246, 0x3f803f80
    v_mfma_f32_16x16x32_bf16 v[80:83], a[136:139], v[140:143], v[80:83]
    ds_read_b64_tr_b16 v[132:133], v11 offset:40064
    v_mov_b32 v247, 0x3f803f80
    v_mfma_f32_16x16x32_bf16 v[84:87], a[140:143], v[140:143], v[84:87]
    ds_read_b64_tr_b16 v[134:135], v11 offset:42624
    s_waitcnt vmcnt(5) lgkmcnt(0)
    s_barrier
    v_mfma_f32_16x16x32_bf16 v[48:51], a[136:139], v[144:147], v[48:51]
    ds_read_b128 a[144:147], v8 offset:0
    ds_read_b128 a[148:151], v8 offset:2048
    v_mfma_f32_16x16x32_bf16 v[52:55], a[140:143], v[144:147], v[52:55]
    ds_read_b64_tr_b16 v[136:137], v10 offset:49152
    ds_read_b64_tr_b16 v[138:139], v10 offset:51712
    v_mfma_f32_16x16x32_bf16 v[88:91], a[136:139], v[148:151], v[88:91]
    ds_read_b64_tr_b16 v[140:141], v10 offset:59392
    v_lshlrev_b32 v250, 4, v0
    v_mfma_f32_16x16x32_bf16 v[92:95], a[140:143], v[148:151], v[92:95]
    ds_read_b64_tr_b16 v[142:143], v10 offset:61952
    v_mov_b32 v252, 0
    v_mfma_f32_16x16x32_bf16 v[56:59], a[136:139], v[120:123], v[56:59]
    ds_read_b64_tr_b16 v[144:145], v10 offset:49184
    v_mov_b32 v253, 0
    v_mfma_f32_16x16x32_bf16 v[60:63], a[140:143], v[120:123], v[60:63]
    ds_read_b64_tr_b16 v[146:147], v10 offset:51744
    v_mov_b32 v254, 0
    v_mfma_f32_16x16x32_bf16 v[96:99], a[136:139], v[124:127], v[96:99]
    ds_read_b64_tr_b16 v[148:149], v10 offset:59424
    v_mov_b32 v255, 0
    v_mfma_f32_16x16x32_bf16 v[100:103], a[140:143], v[124:127], v[100:103]
    ds_write_b128 v250, v[252:255] offset:32768
    ds_read_b64_tr_b16 v[150:151], v10 offset:61984
    v_mfma_f32_16x16x32_bf16 v[64:67], a[136:139], v[128:131], v[64:67]
    ds_read_b64_tr_b16 v[120:121], v10 offset:49216
    v_mfma_f32_16x16x32_bf16 v[68:71], a[140:143], v[128:131], v[68:71]
    ds_read_b64_tr_b16 v[122:123], v10 offset:51776
    v_mfma_f32_16x16x32_bf16 v[104:107], a[136:139], v[132:135], v[104:107]
    ds_read_b64_tr_b16 v[124:125], v10 offset:59456
    v_mfma_f32_16x16x32_bf16 v[108:111], a[140:143], v[132:135], v[108:111]
    ds_read_b64_tr_b16 v[126:127], v10 offset:62016
    s_waitcnt lgkmcnt(9)
    v_mfma_f32_16x16x32_bf16 v[32:35], a[144:147], v[136:139], v[32:35]
    ds_read_b64_tr_b16 v[128:129], v10 offset:49248
    v_mfma_f32_16x16x32_bf16 v[36:39], a[148:151], v[136:139], v[36:39]
    ds_read_b64_tr_b16 v[130:131], v10 offset:51808
    ds_write_b128 v250, v[252:255] offset:36864
    v_mfma_f32_16x16x32_bf16 v[72:75], a[144:147], v[140:143], v[72:75]
    ds_read_b64_tr_b16 v[132:133], v10 offset:59488
    v_mfma_f32_16x16x32_bf16 v[76:79], a[148:151], v[140:143], v[76:79]
    ds_read_b64_tr_b16 v[134:135], v10 offset:62048
    s_waitcnt lgkmcnt(9)
    v_mfma_f32_16x16x32_bf16 v[40:43], a[144:147], v[144:147], v[40:43]
    ds_read_b64_tr_b16 v[136:137], v10 offset:49280
    v_mfma_f32_16x16x32_bf16 v[44:47], a[148:151], v[144:147], v[44:47]
    ds_read_b64_tr_b16 v[138:139], v10 offset:51840
    v_mfma_f32_16x16x32_bf16 v[80:83], a[144:147], v[148:151], v[80:83]
    ds_read_b64_tr_b16 v[140:141], v10 offset:59520
    v_mfma_f32_16x16x32_bf16 v[84:87], a[148:151], v[148:151], v[84:87]
    ds_read_b64_tr_b16 v[142:143], v10 offset:62080
    s_waitcnt lgkmcnt(9)
    v_mfma_f32_16x16x32_bf16 v[48:51], a[144:147], v[120:123], v[48:51]
    ds_read_b128 a[152:155], v9 offset:0
    ds_read_b128 a[156:159], v9 offset:2048
    v_mfma_f32_16x16x32_bf16 v[52:55], a[148:151], v[120:123], v[52:55]
    ds_write_b128 v250, v[252:255] offset:40960
    ds_read_b64_tr_b16 v[144:145], v10 offset:54272
    v_mfma_f32_16x16x32_bf16 v[88:91], a[144:147], v[124:127], v[88:91]
    ds_read_b64_tr_b16 v[146:147], v10 offset:56832
    ds_read_b64_tr_b16 v[148:149], v10 offset:64512
    v_mfma_f32_16x16x32_bf16 v[92:95], a[148:151], v[124:127], v[92:95]
    ds_read_b64_tr_b16 v[150:151], v11 offset:1536
    s_waitcnt lgkmcnt(11)
    v_mfma_f32_16x16x32_bf16 v[56:59], a[144:147], v[128:131], v[56:59]
    ds_read_b64_tr_b16 v[120:121], v10 offset:54304
    v_mfma_f32_16x16x32_bf16 v[60:63], a[148:151], v[128:131], v[60:63]
    ds_read_b64_tr_b16 v[122:123], v10 offset:56864
    v_mfma_f32_16x16x32_bf16 v[96:99], a[144:147], v[132:135], v[96:99]
    ds_read_b64_tr_b16 v[124:125], v10 offset:64544
    v_mfma_f32_16x16x32_bf16 v[100:103], a[148:151], v[132:135], v[100:103]
    ds_read_b64_tr_b16 v[126:127], v11 offset:1568
    ds_write_b128 v250, v[252:255] offset:45056
    s_waitcnt lgkmcnt(12)
    v_mfma_f32_16x16x32_bf16 v[64:67], a[144:147], v[136:139], v[64:67]
    ds_read_b64_tr_b16 v[128:129], v10 offset:54336
    v_mfma_f32_16x16x32_bf16 v[68:71], a[148:151], v[136:139], v[68:71]
    ds_read_b64_tr_b16 v[130:131], v10 offset:56896
    v_mfma_f32_16x16x32_bf16 v[104:107], a[144:147], v[140:143], v[104:107]
    ds_read_b64_tr_b16 v[132:133], v10 offset:64576
    v_mfma_f32_16x16x32_bf16 v[108:111], a[148:151], v[140:143], v[108:111]
    ds_read_b64_tr_b16 v[134:135], v11 offset:1600
    s_waitcnt lgkmcnt(9)
    v_mfma_f32_16x16x32_bf16 v[32:35], a[152:155], v[144:147], v[32:35]
    ds_read_b64_tr_b16 v[136:137], v10 offset:54368
    v_mfma_f32_16x16x32_bf16 v[36:39], a[156:159], v[144:147], v[36:39]
    ds_read_b64_tr_b16 v[138:139], v10 offset:56928
    v_mfma_f32_16x16x32_bf16 v[72:75], a[152:155], v[148:151], v[72:75]
    ds_read_b64_tr_b16 v[140:141], v10 offset:64608
    v_mov_b32 v26, v231
    v_mfma_f32_16x16x32_bf16 v[76:79], a[156:159], v[148:151], v[76:79]
    ds_read_b64_tr_b16 v[142:143], v11 offset:1632
    s_waitcnt lgkmcnt(9)
    v_mfma_f32_16x16x32_bf16 v[40:43], a[152:155], v[120:123], v[40:43]
    ds_read_b64_tr_b16 v[144:145], v10 offset:54400
    v_mfma_f32_16x16x32_bf16 v[44:47], a[156:159], v[120:123], v[44:47]
    ds_read_b64_tr_b16 v[146:147], v10 offset:56960
    v_mfma_f32_16x16x32_bf16 v[80:83], a[152:155], v[124:127], v[80:83]
    ds_read_b64_tr_b16 v[148:149], v10 offset:64640
    v_mfma_f32_16x16x32_bf16 v[84:87], a[156:159], v[124:127], v[84:87]
    ds_read_b64_tr_b16 v[150:151], v11 offset:1664
    s_waitcnt lgkmcnt(8)
    v_mfma_f32_16x16x32_bf16 v[48:51], a[152:155], v[128:131], v[48:51]
    v_mfma_f32_16x16x32_bf16 v[52:55], a[156:159], v[128:131], v[52:55]
    buffer_load_dword v25, v24, s[28:31], 0 offen sc1
    v_mfma_f32_16x16x32_bf16 v[88:91], a[152:155], v[132:135], v[88:91]
    v_mfma_f32_16x16x32_bf16 v[92:95], a[156:159], v[132:135], v[92:95]
    s_waitcnt lgkmcnt(4)
    v_mfma_f32_16x16x32_bf16 v[56:59], a[152:155], v[136:139], v[56:59]
    v_mfma_f32_16x16x32_bf16 v[60:63], a[156:159], v[136:139], v[60:63]
    v_mfma_f32_16x16x32_bf16 v[96:99], a[152:155], v[140:143], v[96:99]
    v_mfma_f32_16x16x32_bf16 v[100:103], a[156:159], v[140:143], v[100:103]
    s_waitcnt lgkmcnt(0)
    v_mfma_f32_16x16x32_bf16 v[64:67], a[152:155], v[144:147], v[64:67]
    v_mfma_f32_16x16x32_bf16 v[68:71], a[156:159], v[144:147], v[68:71]
    v_mfma_f32_16x16x32_bf16 v[104:107], a[152:155], v[148:151], v[104:107]
    v_mfma_f32_16x16x32_bf16 v[108:111], a[156:159], v[148:151], v[108:111]
    s_barrier
    v_cvt_pk_bf16_f32 v224, v72, v73
    v_cvt_pk_bf16_f32 v225, v74, v75
    v_cvt_pk_bf16_f32 v226, v76, v77
    v_cvt_pk_bf16_f32 v227, v78, v79
    v_cvt_pk_bf16_f32 v228, v80, v81
    v_cvt_pk_bf16_f32 v229, v82, v83
    v_cvt_pk_bf16_f32 v230, v84, v85
    v_cvt_pk_bf16_f32 v231, v86, v87
    v_cvt_pk_bf16_f32 v232, v88, v89
    v_cvt_pk_bf16_f32 v233, v90, v91
    v_cvt_pk_bf16_f32 v234, v92, v93
    v_cvt_pk_bf16_f32 v235, v94, v95
    v_cvt_pk_bf16_f32 v236, v96, v97
    v_cvt_pk_bf16_f32 v237, v98, v99
    v_cvt_pk_bf16_f32 v238, v100, v101
    v_cvt_pk_bf16_f32 v239, v102, v103
    v_cvt_pk_bf16_f32 v240, v104, v105
    v_cvt_pk_bf16_f32 v241, v106, v107
    v_cvt_pk_bf16_f32 v242, v108, v109
    v_cvt_pk_bf16_f32 v243, v110, v111
    v_pk_mul_f32 v[120:121], v[32:33], v[248:249]
    v_pk_mul_f32 v[122:123], v[34:35], v[248:249]
    v_pk_mul_f32 v[124:125], v[36:37], v[248:249]
    v_pk_mul_f32 v[126:127], v[38:39], v[248:249]
    s_add_u32 s7, s101, 2
    s_sub_u32 s37, s7, 10
    s_cmp_ge_u32 s7, 10
    s_cselect_b32 s7, s37, s7
    s_mul_i32 s37, s7, 245760
    s_add_u32 s37, s37, s100
    s_mov_b32 s36, 131072
    s_cmp_eq_u32 s46, 0
    s_cselect_b32 s36, s36, 141312
    s_add_u32 s36, s36, s54
    s_mov_b32 m0, s36
    s_nop 0
    buffer_load_dwordx4 v3, s[12:15], s37 offen offset:0 lds
    v_exp_f32 v120, v120 clamp
    v_max_f32 v32, v160, v32
    v_exp_f32 v121, v121 clamp
    v_max_f32 v33, v160, v33
    v_exp_f32 v122, v122 clamp
    v_max_f32 v34, v160, v34
    v_exp_f32 v123, v123 clamp
    v_max_f32 v35, v160, v35
    buffer_load_dwordx4 v4, s[12:15], s37 offen offset:1024 lds
    buffer_load_dwordx4 v5, s[12:15], s37 offen offset:2048 lds
    v_exp_f32 v124, v124 clamp
    v_max_f32 v36, v160, v36
    v_exp_f32 v125, v125 clamp
    v_max_f32 v37, v160, v37
    v_exp_f32 v126, v126 clamp
    v_max_f32 v38, v160, v38
    v_exp_f32 v127, v127 clamp
    v_max_f32 v39, v160, v39
    buffer_load_dwordx4 v6, s[12:15], s37 offen offset:3072 lds
    s_add_u32 m0, s36, 4096
    v_pk_add_f32 v[120:121], v[120:121], v[32:33]
    v_pk_add_f32 v[122:123], v[122:123], v[34:35]
    v_pk_add_f32 v[124:125], v[124:125], v[36:37]
    v_pk_add_f32 v[126:127], v[126:127], v[38:39]
    v_cvt_pk_bf16_f32 v204, v120, v121
    v_cvt_pk_bf16_f32 v205, v122, v123
    v_cvt_pk_bf16_f32 v206, v124, v125
    v_cvt_pk_bf16_f32 v207, v126, v127
    v_pk_mul_f32 v[120:121], v[40:41], v[248:249]
    v_pk_mul_f32 v[122:123], v[42:43], v[248:249]
    v_pk_mul_f32 v[124:125], v[44:45], v[248:249]
    v_pk_mul_f32 v[126:127], v[46:47], v[248:249]
    buffer_load_dwordx4 v7, s[12:15], s37 offen offset:0 lds
    s_add_u32 s7, s101, 4
    s_sub_u32 s37, s7, 10
    s_cmp_ge_u32 s7, 10
    s_cselect_b32 s7, s37, s7
    s_mul_i32 s37, s7, 245760
    s_add_u32 s37, s37, s100
    s_mov_b32 s36, 151552
    s_cmp_eq_u32 s46, 0
    s_cselect_b32 s36, s36, 16384
    s_add_u32 s36, s36, s54
    s_mov_b32 m0, s36
    v_exp_f32 v120, v120 clamp
    v_max_f32 v40, v160, v40
    v_exp_f32 v121, v121 clamp
    v_max_f32 v41, v160, v41
    v_exp_f32 v122, v122 clamp
    v_max_f32 v42, v160, v42
    v_exp_f32 v123, v123 clamp
    v_max_f32 v43, v160, v43
    buffer_load_dwordx4 v3, s[12:15], s37 offen offset:0 lds
    buffer_load_dwordx4 v4, s[12:15], s37 offen offset:1024 lds
    v_exp_f32 v124, v124 clamp
    v_max_f32 v44, v160, v44
    v_exp_f32 v125, v125 clamp
    v_max_f32 v45, v160, v45
    v_exp_f32 v126, v126 clamp
    v_max_f32 v46, v160, v46
    v_exp_f32 v127, v127 clamp
    v_max_f32 v47, v160, v47
    buffer_load_dwordx4 v5, s[12:15], s37 offen offset:2048 lds
    buffer_load_dwordx4 v6, s[12:15], s37 offen offset:3072 lds
    v_pk_add_f32 v[120:121], v[120:121], v[40:41]
    v_pk_add_f32 v[122:123], v[122:123], v[42:43]
    v_pk_add_f32 v[124:125], v[124:125], v[44:45]
    v_pk_add_f32 v[126:127], v[126:127], v[46:47]
    v_cvt_pk_bf16_f32 v208, v120, v121
    v_cvt_pk_bf16_f32 v209, v122, v123
    v_cvt_pk_bf16_f32 v210, v124, v125
    v_cvt_pk_bf16_f32 v211, v126, v127
    v_pk_mul_f32 v[120:121], v[48:49], v[248:249]
    v_pk_mul_f32 v[122:123], v[50:51], v[248:249]
    v_pk_mul_f32 v[124:125], v[52:53], v[248:249]
    v_pk_mul_f32 v[126:127], v[54:55], v[248:249]
    s_add_u32 m0, s36, 4096
    s_nop 0
    buffer_load_dwordx4 v7, s[12:15], s37 offen offset:0 lds
    v_exp_f32 v120, v120 clamp
    v_max_f32 v48, v160, v48
    v_exp_f32 v121, v121 clamp
    v_max_f32 v49, v160, v49
    v_exp_f32 v122, v122 clamp
    v_max_f32 v50, v160, v50
    v_exp_f32 v123, v123 clamp
    v_max_f32 v51, v160, v51
    s_add_u32 s7, s101, 6
    s_sub_u32 s37, s7, 10
    s_cmp_ge_u32 s7, 10
    s_cselect_b32 s7, s37, s7
    s_mul_i32 s37, s7, 245760
    s_add_u32 s37, s37, s100
    s_mov_b32 s36, 69632
    s_cmp_eq_u32 s46, 0
    s_cselect_b32 s36, s36, 79872
    s_add_u32 s36, s36, s54
    s_mov_b32 m0, s36
    v_exp_f32 v124, v124 clamp
    v_max_f32 v52, v160, v52
    v_exp_f32 v125, v125 clamp
    v_max_f32 v53, v160, v53
    v_exp_f32 v126, v126 clamp
    v_max_f32 v54, v160, v54
    v_exp_f32 v127, v127 clamp
    v_max_f32 v55, v160, v55
    buffer_load_dwordx4 v3, s[12:15], s37 offen offset:0 lds
    buffer_load_dwordx4 v4, s[12:15], s37 offen offset:1024 lds
    v_pk_add_f32 v[120:121], v[120:121], v[48:49]
    v_pk_add_f32 v[122:123], v[122:123], v[50:51]
    v_pk_add_f32 v[124:125], v[124:125], v[52:53]
    v_pk_add_f32 v[126:127], v[126:127], v[54:55]
    v_cvt_pk_bf16_f32 v212, v120, v121
    v_cvt_pk_bf16_f32 v213, v122, v123
    v_cvt_pk_bf16_f32 v214, v124, v125
    v_cvt_pk_bf16_f32 v215, v126, v127
    v_pk_mul_f32 v[120:121], v[56:57], v[248:249]
    v_pk_mul_f32 v[122:123], v[58:59], v[248:249]
    v_pk_mul_f32 v[124:125], v[60:61], v[248:249]
    v_pk_mul_f32 v[126:127], v[62:63], v[248:249]
    buffer_load_dwordx4 v5, s[12:15], s37 offen offset:2048 lds
    buffer_load_dwordx4 v6, s[12:15], s37 offen offset:3072 lds
    v_exp_f32 v120, v120 clamp
    v_max_f32 v56, v160, v56
    v_exp_f32 v121, v121 clamp
    v_max_f32 v57, v160, v57
    v_exp_f32 v122, v122 clamp
    v_max_f32 v58, v160, v58
    v_exp_f32 v123, v123 clamp
    v_max_f32 v59, v160, v59
    s_add_u32 m0, s36, 4096
    s_nop 0
    buffer_load_dwordx4 v7, s[12:15], s37 offen offset:0 lds
    v_exp_f32 v124, v124 clamp
    v_max_f32 v60, v160, v60
    v_exp_f32 v125, v125 clamp
    v_max_f32 v61, v160, v61
    v_exp_f32 v126, v126 clamp
    v_max_f32 v62, v160, v62
    v_exp_f32 v127, v127 clamp
    v_max_f32 v63, v160, v63
    s_add_u32 s7, s101, 8
    s_sub_u32 s37, s7, 10
    s_cmp_ge_u32 s7, 10
    s_cselect_b32 s7, s37, s7
    s_mul_i32 s37, s7, 245760
    s_add_u32 s37, s37, s100
    s_mov_b32 s36, 90112
    s_cmp_eq_u32 s46, 0
    s_cselect_b32 s36, s36, 100352
    s_add_u32 s36, s36, s54
    s_mov_b32 m0, s36
    s_nop 0
    buffer_load_dwordx4 v3, s[12:15], s37 offen offset:0 lds
    v_pk_add_f32 v[120:121], v[120:121], v[56:57]
    v_pk_add_f32 v[122:123], v[122:123], v[58:59]
    v_pk_add_f32 v[124:125], v[124:125], v[60:61]
    v_pk_add_f32 v[126:127], v[126:127], v[62:63]
    v_cvt_pk_bf16_f32 v216, v120, v121
    v_cvt_pk_bf16_f32 v217, v122, v123
    v_cvt_pk_bf16_f32 v218, v124, v125
    v_cvt_pk_bf16_f32 v219, v126, v127
    v_pk_mul_f32 v[120:121], v[64:65], v[248:249]
    v_pk_mul_f32 v[122:123], v[66:67], v[248:249]
    v_pk_mul_f32 v[124:125], v[68:69], v[248:249]
    v_pk_mul_f32 v[126:127], v[70:71], v[248:249]
    buffer_load_dwordx4 v4, s[12:15], s37 offen offset:1024 lds
    buffer_load_dwordx4 v5, s[12:15], s37 offen offset:2048 lds
    v_exp_f32 v120, v120 clamp
    v_max_f32 v64, v160, v64
    v_exp_f32 v121, v121 clamp
    v_max_f32 v65, v160, v65
    v_exp_f32 v122, v122 clamp
    v_max_f32 v66, v160, v66
    v_exp_f32 v123, v123 clamp
    v_max_f32 v67, v160, v67
    buffer_load_dwordx4 v6, s[12:15], s37 offen offset:3072 lds
    s_add_u32 m0, s36, 4096
    v_exp_f32 v124, v124 clamp
    v_max_f32 v68, v160, v68
    v_exp_f32 v125, v125 clamp
    v_max_f32 v69, v160, v69
    v_exp_f32 v126, v126 clamp
    v_max_f32 v70, v160, v70
    v_exp_f32 v127, v127 clamp
    v_max_f32 v71, v160, v71
    buffer_load_dwordx4 v7, s[12:15], s37 offen offset:0 lds
    v_pk_add_f32 v[120:121], v[120:121], v[64:65]
    v_pk_add_f32 v[122:123], v[122:123], v[66:67]
    v_pk_add_f32 v[124:125], v[124:125], v[68:69]
    v_pk_add_f32 v[126:127], v[126:127], v[70:71]
    v_cvt_pk_bf16_f32 v220, v120, v121
    v_cvt_pk_bf16_f32 v221, v122, v123
    v_cvt_pk_bf16_f32 v222, v124, v125
    v_cvt_pk_bf16_f32 v223, v126, v127
    v_mfma_f32_16x16x32_bf16 v[128:131], v[204:207], v[224:227], 0
    v_mfma_f32_16x16x32_bf16 v[132:135], v[204:207], v[228:231], 0
    v_mfma_f32_16x16x32_bf16 v[136:139], v[204:207], v[244:247], 0
    v_mfma_f32_16x16x32_bf16 v[140:143], v[208:211], v[224:227], 0
    v_mfma_f32_16x16x32_bf16 v[144:147], v[208:211], v[228:231], 0
    v_mfma_f32_16x16x32_bf16 v[148:151], v[208:211], v[232:235], 0
    v_mfma_f32_16x16x32_bf16 v[152:155], v[208:211], v[244:247], 0
    v_mfma_f32_16x16x32_bf16 v[156:159], v[212:215], v[228:231], 0
    v_mfma_f32_16x16x32_bf16 v[72:75], v[212:215], v[232:235], 0
    v_mfma_f32_16x16x32_bf16 v[76:79], v[212:215], v[236:239], 0
    v_mfma_f32_16x16x32_bf16 v[80:83], v[212:215], v[244:247], 0
    v_mfma_f32_16x16x32_bf16 v[84:87], v[216:219], v[232:235], 0
    v_mfma_f32_16x16x32_bf16 v[88:91], v[216:219], v[236:239], 0
    v_mfma_f32_16x16x32_bf16 v[92:95], v[216:219], v[240:243], 0
    v_mfma_f32_16x16x32_bf16 v[96:99], v[216:219], v[244:247], 0
    v_mfma_f32_16x16x32_bf16 v[100:103], v[220:223], v[236:239], 0
    v_mfma_f32_16x16x32_bf16 v[104:107], v[220:223], v[240:243], 0
    v_mfma_f32_16x16x32_bf16 v[108:111], v[220:223], v[244:247], 0
    s_mov_b64 exec, s[64:65]
    ds_write_b128 v14, v[128:131] offset:0
    s_mov_b64 exec, s[66:67]
    ds_write_b128 v14, v[132:135] offset:1280
    s_mov_b64 exec, s[68:69]
    ds_write_b128 v19, v[136:139] offset:0
    s_mov_b64 exec, s[70:71]
    ds_write_b128 v15, v[140:143] offset:0
    s_mov_b64 exec, s[72:73]
    ds_write_b128 v15, v[144:147] offset:1280
    s_mov_b64 exec, s[74:75]
    ds_write_b128 v15, v[148:151] offset:2560
    s_mov_b64 exec, s[68:69]
    ds_write_b128 v19, v[152:155] offset:64
    s_mov_b64 exec, s[76:77]
    ds_write_b128 v16, v[156:159] offset:1280
    s_mov_b64 exec, s[78:79]
    ds_write_b128 v16, v[72:75] offset:2560
    s_mov_b64 exec, s[80:81]
    ds_write_b128 v16, v[76:79] offset:3840
    s_mov_b64 exec, s[68:69]
    ds_write_b128 v19, v[80:83] offset:128
    s_mov_b64 exec, s[82:83]
    ds_write_b128 v17, v[84:87] offset:2560
    s_mov_b64 exec, s[84:85]
    ds_write_b128 v17, v[88:91] offset:3840
    s_mov_b64 exec, s[86:87]
    ds_write_b128 v17, v[92:95] offset:5120
    s_mov_b64 exec, s[68:69]
    ds_write_b128 v19, v[96:99] offset:192
    s_mov_b64 exec, s[88:89]
    ds_write_b128 v18, v[100:103] offset:3840
    s_mov_b64 exec, s[64:65]
    ds_write_b128 v18, v[104:107] offset:5120
    s_mov_b64 exec, s[68:69]
    ds_write_b128 v19, v[108:111] offset:256
    s_mov_b64 exec, -1
    s_waitcnt vmcnt(20)
    v_cmp_ne_u32 vcc, 0, v25
    s_mov_b32 s98, 0
    s_nop 0
    s_cmp_eq_u64 vcc, -1
    s_cbranch_scc1 L_ok_1
L_spin_2:
    buffer_load_dword v25, v24, s[28:31], 0 offen sc1
    s_add_u32 s98, s98, 1
    s_waitcnt vmcnt(0)
    v_cmp_ne_u32 vcc, 0, v25
    s_cmp_gt_u32 s98, 0x40000
    s_cbranch_scc1 L_ok_1
    s_cmp_eq_u64 vcc, -1
    s_cbranch_scc0 L_spin_2
L_ok_1:
    v_mov_b32 v24, v26
    buffer_load_dword v25, v24, s[16:19], 0 offen sc1
    s_waitcnt vmcnt(6) lgkmcnt(0)
    s_barrier
    ds_read2st64_b32 v[32:33], v28 offset0:0 offset1:28
    ds_read2st64_b32 v[34:35], v28 offset0:192 offset1:220
    ds_read2st64_b32 v[36:37], v28 offset0:4 offset1:32
    ds_read2st64_b32 v[38:39], v28 offset0:196 offset1:224
    ds_read2st64_b32 v[40:41], v28 offset0:8 offset1:36
    ds_read2st64_b32 v[42:43], v28 offset0:200 offset1:228
    ds_read2st64_b32 v[44:45], v28 offset0:12 offset1:40
    ds_read2st64_b32 v[46:47], v28 offset0:204 offset1:232
    ds_read2st64_b32 v[48:49], v28 offset0:16 offset1:44
    ds_read2st64_b32 v[50:51], v28 offset0:208 offset1:236
    ds_read2st64_b32 v[52:53], v28 offset0:20 offset1:48
    ds_read2st64_b32 v[54:55], v28 offset0:212 offset1:240
    ds_read2st64_b32 v[56:57], v28 offset0:24 offset1:52
    ds_read2st64_b32 v[58:59], v28 offset0:216 offset1:244
    s_lshl_b32 s38, s5, 13
    s_add_u32 s38, s38, 131072
    s_waitcnt lgkmcnt(12)
    v_pk_add_f32 v[32:33], v[32:33], v[34:35]
    v_add_f32 v32, v32, v33
    s_add_u32 s7, s38, 0
    buffer_atomic_add_f32 v32, v28, s[16:19], s7 offen offset:0
    s_waitcnt lgkmcnt(10)
    v_pk_add_f32 v[36:37], v[36:37], v[38:39]
    v_add_f32 v36, v36, v37
    buffer_atomic_add_f32 v36, v28, s[16:19], s7 offen offset:1024
    s_waitcnt lgkmcnt(8)
    v_pk_add_f32 v[40:41], v[40:41], v[42:43]
    v_add_f32 v40, v40, v41
    buffer_atomic_add_f32 v40, v28, s[16:19], s7 offen offset:2048
    s_waitcnt lgkmcnt(6)
    v_pk_add_f32 v[44:45], v[44:45], v[46:47]
    v_add_f32 v44, v44, v45
    buffer_atomic_add_f32 v44, v28, s[16:19], s7 offen offset:3072
    s_waitcnt lgkmcnt(4)
    v_pk_add_f32 v[48:49], v[48:49], v[50:51]
    v_add_f32 v48, v48, v49
    s_add_u32 s7, s38, 4096
    buffer_atomic_add_f32 v48, v28, s[16:19], s7 offen offset:0
    s_waitcnt lgkmcnt(2)
    v_pk_add_f32 v[52:53], v[52:53], v[54:55]
    v_add_f32 v52, v52, v53
    buffer_atomic_add_f32 v52, v28, s[16:19], s7 offen offset:1024
    s_waitcnt lgkmcnt(0)
    v_pk_add_f32 v[56:57], v[56:57], v[58:59]
    v_add_f32 v56, v56, v57
    buffer_atomic_add_f32 v56, v29, s[16:19], s7 offen offset:2048
    ds_read_b64_tr_b16 v[72:73], v11 offset:45056
    ds_read_b64_tr_b16 v[74:75], v11 offset:47616
    ds_read_b64_tr_b16 v[76:77], v11 offset:45088
    ds_read_b64_tr_b16 v[78:79], v11 offset:47648
    ds_read_b64_tr_b16 v[80:81], v11 offset:45120
    ds_read_b64_tr_b16 v[82:83], v11 offset:47680
    ds_read_b64_tr_b16 v[84:85], v11 offset:45152
    ds_read_b64_tr_b16 v[86:87], v11 offset:47712
    ds_read_b64_tr_b16 v[88:89], v11 offset:45184
    ds_read_b64_tr_b16 v[90:91], v11 offset:47744
    ds_read_b64_tr_b16 v[92:93], v11 offset:50176
    ds_read_b64_tr_b16 v[94:95], v11 offset:52736
    v_mov_b32 v64, 897988541
    v_mov_b32 v65, 897988541
    v_mov_b32 v66, 897988541
    v_mov_b32 v67, 897988541
    v_mov_b32 v28, 1069066811
    v_mov_b32 v29, 1069066811
    s_waitcnt lgkmcnt(8)
    v_mfma_f32_16x16x32_bf16 v[164:167], v[72:75], a[0:3], v[64:67]
    ds_read_b64_tr_b16 v[96:97], v11 offset:50208
    v_mfma_f32_16x16x32_bf16 v[184:187], v[72:75], a[4:7], v[64:67]
    ds_read_b64_tr_b16 v[98:99], v11 offset:52768
    v_mfma_f32_16x16x32_bf16 v[168:171], v[76:79], a[0:3], v[64:67]
    ds_read_b64_tr_b16 v[100:101], v11 offset:50240
    v_mfma_f32_16x16x32_bf16 v[188:191], v[76:79], a[4:7], v[64:67]
    ds_read_b64_tr_b16 v[102:103], v11 offset:52800
    s_waitcnt lgkmcnt(8)
    v_mfma_f32_16x16x32_bf16 v[172:175], v[80:83], a[0:3], v[64:67]
    ds_read_b64_tr_b16 v[72:73], v11 offset:50272
    v_mfma_f32_16x16x32_bf16 v[192:195], v[80:83], a[4:7], v[64:67]
    ds_read_b64_tr_b16 v[74:75], v11 offset:52832
    v_mfma_f32_16x16x32_bf16 v[176:179], v[84:87], a[0:3], v[64:67]
    ds_read_b64_tr_b16 v[76:77], v11 offset:50304
    v_mfma_f32_16x16x32_bf16 v[196:199], v[84:87], a[4:7], v[64:67]
    ds_read_b64_tr_b16 v[78:79], v11 offset:52864
    s_waitcnt lgkmcnt(8)
    v_mfma_f32_16x16x32_bf16 v[180:183], v[88:91], a[0:3], v[64:67]
    ds_read_b64_tr_b16 v[80:81], v11 offset:55296
    v_mfma_f32_16x16x32_bf16 v[200:203], v[88:91], a[4:7], v[64:67]
    ds_read_b64_tr_b16 v[82:83], v11 offset:57856
    v_mfma_f32_16x16x32_bf16 v[164:167], v[92:95], a[8:11], v[164:167]
    ds_read_b64_tr_b16 v[84:85], v11 offset:55328
    v_mfma_f32_16x16x32_bf16 v[184:187], v[92:95], a[12:15], v[184:187]
    ds_read_b64_tr_b16 v[86:87], v11 offset:57888
    s_waitcnt lgkmcnt(8)
    v_mfma_f32_16x16x32_bf16 v[168:171], v[96:99], a[8:11], v[168:171]
    ds_read_b64_tr_b16 v[88:89], v11 offset:55360
    v_mfma_f32_16x16x32_bf16 v[188:191], v[96:99], a[12:15], v[188:191]
    ds_read_b64_tr_b16 v[90:91], v11 offset:57920
    v_mfma_f32_16x16x32_bf16 v[172:175], v[100:103], a[8:11], v[172:175]
    ds_read_b64_tr_b16 v[92:93], v11 offset:55392
    v_mfma_f32_16x16x32_bf16 v[192:195], v[100:103], a[12:15], v[192:195]
    ds_read_b64_tr_b16 v[94:95], v11 offset:57952
    s_waitcnt lgkmcnt(8)
    v_mfma_f32_16x16x32_bf16 v[176:179], v[72:75], a[8:11], v[176:179]
    ds_read_b64_tr_b16 v[96:97], v11 offset:55424
    v_mfma_f32_16x16x32_bf16 v[196:199], v[72:75], a[12:15], v[196:199]
    ds_read_b64_tr_b16 v[98:99], v11 offset:57984
    v_mfma_f32_16x16x32_bf16 v[180:183], v[76:79], a[8:11], v[180:183]
    ds_read_b64_tr_b16 v[100:101], v11 offset:60416
    v_mfma_f32_16x16x32_bf16 v[200:203], v[76:79], a[12:15], v[200:203]
    ds_read_b64_tr_b16 v[102:103], v11 offset:62976
    s_waitcnt lgkmcnt(8)
    v_mfma_f32_16x16x32_bf16 v[164:167], v[80:83], a[16:19], v[164:167]
    s_waitcnt vmcnt(7)
    ds_read_b64_tr_b16 v[72:73], v11 offset:60448
    v_cmp_ne_u32 vcc, 0, v25
    s_mov_b32 s98, 0
    s_nop 0
    s_cmp_eq_u64 vcc, -1
    s_cbranch_scc1 L_ok_3
L_spin_4:
    buffer_load_dword v25, v24, s[16:19], 0 offen sc1
    s_add_u32 s98, s98, 1
    s_waitcnt vmcnt(0)
    v_cmp_ne_u32 vcc, 0, v25
    s_cmp_gt_u32 s98, 0x40000
    s_cbranch_scc1 L_ok_3
    s_cmp_eq_u64 vcc, -1
    s_cbranch_scc0 L_spin_4
L_ok_3:
    v_mfma_f32_16x16x32_bf16 v[184:187], v[80:83], a[20:23], v[184:187]
    ds_read_b64_tr_b16 v[74:75], v11 offset:63008
    v_mfma_f32_16x16x32_bf16 v[168:171], v[84:87], a[16:19], v[168:171]
    ds_read_b64_tr_b16 v[76:77], v11 offset:60480
    v_mfma_f32_16x16x32_bf16 v[188:191], v[84:87], a[20:23], v[188:191]
    ds_read_b64_tr_b16 v[78:79], v11 offset:63040
    s_waitcnt lgkmcnt(8)
    v_mfma_f32_16x16x32_bf16 v[172:175], v[88:91], a[16:19], v[172:175]
    ds_read_b64_tr_b16 v[80:81], v11 offset:60512
    s_add_u32 s99, s44, 0
    v_mfma_f32_16x16x32_bf16 v[192:195], v[88:91], a[20:23], v[192:195]
    ds_read_b64_tr_b16 v[82:83], v11 offset:63072
    buffer_load_dwordx4 a[160:163], v21, s[16:19], s99 offen offset:0 sc1
    v_mfma_f32_16x16x32_bf16 v[176:179], v[92:95], a[16:19], v[176:179]
    ds_read_b64_tr_b16 v[84:85], v11 offset:60544
    buffer_load_dwordx4 a[164:167], v21, s[16:19], s99 offen offset:1024 sc1
    v_mfma_f32_16x16x32_bf16 v[196:199], v[92:95], a[20:23], v[196:199]
    ds_read_b64_tr_b16 v[86:87], v11 offset:63104
    s_waitcnt lgkmcnt(8)
    v_mfma_f32_16x16x32_bf16 v[180:183], v[96:99], a[16:19], v[180:183]
    ds_read_b64_tr_b16 v[88:89], v12 offset:0
    v_mfma_f32_16x16x32_bf16 v[200:203], v[96:99], a[20:23], v[200:203]
    ds_read_b64_tr_b16 v[90:91], v12 offset:2560
    v_mfma_f32_16x16x32_bf16 v[164:167], v[100:103], a[24:27], v[164:167]
    ds_read_b64_tr_b16 v[92:93], v12 offset:32
    buffer_load_dwordx4 a[168:171], v21, s[16:19], s99 offen offset:2048 sc1
    v_mfma_f32_16x16x32_bf16 v[184:187], v[100:103], a[28:31], v[184:187]
    ds_read_b64_tr_b16 v[94:95], v12 offset:2592
    s_waitcnt lgkmcnt(8)
    v_mfma_f32_16x16x32_bf16 v[168:171], v[72:75], a[24:27], v[168:171]
    ds_read_b64_tr_b16 v[96:97], v12 offset:64
    v_mfma_f32_16x16x32_bf16 v[188:191], v[72:75], a[28:31], v[188:191]
    ds_read_b64_tr_b16 v[98:99], v12 offset:2624
    buffer_load_dwordx4 a[172:175], v21, s[16:19], s99 offen offset:3072 sc1
    v_mfma_f32_16x16x32_bf16 v[172:175], v[76:79], a[24:27], v[172:175]
    ds_read_b64_tr_b16 v[100:101], v12 offset:96
    v_mfma_f32_16x16x32_bf16 v[192:195], v[76:79], a[28:31], v[192:195]
    ds_read_b64_tr_b16 v[102:103], v12 offset:2656
    s_waitcnt lgkmcnt(8)
    v_mfma_f32_16x16x32_bf16 v[176:179], v[80:83], a[24:27], v[176:179]
    ds_read_b64_tr_b16 v[72:73], v12 offset:128
    v_mfma_f32_16x16x32_bf16 v[196:199], v[80:83], a[28:31], v[196:199]
    ds_read_b64_tr_b16 v[74:75], v12 offset:2688
    s_add_u32 s99, s44, 4096
    v_mfma_f32_16x16x32_bf16 v[180:183], v[84:87], a[24:27], v[180:183]
    ds_read_b64_tr_b16 v[76:77], v12 offset:5120
    buffer_load_dwordx4 a[176:179], v21, s[16:19], s99 offen offset:0 sc1
    v_mfma_f32_16x16x32_bf16 v[200:203], v[84:87], a[28:31], v[200:203]
    ds_read_b64_tr_b16 v[78:79], v12 offset:7680
    s_waitcnt lgkmcnt(8)
    v_mfma_f32_16x16x32_bf16 v[164:167], v[88:91], a[32:35], v[164:167]
    ds_read_b64_tr_b16 v[80:81], v12 offset:5152
    s_add_u32 s99, s44, 15360
    v_mfma_f32_16x16x32_bf16 v[184:187], v[88:91], a[36:39], v[184:187]
    ds_read_b64_tr_b16 v[82:83], v12 offset:7712
    buffer_load_dwordx4 a[180:183], v21, s[16:19], s99 offen offset:0 sc1
    v_mfma_f32_16x16x32_bf16 v[168:171], v[92:95], a[32:35], v[168:171]
    ds_read_b64_tr_b16 v[84:85], v12 offset:5184
    v_mfma_f32_16x16x32_bf16 v[188:191], v[92:95], a[36:39], v[188:191]
    ds_read_b64_tr_b16 v[86:87], v12 offset:7744
    s_waitcnt lgkmcnt(8)
    v_mfma_f32_16x16x32_bf16 v[172:175], v[96:99], a[32:35], v[172:175]
    ds_read_b64_tr_b16 v[88:89], v12 offset:5216
    buffer_load_dwordx4 a[184:187], v21, s[16:19], s99 offen offset:1024 sc1
    v_mfma_f32_16x16x32_bf16 v[192:195], v[96:99], a[36:39], v[192:195]
    ds_read_b64_tr_b16 v[90:91], v12 offset:7776
    v_mfma_f32_16x16x32_bf16 v[176:179], v[100:103], a[32:35], v[176:179]
    ds_read_b64_tr_b16 v[92:93], v12 offset:5248
    v_mfma_f32_16x16x32_bf16 v[196:199], v[100:103], a[36:39], v[196:199]
    ds_read_b64_tr_b16 v[94:95], v12 offset:7808
    s_waitcnt lgkmcnt(8)
    v_mfma_f32_16x16x32_bf16 v[180:183], v[72:75], a[32:35], v[180:183]
    ds_read_b64_tr_b16 v[96:97], v12 offset:10240
    buffer_load_dwordx4 a[188:191], v21, s[16:19], s99 offen offset:2048 sc1
    v_mfma_f32_16x16x32_bf16 v[200:203], v[72:75], a[36:39], v[200:203]
    ds_read_b64_tr_b16 v[98:99], v12 offset:12800
    v_mfma_f32_16x16x32_bf16 v[164:167], v[76:79], a[40:43], v[164:167]
    ds_read_b64_tr_b16 v[100:101], v12 offset:10272
    v_mfma_f32_16x16x32_bf16 v[184:187], v[76:79], a[44:47], v[184:187]
    ds_read_b64_tr_b16 v[102:103], v12 offset:12832
    s_waitcnt lgkmcnt(8)
    v_mfma_f32_16x16x32_bf16 v[168:171], v[80:83], a[40:43], v[168:171]
    ds_read_b64_tr_b16 v[72:73], v12 offset:10304
    buffer_load_dwordx4 a[192:195], v21, s[16:19], s99 offen offset:3072 sc1
    v_mfma_f32_16x16x32_bf16 v[188:191], v[80:83], a[44:47], v[188:191]
    ds_read_b64_tr_b16 v[74:75], v12 offset:12864
    v_mfma_f32_16x16x32_bf16 v[172:175], v[84:87], a[40:43], v[172:175]
    ds_read_b64_tr_b16 v[76:77], v12 offset:10336
    s_add_u32 s99, s44, 19456
    v_mfma_f32_16x16x32_bf16 v[192:195], v[84:87], a[44:47], v[192:195]
    ds_read_b64_tr_b16 v[78:79], v12 offset:12896
    s_waitcnt lgkmcnt(8)
    v_mfma_f32_16x16x32_bf16 v[176:179], v[88:91], a[40:43], v[176:179]
    ds_read_b64_tr_b16 v[80:81], v12 offset:10368
    buffer_load_dwordx4 a[196:199], v21, s[16:19], s99 offen offset:0 sc1
    v_mfma_f32_16x16x32_bf16 v[196:199], v[88:91], a[44:47], v[196:199]
    ds_read_b64_tr_b16 v[82:83], v12 offset:12928
    s_add_u32 s99, s44, 30720
    v_mfma_f32_16x16x32_bf16 v[180:183], v[92:95], a[40:43], v[180:183]
    ds_read_b64_tr_b16 v[84:85], v12 offset:15360
    buffer_load_dwordx4 a[200:203], v21, s[16:19], s99 offen offset:0 sc1
    v_mfma_f32_16x16x32_bf16 v[200:203], v[92:95], a[44:47], v[200:203]
    ds_read_b64_tr_b16 v[86:87], v12 offset:17920
    s_waitcnt lgkmcnt(8)
    v_mfma_f32_16x16x32_bf16 v[164:167], v[96:99], a[48:51], v[164:167]
    ds_read_b64_tr_b16 v[88:89], v12 offset:15392
    v_mfma_f32_16x16x32_bf16 v[184:187], v[96:99], a[52:55], v[184:187]
    ds_read_b64_tr_b16 v[90:91], v12 offset:17952
    buffer_load_dwordx4 a[204:207], v21, s[16:19], s99 offen offset:1024 sc1
    v_mfma_f32_16x16x32_bf16 v[168:171], v[100:103], a[48:51], v[168:171]
    ds_read_b64_tr_b16 v[92:93], v12 offset:15424
    v_mfma_f32_16x16x32_bf16 v[188:191], v[100:103], a[52:55], v[188:191]
    ds_read_b64_tr_b16 v[94:95], v12 offset:17984
    s_waitcnt lgkmcnt(8)
    v_mfma_f32_16x16x32_bf16 v[172:175], v[72:75], a[48:51], v[172:175]
    ds_read_b64_tr_b16 v[96:97], v12 offset:15456
    buffer_load_dwordx4 a[208:211], v21, s[16:19], s99 offen offset:2048 sc1
    v_mfma_f32_16x16x32_bf16 v[192:195], v[72:75], a[52:55], v[192:195]
    ds_read_b64_tr_b16 v[98:99], v12 offset:18016
    v_mfma_f32_16x16x32_bf16 v[176:179], v[76:79], a[48:51], v[176:179]
    ds_read_b64_tr_b16 v[100:101], v12 offset:15488
    v_mfma_f32_16x16x32_bf16 v[196:199], v[76:79], a[52:55], v[196:199]
    ds_read_b64_tr_b16 v[102:103], v12 offset:18048
    s_waitcnt lgkmcnt(8)
    v_mfma_f32_16x16x32_bf16 v[180:183], v[80:83], a[48:51], v[180:183]
    ds_read_b64_tr_b16 v[72:73], v12 offset:20480
    buffer_load_dwordx4 a[212:215], v21, s[16:19], s99 offen offset:3072 sc1
    v_mfma_f32_16x16x32_bf16 v[200:203], v[80:83], a[52:55], v[200:203]
    ds_read_b64_tr_b16 v[74:75], v12 offset:23040
    v_mfma_f32_16x16x32_bf16 v[164:167], v[84:87], a[56:59], v[164:167]
    ds_read_b64_tr_b16 v[76:77], v12 offset:20512
    v_mfma_f32_16x16x32_bf16 v[184:187], v[84:87], a[60:63], v[184:187]
    ds_read_b64_tr_b16 v[78:79], v12 offset:23072
    s_waitcnt lgkmcnt(8)
    v_mfma_f32_16x16x32_bf16 v[168:171], v[88:91], a[56:59], v[168:171]
    ds_read_b64_tr_b16 v[80:81], v12 offset:20544
    s_add_u32 s99, s44, 34816
    v_mfma_f32_16x16x32_bf16 v[188:191], v[88:91], a[60:63], v[188:191]
    ds_read_b64_tr_b16 v[82:83], v12 offset:23104
    buffer_load_dwordx4 a[216:219], v21, s[16:19], s99 offen offset:0 sc1
    v_mfma_f32_16x16x32_bf16 v[172:175], v[92:95], a[56:59], v[172:175]
    ds_read_b64_tr_b16 v[84:85], v12 offset:20576
    v_mfma_f32_16x16x32_bf16 v[192:195], v[92:95], a[60:63], v[192:195]
    ds_read_b64_tr_b16 v[86:87], v12 offset:23136
    s_waitcnt lgkmcnt(8)
    v_mfma_f32_16x16x32_bf16 v[176:179], v[96:99], a[56:59], v[176:179]
    ds_read_b64_tr_b16 v[88:89], v12 offset:20608
    s_add_u32 s99, s44, 46080
    v_mfma_f32_16x16x32_bf16 v[196:199], v[96:99], a[60:63], v[196:199]
    ds_read_b64_tr_b16 v[90:91], v12 offset:23168
    buffer_load_dwordx4 a[220:223], v21, s[16:19], s99 offen offset:0 sc1
    v_mfma_f32_16x16x32_bf16 v[180:183], v[100:103], a[56:59], v[180:183]
    ds_read_b64_tr_b16 v[92:93], v12 offset:25600
    buffer_load_dwordx4 a[224:227], v21, s[16:19], s99 offen offset:1024 sc1
    v_mfma_f32_16x16x32_bf16 v[200:203], v[100:103], a[60:63], v[200:203]
    ds_read_b64_tr_b16 v[94:95], v12 offset:28160
    s_waitcnt lgkmcnt(8)
    v_mfma_f32_16x16x32_bf16 v[164:167], v[72:75], a[64:67], v[164:167]
    ds_read_b64_tr_b16 v[96:97], v12 offset:25632
    v_mfma_f32_16x16x32_bf16 v[184:187], v[72:75], a[68:71], v[184:187]
    ds_read_b64_tr_b16 v[98:99], v12 offset:28192
    v_mfma_f32_16x16x32_bf16 v[168:171], v[76:79], a[64:67], v[168:171]
    ds_read_b64_tr_b16 v[100:101], v12 offset:25664
    buffer_load_dwordx4 a[228:231], v21, s[16:19], s99 offen offset:2048 sc1
    v_mfma_f32_16x16x32_bf16 v[188:191], v[76:79], a[68:71], v[188:191]
    ds_read_b64_tr_b16 v[102:103], v12 offset:28224
    s_waitcnt lgkmcnt(8)
    v_mfma_f32_16x16x32_bf16 v[172:175], v[80:83], a[64:67], v[172:175]
    ds_read_b64_tr_b16 v[72:73], v12 offset:25696
    v_mfma_f32_16x16x32_bf16 v[192:195], v[80:83], a[68:71], v[192:195]
    ds_read_b64_tr_b16 v[74:75], v12 offset:28256
    buffer_load_dwordx4 a[232:235], v21, s[16:19], s99 offen offset:3072 sc1
    v_mfma_f32_16x16x32_bf16 v[176:179], v[84:87], a[64:67], v[176:179]
    ds_read_b64_tr_b16 v[76:77], v12 offset:25728
    v_mfma_f32_16x16x32_bf16 v[196:199], v[84:87], a[68:71], v[196:199]
    ds_read_b64_tr_b16 v[78:79], v12 offset:28288
    s_waitcnt lgkmcnt(8)
    v_mfma_f32_16x16x32_bf16 v[180:183], v[88:91], a[64:67], v[180:183]
    ds_read_b64_tr_b16 v[80:81], v10 offset:16384
    v_mfma_f32_16x16x32_bf16 v[200:203], v[88:91], a[68:71], v[200:203]
    ds_read_b64_tr_b16 v[82:83], v10 offset:18944
    s_add_u32 s99, s44, 50176
    v_mfma_f32_16x16x32_bf16 v[164:167], v[92:95], a[72:75], v[164:167]
    ds_read_b64_tr_b16 v[84:85], v10 offset:16416
    buffer_load_dwordx4 a[236:239], v21, s[16:19], s99 offen offset:0 sc1
    v_mfma_f32_16x16x32_bf16 v[184:187], v[92:95], a[76:79], v[184:187]
    ds_read_b64_tr_b16 v[86:87], v10 offset:18976
    s_waitcnt lgkmcnt(8)
    v_mfma_f32_16x16x32_bf16 v[168:171], v[96:99], a[72:75], v[168:171]
    ds_read_b64_tr_b16 v[88:89], v10 offset:16448
    s_add_u32 s99, s44, 5120
    v_mfma_f32_16x16x32_bf16 v[188:191], v[96:99], a[76:79], v[188:191]
    ds_read_b64_tr_b16 v[90:91], v10 offset:19008
    buffer_load_dwordx4 a[240:243], v21, s[16:19], s99 offen offset:0 sc1
    v_mfma_f32_16x16x32_bf16 v[172:175], v[100:103], a[72:75], v[172:175]
    ds_read_b64_tr_b16 v[92:93], v10 offset:16480
    v_mfma_f32_16x16x32_bf16 v[192:195], v[100:103], a[76:79], v[192:195]
    ds_read_b64_tr_b16 v[94:95], v10 offset:19040
    s_waitcnt lgkmcnt(8)
    v_mfma_f32_16x16x32_bf16 v[176:179], v[72:75], a[72:75], v[176:179]
    ds_read_b64_tr_b16 v[96:97], v10 offset:16512
    buffer_load_dwordx4 a[244:247], v21, s[16:19], s99 offen offset:1024 sc1
    v_mfma_f32_16x16x32_bf16 v[196:199], v[72:75], a[76:79], v[196:199]
    ds_read_b64_tr_b16 v[98:99], v10 offset:19072
    v_mfma_f32_16x16x32_bf16 v[180:183], v[76:79], a[72:75], v[180:183]
    ds_read_b64_tr_b16 v[100:101], v10 offset:21504
    v_mfma_f32_16x16x32_bf16 v[200:203], v[76:79], a[76:79], v[200:203]
    ds_read_b64_tr_b16 v[102:103], v10 offset:24064
    s_waitcnt lgkmcnt(8)
    v_mfma_f32_16x16x32_bf16 v[164:167], v[80:83], a[80:83], v[164:167]
    ds_read_b64_tr_b16 v[72:73], v10 offset:21536
    buffer_load_dwordx4 a[248:251], v21, s[16:19], s99 offen offset:2048 sc1
    v_mfma_f32_16x16x32_bf16 v[184:187], v[80:83], a[84:87], v[184:187]
    ds_read_b64_tr_b16 v[74:75], v10 offset:24096
    v_mfma_f32_16x16x32_bf16 v[168:171], v[84:87], a[80:83], v[168:171]
    ds_read_b64_tr_b16 v[76:77], v10 offset:21568
    buffer_load_dwordx4 a[252:255], v21, s[16:19], s99 offen offset:3072 sc1
    v_mfma_f32_16x16x32_bf16 v[188:191], v[84:87], a[84:87], v[188:191]
    ds_read_b64_tr_b16 v[78:79], v10 offset:24128
    s_waitcnt lgkmcnt(8)
    v_mfma_f32_16x16x32_bf16 v[172:175], v[88:91], a[80:83], v[172:175]
    ds_read_b64_tr_b16 v[80:81], v10 offset:21600
    v_mfma_f32_16x16x32_bf16 v[192:195], v[88:91], a[84:87], v[192:195]
    ds_read_b64_tr_b16 v[82:83], v10 offset:24160
    v_mfma_f32_16x16x32_bf16 v[176:179], v[92:95], a[80:83], v[176:179]
    ds_read_b64_tr_b16 v[84:85], v10 offset:21632
    s_add_u32 s99, s44, 9216
    v_mfma_f32_16x16x32_bf16 v[196:199], v[92:95], a[84:87], v[196:199]
    ds_read_b64_tr_b16 v[86:87], v10 offset:24192
    s_waitcnt lgkmcnt(8)
    v_mfma_f32_16x16x32_bf16 v[180:183], v[96:99], a[80:83], v[180:183]
    ds_read_b64_tr_b16 v[88:89], v11 offset:4096
    buffer_load_dwordx4 v[204:207], v21, s[16:19], s99 offen offset:0 sc1
    v_mfma_f32_16x16x32_bf16 v[200:203], v[96:99], a[84:87], v[200:203]
    ds_read_b64_tr_b16 v[90:91], v11 offset:6656
    s_add_u32 s99, s44, 20480
    v_mfma_f32_16x16x32_bf16 v[164:167], v[100:103], a[88:91], v[164:167]
    ds_read_b64_tr_b16 v[92:93], v11 offset:4128
    buffer_load_dwordx4 v[208:211], v21, s[16:19], s99 offen offset:0 sc1
    v_mfma_f32_16x16x32_bf16 v[184:187], v[100:103], a[92:95], v[184:187]
    ds_read_b64_tr_b16 v[94:95], v11 offset:6688
    s_waitcnt lgkmcnt(8)
    v_mfma_f32_16x16x32_bf16 v[168:171], v[72:75], a[88:91], v[168:171]
    ds_read_b64_tr_b16 v[96:97], v11 offset:4160
    v_mfma_f32_16x16x32_bf16 v[188:191], v[72:75], a[92:95], v[188:191]
    ds_read_b64_tr_b16 v[98:99], v11 offset:6720
    buffer_load_dwordx4 v[212:215], v21, s[16:19], s99 offen offset:1024 sc1
    v_mfma_f32_16x16x32_bf16 v[172:175], v[76:79], a[88:91], v[172:175]
    ds_read_b64_tr_b16 v[100:101], v11 offset:4192
    v_mfma_f32_16x16x32_bf16 v[192:195], v[76:79], a[92:95], v[192:195]
    ds_read_b64_tr_b16 v[102:103], v11 offset:6752
    s_waitcnt lgkmcnt(8)
    v_mfma_f32_16x16x32_bf16 v[176:179], v[80:83], a[88:91], v[176:179]
    ds_read_b64_tr_b16 v[72:73], v11 offset:4224
    buffer_load_dwordx4 v[216:219], v21, s[16:19], s99 offen offset:2048 sc1
    v_mfma_f32_16x16x32_bf16 v[196:199], v[80:83], a[92:95], v[196:199]
    ds_read_b64_tr_b16 v[74:75], v11 offset:6784
    v_mfma_f32_16x16x32_bf16 v[180:183], v[84:87], a[88:91], v[180:183]
    ds_read_b64_tr_b16 v[76:77], v11 offset:9216
    v_mfma_f32_16x16x32_bf16 v[200:203], v[84:87], a[92:95], v[200:203]
    ds_read_b64_tr_b16 v[78:79], v11 offset:11776
    s_waitcnt lgkmcnt(8)
    v_mfma_f32_16x16x32_bf16 v[164:167], v[88:91], a[96:99], v[164:167]
    ds_read_b64_tr_b16 v[80:81], v11 offset:9248
    buffer_load_dwordx4 v[220:223], v21, s[16:19], s99 offen offset:3072 sc1
    v_mfma_f32_16x16x32_bf16 v[184:187], v[88:91], a[100:103], v[184:187]
    ds_read_b64_tr_b16 v[82:83], v11 offset:11808
    v_mfma_f32_16x16x32_bf16 v[168:171], v[92:95], a[96:99], v[168:171]
    ds_read_b64_tr_b16 v[84:85], v11 offset:9280
    v_mfma_f32_16x16x32_bf16 v[188:191], v[92:95], a[100:103], v[188:191]
    ds_read_b64_tr_b16 v[86:87], v11 offset:11840
    s_waitcnt lgkmcnt(8)
    v_mfma_f32_16x16x32_bf16 v[172:175], v[96:99], a[96:99], v[172:175]
    ds_read_b64_tr_b16 v[88:89], v11 offset:9312
    s_add_u32 s99, s44, 24576
    v_mfma_f32_16x16x32_bf16 v[192:195], v[96:99], a[100:103], v[192:195]
    ds_read_b64_tr_b16 v[90:91], v11 offset:11872
    buffer_load_dwordx4 v[224:227], v21, s[16:19], s99 offen offset:0 sc1
    v_mfma_f32_16x16x32_bf16 v[176:179], v[100:103], a[96:99], v[176:179]
    ds_read_b64_tr_b16 v[92:93], v11 offset:9344
    s_add_u32 s99, s44, 35840
    v_mfma_f32_16x16x32_bf16 v[196:199], v[100:103], a[100:103], v[196:199]
    buffer_load_dwordx4 v[228:231], v21, s[16:19], s99 offen offset:0 sc1
    s_waitcnt vmcnt(31)
    ds_read_b64_tr_b16 v[94:95], v11 offset:11904
    s_barrier
    s_cmp_lg_u32 s3, 0
    s_cbranch_scc1 L_nf_5
    s_lshl_b32 s7, s5, 4
    s_add_u32 s7, s7, s4
    s_lshl_b32 s7, s7, 7
    s_add_u32 s7, s7, 32768
    s_mov_b64 exec, 1
    buffer_store_dword v22, v23, s[16:19], s7 offen sc1
    s_mov_b64 exec, -1
L_nf_5:
    s_waitcnt lgkmcnt(8)
    v_mfma_f32_16x16x32_bf16 v[180:183], v[72:75], a[96:99], v[180:183]
    ds_read_b64_tr_b16 v[96:97], v11 offset:14336
    v_mfma_f32_16x16x32_bf16 v[200:203], v[72:75], a[100:103], v[200:203]
    ds_read_b64_tr_b16 v[98:99], v11 offset:16896
    v_mfma_f32_16x16x32_bf16 v[164:167], v[76:79], a[104:107], v[164:167]
    ds_read_b64_tr_b16 v[100:101], v11 offset:14368
    buffer_load_dwordx4 v[232:235], v21, s[16:19], s99 offen offset:1024 sc1
    v_mfma_f32_16x16x32_bf16 v[184:187], v[76:79], a[108:111], v[184:187]
    ds_read_b64_tr_b16 v[102:103], v11 offset:16928
    s_waitcnt lgkmcnt(8)
    v_mfma_f32_16x16x32_bf16 v[168:171], v[80:83], a[104:107], v[168:171]
    ds_read_b64_tr_b16 v[72:73], v11 offset:14400
    v_mfma_f32_16x16x32_bf16 v[188:191], v[80:83], a[108:111], v[188:191]
    ds_read_b64_tr_b16 v[74:75], v11 offset:16960
    buffer_load_dwordx4 v[236:239], v21, s[16:19], s99 offen offset:2048 sc1
    v_mfma_f32_16x16x32_bf16 v[172:175], v[84:87], a[104:107], v[172:175]
    ds_read_b64_tr_b16 v[76:77], v11 offset:14432
    v_mfma_f32_16x16x32_bf16 v[192:195], v[84:87], a[108:111], v[192:195]
    ds_read_b64_tr_b16 v[78:79], v11 offset:16992
    s_waitcnt lgkmcnt(8)
    v_mfma_f32_16x16x32_bf16 v[176:179], v[88:91], a[104:107], v[176:179]
    ds_read_b64_tr_b16 v[80:81], v11 offset:14464
    v_mfma_f32_16x16x32_bf16 v[196:199], v[88:91], a[108:111], v[196:199]
    ds_read_b64_tr_b16 v[82:83], v11 offset:17024
    buffer_load_dwordx4 v[240:243], v21, s[16:19], s99 offen offset:3072 sc1
    v_mfma_f32_16x16x32_bf16 v[180:183], v[92:95], a[104:107], v[180:183]
    ds_read_b64_tr_b16 v[84:85], v11 offset:19456
    v_mfma_f32_16x16x32_bf16 v[200:203], v[92:95], a[108:111], v[200:203]
    ds_read_b64_tr_b16 v[86:87], v11 offset:22016
    s_waitcnt lgkmcnt(8)
    v_mfma_f32_16x16x32_bf16 v[164:167], v[96:99], a[112:115], v[164:167]
    ds_read_b64_tr_b16 v[88:89], v11 offset:19488
    s_add_u32 s99, s44, 39936
    v_mfma_f32_16x16x32_bf16 v[184:187], v[96:99], a[116:119], v[184:187]
    ds_read_b64_tr_b16 v[90:91], v11 offset:22048
    buffer_load_dwordx4 v[244:247], v21, s[16:19], s99 offen offset:0 sc1
    v_mfma_f32_16x16x32_bf16 v[168:171], v[100:103], a[112:115], v[168:171]
    ds_read_b64_tr_b16 v[92:93], v11 offset:19520
    v_mfma_f32_16x16x32_bf16 v[188:191], v[100:103], a[116:119], v[188:191]
    ds_read_b64_tr_b16 v[94:95], v11 offset:22080
    s_waitcnt lgkmcnt(8)
    v_mfma_f32_16x16x32_bf16 v[172:175], v[72:75], a[112:115], v[172:175]
    ds_read_b64_tr_b16 v[96:97], v11 offset:19552
    s_add_u32 s99, s44, 51200
    v_mfma_f32_16x16x32_bf16 v[192:195], v[72:75], a[116:119], v[192:195]
    ds_read_b64_tr_b16 v[98:99], v11 offset:22112
    buffer_load_dwordx4 v[248:251], v21, s[16:19], s99 offen offset:0 sc1
    v_mfma_f32_16x16x32_bf16 v[176:179], v[76:79], a[112:115], v[176:179]
    ds_read_b64_tr_b16 v[100:101], v11 offset:19584
    v_mfma_f32_16x16x32_bf16 v[196:199], v[76:79], a[116:119], v[196:199]
    ds_read_b64_tr_b16 v[102:103], v11 offset:22144
    s_waitcnt lgkmcnt(8)
    v_mfma_f32_16x16x32_bf16 v[180:183], v[80:83], a[112:115], v[180:183]
    ds_read_b64_tr_b16 v[72:73], v11 offset:24576
    buffer_load_dwordx4 v[252:255], v21, s[16:19], s99 offen offset:1024 sc1
    v_mfma_f32_16x16x32_bf16 v[200:203], v[80:83], a[116:119], v[200:203]
    ds_read_b64_tr_b16 v[74:75], v11 offset:27136
    v_mfma_f32_16x16x32_bf16 v[164:167], v[84:87], a[120:123], v[164:167]
    ds_read_b64_tr_b16 v[76:77], v11 offset:24608
    v_mfma_f32_16x16x32_bf16 v[184:187], v[84:87], a[124:127], v[184:187]
    ds_read_b64_tr_b16 v[78:79], v11 offset:27168
    s_waitcnt lgkmcnt(8)
    v_mfma_f32_16x16x32_bf16 v[168:171], v[88:91], a[120:123], v[168:171]
    ds_read_b64_tr_b16 v[80:81], v11 offset:24640
    buffer_load_dwordx4 v[112:115], v21, s[16:19], s99 offen offset:2048 sc1
    v_mfma_f32_16x16x32_bf16 v[188:191], v[88:91], a[124:127], v[188:191]
    ds_read_b64_tr_b16 v[82:83], v11 offset:27200
    v_mfma_f32_16x16x32_bf16 v[172:175], v[92:95], a[120:123], v[172:175]
    ds_read_b64_tr_b16 v[84:85], v11 offset:24672
    buffer_load_dwordx4 v[116:119], v21, s[16:19], s99 offen offset:3072 sc1
    v_mfma_f32_16x16x32_bf16 v[192:195], v[92:95], a[124:127], v[192:195]
    ds_read_b64_tr_b16 v[86:87], v11 offset:27232
    s_waitcnt lgkmcnt(8)
    v_mfma_f32_16x16x32_bf16 v[176:179], v[96:99], a[120:123], v[176:179]
    ds_read_b64_tr_b16 v[88:89], v11 offset:24704
    v_mfma_f32_16x16x32_bf16 v[196:199], v[96:99], a[124:127], v[196:199]
    ds_read_b64_tr_b16 v[90:91], v11 offset:27264
    v_mfma_f32_16x16x32_bf16 v[180:183], v[100:103], a[120:123], v[180:183]
    ds_read_b64_tr_b16 v[92:93], v11 offset:29696
    s_add_u32 s99, s44, 55296
    v_mfma_f32_16x16x32_bf16 v[200:203], v[100:103], a[124:127], v[200:203]
    ds_read_b64_tr_b16 v[94:95], v11 offset:32256
    s_waitcnt lgkmcnt(8)
    v_mfma_f32_16x16x32_bf16 v[164:167], v[72:75], a[128:131], v[164:167]
    ds_read_b64_tr_b16 v[96:97], v11 offset:29728
    buffer_load_dwordx4 v[120:123], v21, s[16:19], s99 offen offset:0 sc1
    v_mfma_f32_16x16x32_bf16 v[184:187], v[72:75], a[132:135], v[184:187]
    ds_read_b64_tr_b16 v[98:99], v11 offset:32288
    s_add_u32 s99, s44, 10240
    v_mfma_f32_16x16x32_bf16 v[168:171], v[76:79], a[128:131], v[168:171]
    ds_read_b64_tr_b16 v[100:101], v11 offset:29760
    buffer_load_dwordx4 v[124:127], v21, s[16:19], s99 offen offset:0 sc1
    v_mfma_f32_16x16x32_bf16 v[188:191], v[76:79], a[132:135], v[188:191]
    ds_read_b64_tr_b16 v[102:103], v11 offset:32320
    s_waitcnt lgkmcnt(8)
    v_mfma_f32_16x16x32_bf16 v[172:175], v[80:83], a[128:131], v[172:175]
    ds_read_b64_tr_b16 v[72:73], v11 offset:29792
    buffer_load_dwordx4 v[128:131], v21, s[16:19], s99 offen offset:1024 sc1
    v_mfma_f32_16x16x32_bf16 v[192:195], v[80:83], a[132:135], v[192:195]
    ds_read_b64_tr_b16 v[74:75], v11 offset:32352
    v_mfma_f32_16x16x32_bf16 v[176:179], v[84:87], a[128:131], v[176:179]
    ds_read_b64_tr_b16 v[76:77], v11 offset:29824
    v_mfma_f32_16x16x32_bf16 v[196:199], v[84:87], a[132:135], v[196:199]
    ds_read_b64_tr_b16 v[78:79], v11 offset:32384
    s_waitcnt lgkmcnt(8)
    v_mfma_f32_16x16x32_bf16 v[180:183], v[88:91], a[128:131], v[180:183]
    ds_read_b64_tr_b16 v[80:81], v11 offset:34816
    buffer_load_dwordx4 v[132:135], v21, s[16:19], s99 offen offset:2048 sc1
    v_mfma_f32_16x16x32_bf16 v[200:203], v[88:91], a[132:135], v[200:203]
    ds_read_b64_tr_b16 v[82:83], v11 offset:37376
    v_mfma_f32_16x16x32_bf16 v[164:167], v[92:95], a[136:139], v[164:167]
    ds_read_b64_tr_b16 v[84:85], v11 offset:34848
    v_mfma_f32_16x16x32_bf16 v[184:187], v[92:95], a[140:143], v[184:187]
    ds_read_b64_tr_b16 v[86:87], v11 offset:37408
    s_waitcnt lgkmcnt(8)
    v_mfma_f32_16x16x32_bf16 v[168:171], v[96:99], a[136:139], v[168:171]
    ds_read_b64_tr_b16 v[88:89], v11 offset:34880
    buffer_load_dwordx4 v[136:139], v21, s[16:19], s99 offen offset:3072 sc1
    v_mfma_f32_16x16x32_bf16 v[188:191], v[96:99], a[140:143], v[188:191]
    ds_read_b64_tr_b16 v[90:91], v11 offset:37440
    v_mfma_f32_16x16x32_bf16 v[172:175], v[100:103], a[136:139], v[172:175]
    ds_read_b64_tr_b16 v[92:93], v11 offset:34912
    v_mfma_f32_16x16x32_bf16 v[192:195], v[100:103], a[140:143], v[192:195]
    ds_read_b64_tr_b16 v[94:95], v11 offset:37472
    s_waitcnt lgkmcnt(8)
    v_mfma_f32_16x16x32_bf16 v[176:179], v[72:75], a[136:139], v[176:179]
    ds_read_b64_tr_b16 v[96:97], v11 offset:34944
    s_add_u32 s99, s44, 14336
    v_mfma_f32_16x16x32_bf16 v[196:199], v[72:75], a[140:143], v[196:199]
    ds_read_b64_tr_b16 v[98:99], v11 offset:37504
    buffer_load_dwordx4 v[140:143], v21, s[16:19], s99 offen offset:0 sc1
    v_mfma_f32_16x16x32_bf16 v[180:183], v[76:79], a[136:139], v[180:183]
    ds_read_b64_tr_b16 v[100:101], v11 offset:39936
    s_add_u32 s99, s44, 25600
    v_mfma_f32_16x16x32_bf16 v[200:203], v[76:79], a[140:143], v[200:203]
    ds_read_b64_tr_b16 v[102:103], v11 offset:42496
    s_waitcnt lgkmcnt(8)
    v_mfma_f32_16x16x32_bf16 v[164:167], v[80:83], a[144:147], v[164:167]
    ds_read_b64_tr_b16 v[72:73], v11 offset:39968
    buffer_load_dwordx4 v[144:147], v21, s[16:19], s99 offen offset:0 sc1
    v_mfma_f32_16x16x32_bf16 v[184:187], v[80:83], a[148:151], v[184:187]
    ds_read_b64_tr_b16 v[74:75], v11 offset:42528
    v_mfma_f32_16x16x32_bf16 v[168:171], v[84:87], a[144:147], v[168:171]
    ds_read_b64_tr_b16 v[76:77], v11 offset:40000
    buffer_load_dwordx4 v[148:151], v21, s[16:19], s99 offen offset:1024 sc1
    v_mfma_f32_16x16x32_bf16 v[188:191], v[84:87], a[148:151], v[188:191]
    ds_read_b64_tr_b16 v[78:79], v11 offset:42560
    s_waitcnt lgkmcnt(8)
    v_mfma_f32_16x16x32_bf16 v[172:175], v[88:91], a[144:147], v[172:175]
    ds_read_b64_tr_b16 v[80:81], v11 offset:40032
    v_mfma_f32_16x16x32_bf16 v[192:195], v[88:91], a[148:151], v[192:195]
    ds_read_b64_tr_b16 v[82:83], v11 offset:42592
    buffer_load_dwordx4 v[152:155], v21, s[16:19], s99 offen offset:2048 sc1
    v_mfma_f32_16x16x32_bf16 v[176:179], v[92:95], a[144:147], v[176:179]
    ds_read_b64_tr_b16 v[84:85], v11 offset:40064
    v_mfma_f32_16x16x32_bf16 v[196:199], v[92:95], a[148:151], v[196:199]
    ds_read_b64_tr_b16 v[86:87], v11 offset:42624
    s_waitcnt lgkmcnt(8)
    v_mfma_f32_16x16x32_bf16 v[180:183], v[96:99], a[144:147], v[180:183]
    v_mfma_f32_16x16x32_bf16 v[200:203], v[96:99], a[148:151], v[200:203]
    buffer_load_dwordx4 v[156:159], v21, s[16:19], s99 offen offset:3072 sc1
    v_mfma_f32_16x16x32_bf16 v[164:167], v[100:103], a[152:155], v[164:167]
    v_mfma_f32_16x16x32_bf16 v[184:187], v[100:103], a[156:159], v[184:187]
    s_waitcnt lgkmcnt(4)
    v_mfma_f32_16x16x32_bf16 v[168:171], v[72:75], a[152:155], v[168:171]
    s_add_u32 s99, s44, 29696
    buffer_load_dwordx4 v[160:163], v21, s[16:19], s99 offen offset:0 sc1
    v_mfma_f32_16x16x32_bf16 v[188:191], v[72:75], a[156:159], v[188:191]
    v_mfma_f32_16x16x32_bf16 v[172:175], v[76:79], a[152:155], v[172:175]
    v_mfma_f32_16x16x32_bf16 v[192:195], v[76:79], a[156:159], v[192:195]
    s_waitcnt lgkmcnt(0)
    v_mfma_f32_16x16x32_bf16 v[176:179], v[80:83], a[152:155], v[176:179]
    v_mfma_f32_16x16x32_bf16 v[196:199], v[80:83], a[156:159], v[196:199]
    v_mfma_f32_16x16x32_bf16 v[180:183], v[84:87], a[152:155], v[180:183]
    v_mfma_f32_16x16x32_bf16 v[200:203], v[84:87], a[156:159], v[200:203]
    s_lshl_b32 s7, s5, 11
    s_add_u32 s7, s7, 32768
    v_and_b32 v24, 15, v20
    v_lshl_add_u32 v24, v24, 7, s7
    v_pk_mul_f32 v[32:33], v[164:165], v[28:29]
    v_pk_mul_f32 v[34:35], v[166:167], v[28:29]
    v_pk_mul_f32 v[36:37], v[168:169], v[28:29]
    v_pk_mul_f32 v[38:39], v[170:171], v[28:29]
    v_exp_f32 v32, v32 clamp
    v_max_f32 v164, v64, v164
    v_exp_f32 v33, v33 clamp
    v_max_f32 v165, v64, v165
    v_exp_f32 v34, v34 clamp
    v_max_f32 v166, v64, v166
    v_exp_f32 v35, v35 clamp
    v_max_f32 v167, v64, v167
    v_exp_f32 v36, v36 clamp
    v_max_f32 v168, v64, v168
    v_exp_f32 v37, v37 clamp
    v_max_f32 v169, v64, v169
    v_exp_f32 v38, v38 clamp
    v_max_f32 v170, v64, v170
    v_exp_f32 v39, v39 clamp
    v_max_f32 v171, v64, v171
    v_pk_add_f32 v[32:33], v[32:33], v[164:165]
    v_pk_add_f32 v[34:35], v[34:35], v[166:167]
    v_pk_add_f32 v[36:37], v[36:37], v[168:169]
    v_pk_add_f32 v[38:39], v[38:39], v[170:171]
    v_cvt_pk_bf16_f32 v40, v32, v33
    v_cvt_pk_bf16_f32 v41, v34, v35
    v_cvt_pk_bf16_f32 v42, v36, v37
    v_cvt_pk_bf16_f32 v43, v38, v39
    v_pk_mul_f32 v[32:33], v[172:173], v[28:29]
    v_pk_mul_f32 v[34:35], v[174:175], v[28:29]
    v_pk_mul_f32 v[36:37], v[176:177], v[28:29]
    v_pk_mul_f32 v[38:39], v[178:179], v[28:29]
    v_exp_f32 v32, v32 clamp
    v_max_f32 v172, v64, v172
    v_exp_f32 v33, v33 clamp
    v_max_f32 v173, v64, v173
    v_exp_f32 v34, v34 clamp
    v_max_f32 v174, v64, v174
    v_exp_f32 v35, v35 clamp
    v_max_f32 v175, v64, v175
    v_exp_f32 v36, v36 clamp
    v_max_f32 v176, v64, v176
    v_exp_f32 v37, v37 clamp
    v_max_f32 v177, v64, v177
    v_exp_f32 v38, v38 clamp
    v_max_f32 v178, v64, v178
    v_exp_f32 v39, v39 clamp
    v_max_f32 v179, v64, v179
    v_pk_add_f32 v[32:33], v[32:33], v[172:173]
    v_pk_add_f32 v[34:35], v[34:35], v[174:175]
    v_pk_add_f32 v[36:37], v[36:37], v[176:177]
    v_pk_add_f32 v[38:39], v[38:39], v[178:179]
    v_cvt_pk_bf16_f32 v44, v32, v33
    v_cvt_pk_bf16_f32 v45, v34, v35
    v_cvt_pk_bf16_f32 v46, v36, v37
    v_cvt_pk_bf16_f32 v47, v38, v39
    v_pk_mul_f32 v[32:33], v[180:181], v[28:29]
    v_pk_mul_f32 v[34:35], v[182:183], v[28:29]
    v_pk_mul_f32 v[36:37], v[184:185], v[28:29]
    v_pk_mul_f32 v[38:39], v[186:187], v[28:29]
    v_exp_f32 v32, v32 clamp
    v_max_f32 v180, v64, v180
    v_exp_f32 v33, v33 clamp
    v_max_f32 v181, v64, v181
    v_exp_f32 v34, v34 clamp
    v_max_f32 v182, v64, v182
    v_exp_f32 v35, v35 clamp
    v_max_f32 v183, v64, v183
    v_exp_f32 v36, v36 clamp
    v_max_f32 v184, v64, v184
    v_exp_f32 v37, v37 clamp
    v_max_f32 v185, v64, v185
    v_exp_f32 v38, v38 clamp
    v_max_f32 v186, v64, v186
    v_exp_f32 v39, v39 clamp
    v_max_f32 v187, v64, v187
    v_pk_add_f32 v[32:33], v[32:33], v[180:181]
    v_pk_add_f32 v[34:35], v[34:35], v[182:183]
    v_pk_add_f32 v[36:37], v[36:37], v[184:185]
    v_pk_add_f32 v[38:39], v[38:39], v[186:187]
    v_cvt_pk_bf16_f32 v48, v32, v33
    v_cvt_pk_bf16_f32 v49, v34, v35
    v_cvt_pk_bf16_f32 v50, v36, v37
    v_cvt_pk_bf16_f32 v51, v38, v39
    buffer_load_dword v25, v24, s[16:19], 0 offen sc1
    v_pk_mul_f32 v[32:33], v[188:189], v[28:29]
    v_pk_mul_f32 v[34:35], v[190:191], v[28:29]
    v_pk_mul_f32 v[36:37], v[192:193], v[28:29]
    v_pk_mul_f32 v[38:39], v[194:195], v[28:29]
    v_exp_f32 v32, v32 clamp
    v_max_f32 v188, v64, v188
    v_exp_f32 v33, v33 clamp
    v_max_f32 v189, v64, v189
    v_exp_f32 v34, v34 clamp
    v_max_f32 v190, v64, v190
    v_exp_f32 v35, v35 clamp
    v_max_f32 v191, v64, v191
    v_exp_f32 v36, v36 clamp
    v_max_f32 v192, v64, v192
    v_exp_f32 v37, v37 clamp
    v_max_f32 v193, v64, v193
    v_exp_f32 v38, v38 clamp
    v_max_f32 v194, v64, v194
    v_exp_f32 v39, v39 clamp
    v_max_f32 v195, v64, v195
    v_pk_add_f32 v[32:33], v[32:33], v[188:189]
    v_pk_add_f32 v[34:35], v[34:35], v[190:191]
    v_pk_add_f32 v[36:37], v[36:37], v[192:193]
    v_pk_add_f32 v[38:39], v[38:39], v[194:195]
    v_cvt_pk_bf16_f32 v52, v32, v33
    v_cvt_pk_bf16_f32 v53, v34, v35
    v_cvt_pk_bf16_f32 v54, v36, v37
    v_cvt_pk_bf16_f32 v55, v38, v39
    v_pk_mul_f32 v[32:33], v[196:197], v[28:29]
    v_pk_mul_f32 v[34:35], v[198:199], v[28:29]
    v_pk_mul_f32 v[36:37], v[200:201], v[28:29]
    v_pk_mul_f32 v[38:39], v[202:203], v[28:29]
    v_exp_f32 v32, v32 clamp
    v_max_f32 v196, v64, v196
    v_exp_f32 v33, v33 clamp
    v_max_f32 v197, v64, v197
    v_exp_f32 v34, v34 clamp
    v_max_f32 v198, v64, v198
    v_exp_f32 v35, v35 clamp
    v_max_f32 v199, v64, v199
    v_exp_f32 v36, v36 clamp
    v_max_f32 v200, v64, v200
    v_exp_f32 v37, v37 clamp
    v_max_f32 v201, v64, v201
    v_exp_f32 v38, v38 clamp
    v_max_f32 v202, v64, v202
    v_exp_f32 v39, v39 clamp
    v_max_f32 v203, v64, v203
    v_pk_add_f32 v[32:33], v[32:33], v[196:197]
    v_pk_add_f32 v[34:35], v[34:35], v[198:199]
    v_pk_add_f32 v[36:37], v[36:37], v[200:201]
    v_pk_add_f32 v[38:39], v[38:39], v[202:203]
    v_cvt_pk_bf16_f32 v56, v32, v33
    v_cvt_pk_bf16_f32 v57, v34, v35
    v_cvt_pk_bf16_f32 v58, v36, v37
    v_cvt_pk_bf16_f32 v59, v38, v39
    v_lshlrev_b32 v14, 4, v0
    v_add_u32 v15, 4096, v14
    v_mov_b32 v16, 2147418112
    v_cmp_gt_u32 vcc, 144, v0
    s_lshl_b32 s38, s5, 13
    s_add_u32 s38, s38, 131072
    v_cndmask_b32 v15, v16, v15, vcc
    ds_read_b128 v[164:167], v13 offset:0
    ds_read_b128 v[168:171], v13 offset:64
    ds_read_b128 v[172:175], v13 offset:128
    ds_read_b128 v[176:179], v13 offset:192
    ds_read_b128 v[180:183], v13 offset:256
    ds_read_b128 v[184:187], v13 offset:320
    ds_read_b128 v[188:191], v13 offset:384
    ds_read_b128 v[192:195], v13 offset:448
    ds_read_b128 v[196:199], v13 offset:512
    ds_read_b128 v[200:203], v13 offset:576
    s_waitcnt vmcnt(0)
    v_cmp_ne_u32 vcc, 0, v25
    s_mov_b32 s98, 0
    s_nop 0
    s_cmp_eq_u64 vcc, -1
    s_cbranch_scc1 L_ok_6
L_spin_7:
    buffer_load_dword v25, v24, s[16:19], 0 offen sc1
    s_add_u32 s98, s98, 1
    s_waitcnt vmcnt(0)
    v_cmp_ne_u32 vcc, 0, v25
    s_cmp_gt_u32 s98, 0x40000
    s_cbranch_scc1 L_ok_6
    s_cmp_eq_u64 vcc, -1
    s_cbranch_scc0 L_spin_7
L_ok_6:
    buffer_load_dwordx4 v[72:75], v14, s[16:19], s38 offen sc1
    buffer_load_dwordx4 v[76:79], v1, s[16:19], s38 offen sc1
    buffer_load_dwordx4 v[80:83], v15, s[16:19], s38 offen sc1
    buffer_load_dwordx4 v[84:87], v2, s[16:19], s38 offen sc1
    s_waitcnt lgkmcnt(9)
    v_mfma_f32_16x16x32_bf16 v[104:107], v[164:167], a[0:3], 0
    v_mfma_f32_16x16x32_bf16 v[108:111], v[164:167], a[4:7], 0
    s_waitcnt lgkmcnt(8)
    v_mfma_f32_16x16x32_bf16 v[104:107], v[168:171], a[8:11], v[104:107]
    v_mfma_f32_16x16x32_bf16 v[108:111], v[168:171], a[12:15], v[108:111]
    ds_read_b128 v[164:167], v13 offset:640
    s_waitcnt lgkmcnt(8)
    v_mfma_f32_16x16x32_bf16 v[104:107], v[172:175], a[16:19], v[104:107]
    v_mfma_f32_16x16x32_bf16 v[108:111], v[172:175], a[20:23], v[108:111]
    ds_read_b128 v[168:171], v13 offset:704
    s_waitcnt lgkmcnt(8)
    v_mfma_f32_16x16x32_bf16 v[104:107], v[176:179], a[24:27], v[104:107]
    v_mfma_f32_16x16x32_bf16 v[108:111], v[176:179], a[28:31], v[108:111]
    ds_read_b128 v[172:175], v13 offset:768
    s_waitcnt lgkmcnt(8)
    v_mfma_f32_16x16x32_bf16 v[104:107], v[180:183], a[32:35], v[104:107]
    v_mfma_f32_16x16x32_bf16 v[108:111], v[180:183], a[36:39], v[108:111]
    ds_read_b128 v[176:179], v13 offset:832
    s_waitcnt lgkmcnt(8)
    v_mfma_f32_16x16x32_bf16 v[104:107], v[184:187], a[40:43], v[104:107]
    v_mfma_f32_16x16x32_bf16 v[108:111], v[184:187], a[44:47], v[108:111]
    ds_read_b128 v[180:183], v13 offset:896
    s_waitcnt lgkmcnt(8)
    v_mfma_f32_16x16x32_bf16 v[104:107], v[188:191], a[48:51], v[104:107]
    v_mfma_f32_16x16x32_bf16 v[108:111], v[188:191], a[52:55], v[108:111]
    ds_read_b128 v[184:187], v13 offset:960
    s_waitcnt lgkmcnt(8)
    v_mfma_f32_16x16x32_bf16 v[104:107], v[192:195], a[56:59], v[104:107]
    v_mfma_f32_16x16x32_bf16 v[108:111], v[192:195], a[60:63], v[108:111]
    ds_read_b128 v[188:191], v13 offset:1024
    s_waitcnt lgkmcnt(8)
    v_mfma_f32_16x16x32_bf16 v[104:107], v[196:199], a[64:67], v[104:107]
    v_mfma_f32_16x16x32_bf16 v[108:111], v[196:199], a[68:71], v[108:111]
    ds_read_b128 v[192:195], v13 offset:1088
    s_waitcnt lgkmcnt(8)
    v_mfma_f32_16x16x32_bf16 v[104:107], v[200:203], a[72:75], v[104:107]
    v_mfma_f32_16x16x32_bf16 v[108:111], v[200:203], a[76:79], v[108:111]
    ds_read_b128 v[196:199], v13 offset:1152
    s_waitcnt lgkmcnt(8)
    v_mfma_f32_16x16x32_bf16 v[104:107], v[164:167], a[80:83], v[104:107]
    v_mfma_f32_16x16x32_bf16 v[108:111], v[164:167], a[84:87], v[108:111]
    ds_read_b128 v[200:203], v13 offset:1216
    s_waitcnt lgkmcnt(8)
    v_mfma_f32_16x16x32_bf16 v[104:107], v[168:171], a[88:91], v[104:107]
    v_mfma_f32_16x16x32_bf16 v[108:111], v[168:171], a[92:95], v[108:111]
    s_waitcnt lgkmcnt(7)
    v_mfma_f32_16x16x32_bf16 v[104:107], v[172:175], a[96:99], v[104:107]
    v_mfma_f32_16x16x32_bf16 v[108:111], v[172:175], a[100:103], v[108:111]
    s_waitcnt lgkmcnt(6)
    v_mfma_f32_16x16x32_bf16 v[104:107], v[176:179], a[104:107], v[104:107]
    v_mfma_f32_16x16x32_bf16 v[108:111], v[176:179], a[108:111], v[108:111]
    s_waitcnt lgkmcnt(5)
    v_mfma_f32_16x16x32_bf16 v[104:107], v[180:183], a[112:115], v[104:107]
    v_mfma_f32_16x16x32_bf16 v[108:111], v[180:183], a[116:119], v[108:111]
    s_waitcnt lgkmcnt(4)
    v_mfma_f32_16x16x32_bf16 v[104:107], v[184:187], a[120:123], v[104:107]
    v_mfma_f32_16x16x32_bf16 v[108:111], v[184:187], a[124:127], v[108:111]
    s_waitcnt lgkmcnt(3)
    v_mfma_f32_16x16x32_bf16 v[104:107], v[188:191], a[128:131], v[104:107]
    v_mfma_f32_16x16x32_bf16 v[108:111], v[188:191], a[132:135], v[108:111]
    s_waitcnt lgkmcnt(2)
    v_mfma_f32_16x16x32_bf16 v[104:107], v[192:195], a[136:139], v[104:107]
    v_mfma_f32_16x16x32_bf16 v[108:111], v[192:195], a[140:143], v[108:111]
    s_waitcnt lgkmcnt(1)
    v_mfma_f32_16x16x32_bf16 v[104:107], v[196:199], a[144:147], v[104:107]
    v_mfma_f32_16x16x32_bf16 v[108:111], v[196:199], a[148:151], v[108:111]
    s_waitcnt lgkmcnt(0)
    v_mfma_f32_16x16x32_bf16 v[104:107], v[200:203], a[152:155], v[104:107]
    v_mfma_f32_16x16x32_bf16 v[108:111], v[200:203], a[156:159], v[108:111]
    s_waitcnt vmcnt(2)
    v_cvt_pk_bf16_f32 v88, v72, v73
    v_cvt_pk_bf16_f32 v89, v74, v75
    v_cvt_pk_bf16_f32 v90, v76, v77
    v_cvt_pk_bf16_f32 v91, v78, v79
    ds_write_b64 v30, v[88:89] offset:32768
    ds_write_b64 v30, v[90:91] offset:39936
    s_waitcnt vmcnt(0)
    v_cvt_pk_bf16_f32 v92, v80, v81
    v_cvt_pk_bf16_f32 v93, v82, v83
    v_cvt_pk_bf16_f32 v94, v84, v85
    v_cvt_pk_bf16_f32 v95, v86, v87
    ds_write_b64 v31, v[92:93] offset:32768
    ds_write_b64 v31, v[94:95] offset:39936
    v_lshlrev_b32 v14, 3, v20
    v_mul_f32 v96, v28, v104
    v_mul_f32 v97, v28, v108
    v_exp_f32 v96, -v96
    v_exp_f32 v97, -v97
    s_lshl_b32 s7, s4, 2
    s_add_u32 s7, s7, s3
    s_lshl_b32 s7, s7, 7
    s_lshl_b32 s39, s5, 13
    s_add_u32 s7, s7, s39
    s_add_u32 s7, s7, 196608
    v_add_f32 v98, 1.0, v96
    v_add_f32 v99, 1.0, v97
    v_rcp_f32 v26, v98
    v_rcp_f32 v27, v99
    v_cmp_gt_u32 vcc, 16, v20
    v_sub_f32 v96, 1.0, v26
    v_sub_f32 v97, 1.0, v27
    v_cndmask_b32 v96, v97, v96, vcc
    v_lshlrev_b32 v97, 2, v20
    s_mov_b32 exec_hi, 0
    buffer_store_dword v96, v97, s[16:19], s7 offen sc1
    s_mov_b64 exec, -1
    s_waitcnt lgkmcnt(0)
    s_barrier
    ds_read_b64 a[0:1], v14 offset:32768
    ds_read_b64 a[2:3], v14 offset:33280
    ds_read_b64 a[26:27], v14 offset:39936
    ds_read_b64 a[28:29], v14 offset:40448
    ds_read_b64 a[4:5], v14 offset:33792
    ds_read_b64 a[6:7], v14 offset:34304
    ds_read_b64 a[8:9], v14 offset:34816
    ds_read_b64 a[30:31], v14 offset:40960
    ds_read_b64 a[32:33], v14 offset:41472
    ds_read_b64 a[34:35], v14 offset:41984
    ds_read_b64 a[10:11], v14 offset:35328
    ds_read_b64 a[12:13], v14 offset:35840
    ds_read_b64 a[14:15], v14 offset:36352
    s_waitcnt lgkmcnt(11)
    ds_read_b64 a[36:37], v14 offset:42496
    ds_read_b64 a[38:39], v14 offset:43008
    ds_read_b64 a[40:41], v14 offset:43520
    s_waitcnt lgkmcnt(9)
    ds_read_b64 a[16:17], v14 offset:36864
    ds_read_b64 a[18:19], v14 offset:37376
    ds_read_b64 a[20:21], v14 offset:37888
    s_waitcnt lgkmcnt(9)
    ds_read_b64 a[42:43], v14 offset:44032
    ds_read_b64 a[44:45], v14 offset:44544
    ds_read_b64 a[46:47], v14 offset:45056
    s_waitcnt lgkmcnt(9)
    ds_read_b64 a[22:23], v14 offset:38400
    ds_read_b64 a[24:25], v14 offset:38912
    ds_read_b64 a[48:49], v14 offset:45568
    ds_read_b64 a[50:51], v14 offset:46080
    s_waitcnt lgkmcnt(10)
    s_lshl_b32 s36, s4, 2
    s_add_u32 s36, s36, s3
    s_lshl_b32 s36, s36, 3
    s_lshr_b32 s7, s5, 1
    s_add_u32 s36, s36, s7
    s_mul_i32 s36, s36, 5120
    s_add_u32 s36, s36, 10485760
    s_and_b32 s7, s5, 1
    s_lshl_b32 s37, s7, 9
    s_add_u32 s37, s37, s36
    s_add_u32 s37, s37, 4096
    s_lshl_b32 s7, s7, 11
    s_add_u32 s36, s36, s7
    v_mfma_f32_16x16x32_bf16 v[72:75], a[0:3], v[40:43], 0
    v_mfma_f32_16x16x32_bf16 v[92:95], a[26:29], v[40:43], v[64:67]
    v_mfma_f32_16x16x32_bf16 v[76:79], a[4:7], v[40:43], 0
    v_mfma_f32_16x16x32_bf16 v[96:99], a[30:33], v[40:43], v[64:67]
    v_mfma_f32_16x16x32_bf16 v[80:83], a[10:13], v[42:45], 0
    v_mfma_f32_16x16x32_bf16 v[100:103], a[36:39], v[42:45], v[64:67]
    s_waitcnt lgkmcnt(7)
    v_mfma_f32_16x16x32_bf16 v[84:87], a[16:19], v[44:47], 0
    s_waitcnt lgkmcnt(4)
    v_mfma_f32_16x16x32_bf16 v[104:107], a[42:45], v[44:47], v[64:67]
    s_waitcnt lgkmcnt(2)
    v_mfma_f32_16x16x32_bf16 v[88:91], a[22:25], v[46:49], 0
    s_waitcnt lgkmcnt(0)
    v_mfma_f32_16x16x32_bf16 v[108:111], a[48:51], v[46:49], v[64:67]
    v_mfma_f32_16x16x16_bf16 v[76:79], a[8:9], v[44:45], v[76:79]
    v_mfma_f32_16x16x16_bf16 v[96:99], a[34:35], v[44:45], v[96:99]
    v_mfma_f32_16x16x16_bf16 v[80:83], a[14:15], v[46:47], v[80:83]
    v_mfma_f32_16x16x16_bf16 v[100:103], a[40:41], v[46:47], v[100:103]
    v_mfma_f32_16x16x16_bf16 v[84:87], a[20:21], v[48:49], v[84:87]
    v_mfma_f32_16x16x16_bf16 v[104:107], a[46:47], v[48:49], v[104:107]
    v_mfma_f32_16x16x32_bf16 v[164:167], a[0:3], v[50:53], 0
    v_mfma_f32_16x16x32_bf16 v[184:187], a[26:29], v[50:53], v[64:67]
    v_mfma_f32_16x16x32_bf16 v[168:171], a[4:7], v[50:53], 0
    v_mfma_f32_16x16x32_bf16 v[188:191], a[30:33], v[50:53], v[64:67]
    v_mfma_f32_16x16x32_bf16 v[172:175], a[10:13], v[52:55], 0
    v_rcp_f32 v92, v92
    v_rcp_f32 v108, v108
    v_rcp_f32 v96, v96
    v_rcp_f32 v100, v100
    v_mfma_f32_16x16x32_bf16 v[192:195], a[36:39], v[52:55], v[64:67]
    v_rcp_f32 v104, v104
    v_mul_f32 v92, v26, v92
    v_mul_f32 v108, v26, v108
    v_mul_f32 v96, v26, v96
    v_mfma_f32_16x16x32_bf16 v[176:179], a[16:19], v[54:57], 0
    v_mul_f32 v100, v26, v100
    v_mul_f32 v104, v26, v104
    v_mul_f32 v72, v72, v92
    v_mul_f32 v73, v73, v92
    v_mfma_f32_16x16x32_bf16 v[196:199], a[42:45], v[54:57], v[64:67]
    v_mul_f32 v74, v74, v92
    v_mul_f32 v75, v75, v92
    v_cvt_pk_bf16_f32 v32, v72, v73
    v_cvt_pk_bf16_f32 v33, v74, v75
    v_mfma_f32_16x16x32_bf16 v[180:183], a[22:25], v[56:59], 0
    v_mul_f32 v76, v76, v96
    v_mul_f32 v77, v77, v96
    v_mul_f32 v78, v78, v96
    v_mul_f32 v79, v79, v96
    v_mfma_f32_16x16x32_bf16 v[200:203], a[48:51], v[56:59], v[64:67]
    v_cvt_pk_bf16_f32 v34, v76, v77
    v_cvt_pk_bf16_f32 v35, v78, v79
    s_add_u32 s7, s36, 0
    v_mfma_f32_16x16x16_bf16 v[168:171], a[8:9], v[54:55], v[168:171]
    buffer_store_dwordx4 v[32:35], v21, s[16:19], s7 offen offset:0 sc1
    v_mul_f32 v80, v80, v100
    v_mul_f32 v81, v81, v100
    v_mul_f32 v82, v82, v100
    v_mfma_f32_16x16x16_bf16 v[188:191], a[34:35], v[54:55], v[188:191]
    v_mul_f32 v83, v83, v100
    v_cvt_pk_bf16_f32 v36, v80, v81
    v_cvt_pk_bf16_f32 v37, v82, v83
    v_mul_f32 v84, v84, v104
    v_mfma_f32_16x16x16_bf16 v[172:175], a[14:15], v[56:57], v[172:175]
    v_mul_f32 v85, v85, v104
    v_mul_f32 v86, v86, v104
    v_mul_f32 v87, v87, v104
    v_cvt_pk_bf16_f32 v38, v84, v85
    v_mfma_f32_16x16x16_bf16 v[192:195], a[40:41], v[56:57], v[192:195]
    v_cvt_pk_bf16_f32 v39, v86, v87
    s_add_u32 s7, s36, 0
    buffer_store_dwordx4 v[36:39], v21, s[16:19], s7 offen offset:1024 sc1
    v_mul_f32 v88, v88, v108
    v_mfma_f32_16x16x16_bf16 v[176:179], a[20:21], v[58:59], v[176:179]
    v_mul_f32 v89, v89, v108
    v_mul_f32 v90, v90, v108
    v_mul_f32 v91, v91, v108
    v_cvt_pk_bf16_f32 v68, v88, v89
    v_mfma_f32_16x16x16_bf16 v[196:199], a[46:47], v[58:59], v[196:199]
    v_cvt_pk_bf16_f32 v69, v90, v91
    s_add_u32 s7, s37, 0
    buffer_store_dwordx2 v[68:69], v14, s[16:19], s7 offen sc1
    v_rcp_f32 v184, v184
    v_rcp_f32 v200, v200
    v_rcp_f32 v188, v188
    v_rcp_f32 v192, v192
    s_nop 0
    v_rcp_f32 v196, v196
    v_mul_f32 v184, v27, v184
    v_mul_f32 v200, v27, v200
    v_mul_f32 v188, v27, v188
    v_mul_f32 v192, v27, v192
    v_mul_f32 v196, v27, v196
    v_pk_mul_f32 v[164:165], v[164:165], v[184:185] op_sel_hi:[1,0]
    v_pk_mul_f32 v[166:167], v[166:167], v[184:185] op_sel_hi:[1,0]
    v_cvt_pk_bf16_f32 v40, v164, v165
    v_cvt_pk_bf16_f32 v41, v166, v167
    v_pk_mul_f32 v[168:169], v[168:169], v[188:189] op_sel_hi:[1,0]
    v_pk_mul_f32 v[170:171], v[170:171], v[188:189] op_sel_hi:[1,0]
    v_cvt_pk_bf16_f32 v42, v168, v169
    v_cvt_pk_bf16_f32 v43, v170, v171
    s_add_u32 s7, s36, 20480
    buffer_store_dwordx4 v[40:43], v21, s[16:19], s7 offen offset:0 sc1
    v_pk_mul_f32 v[172:173], v[172:173], v[192:193] op_sel_hi:[1,0]
    v_pk_mul_f32 v[174:175], v[174:175], v[192:193] op_sel_hi:[1,0]
    v_cvt_pk_bf16_f32 v44, v172, v173
    v_cvt_pk_bf16_f32 v45, v174, v175
    v_pk_mul_f32 v[176:177], v[176:177], v[196:197] op_sel_hi:[1,0]
    v_pk_mul_f32 v[178:179], v[178:179], v[196:197] op_sel_hi:[1,0]
    v_cvt_pk_bf16_f32 v46, v176, v177
    v_cvt_pk_bf16_f32 v47, v178, v179
    s_add_u32 s7, s36, 20480
    buffer_store_dwordx4 v[44:47], v21, s[16:19], s7 offen offset:1024 sc1
    v_pk_mul_f32 v[180:181], v[180:181], v[200:201] op_sel_hi:[1,0]
    v_pk_mul_f32 v[182:183], v[182:183], v[200:201] op_sel_hi:[1,0]
    v_cvt_pk_bf16_f32 v70, v180, v181
    v_cvt_pk_bf16_f32 v71, v182, v183
    s_add_u32 s7, s37, 20480
    buffer_store_dwordx2 v[70:71], v14, s[16:19], s7 offen sc1
    s_add_u32 s99, s44, 40960
    buffer_load_dwordx4 v[164:167], v21, s[16:19], s99 offen offset:0 sc1
    s_lshl_b32 s7, s32, 3
    s_lshl_b32 s62, s3, 1
    s_add_u32 s7, s7, s62
    s_lshl_b32 s62, s7, 7
    v_and_b32 v25, 1, v20
    v_lshl_add_u32 v25, v25, 7, s62
    v_add_u32 v26, 16384, v25
    v_add_u32 v18, 81920, v25
    buffer_load_dwordx4 v[168:171], v21, s[16:19], s99 offen offset:1024 sc1
    s_lshl_b32 s40, s32, 3
    s_add_u32 s40, s40, 5
    s_lshl_b32 s41, s40, 2
    s_mul_i32 s40, s40, 48
    s_mul_i32 s7, s3, 12
    s_add_u32 s40, s40, s7
    s_lshl_b32 s40, s40, 10
    s_add_u32 s40, s40, 4194304
    buffer_load_dwordx4 v[172:175], v21, s[16:19], s99 offen offset:2048 sc1
    s_add_u32 s41, s41, s3
    s_mul_i32 s41, s41, 5120
    s_add_u32 s41, s41, 10485760
    buffer_load_dwordx4 v[176:179], v21, s[16:19], s99 offen offset:3072 sc1
    s_lshl_b32 s43, s32, 7
    s_add_u32 s43, s43, 80
    s_lshl_b32 s42, s43, 2
    s_lshl_b32 s62, s3, 14
    s_add_u32 s42, s42, s62
    s_add_u32 s42, s42, 196608
    s_add_u32 s99, s44, 45056
    buffer_load_dwordx4 v[180:183], v21, s[16:19], s99 offen offset:0 sc1
    s_mul_i32 s43, s43, 1280
    s_mul_i32 s62, s33, 160
    s_add_u32 s43, s43, s62
    s_add_u32 s99, s44, 56320
    buffer_load_dwordx4 v[184:187], v21, s[16:19], s99 offen offset:0 sc1
    v_and_b32 v29, 15, v20
    v_lshlrev_b32 v28, 2, v29
    v_lshlrev_b32 v27, 3, v20
    v_add_u32 v30, s48, v21
    v_mul_u32_u24 v29, 160, v29
    buffer_load_dwordx4 v[188:191], v21, s[16:19], s99 offen offset:1024 sc1
    v_bfe_u32 v31, v20, 4, 1
    v_mul_u32_u24 v31, 7680, v31
    v_add_u32 v29, v29, v31
    v_lshrrev_b32 v31, 5, v20
    v_bfe_u32 v1, v20, 2, 1
    v_xor_b32 v31, v31, v1
    v_lshl_add_u32 v29, v31, 4, v29
    v_add_u32 v29, s48, v29
    buffer_load_dwordx4 v[192:195], v21, s[16:19], s99 offen offset:2048 sc1
    v_add_u32 v31, 0, v0
    s_mov_b32 s7, 0x1999999a
    v_mul_hi_u32 v10, v31, s7
    v_mul_u32_u24 v14, 10, v10
    v_sub_u32 v1, v31, v14
    v_lshlrev_b32 v1, 4, v1
    buffer_load_dwordx4 v[196:199], v21, s[16:19], s99 offen offset:3072 sc1
    v_mul_u32_u24 v14, 160, v10
    v_add_u32 v14, v14, v1
    v_and_b32 v24, 4, v10
    v_lshlrev_b32 v24, 2, v24
    v_xor_b32 v14, v14, v24
    v_mul_u32_u24 v10, 1280, v10
    v_add_u32 v10, v10, v1
    s_add_u32 s99, s44, 60416
    buffer_load_dwordx4 v[200:203], v21, s[16:19], s99 offen offset:0 sc1
    v_add_u32 v31, 256, v0
    s_mov_b32 s7, 0x1999999a
    v_mul_hi_u32 v11, v31, s7
    v_mul_u32_u24 v15, 10, v11
    v_sub_u32 v1, v31, v15
    v_lshlrev_b32 v1, 4, v1
    s_add_u32 s99, s45, 0
    buffer_load_dwordx4 a[52:55], v21, s[16:19], s99 offen offset:0 sc1
    v_mul_u32_u24 v15, 160, v11
    v_add_u32 v15, v15, v1
    v_and_b32 v24, 4, v11
    v_lshlrev_b32 v24, 2, v24
    v_xor_b32 v15, v15, v24
    v_mul_u32_u24 v11, 1280, v11
    v_add_u32 v11, v11, v1
    v_mov_b32 v1, 2147418112
    v_cmp_gt_u32 vcc, 480, v31
    s_nop 1
    v_cndmask_b32 v11, v1, v11, vcc
    buffer_load_dwordx4 a[56:59], v21, s[16:19], s99 offen offset:1024 sc1
    s_mov_b64 s[24:25], s[56:57]
    s_mov_b32 s26, 2621440
    s_mov_b32 s27, 0x20000
    buffer_load_dword v24, v18, s[16:19], 0 offen sc1
    s_waitcnt vmcnt(0)
    v_cmp_ne_u32 vcc, 0, v24
    s_mov_b32 s98, 0
    s_nop 0
    s_cmp_eq_u64 vcc, -1
    s_cbranch_scc1 L_ok_8
L_spin_9:
    buffer_load_dword v24, v18, s[16:19], 0 offen sc1
    s_add_u32 s98, s98, 1
    s_waitcnt vmcnt(0)
    v_cmp_ne_u32 vcc, 0, v24
    s_cmp_gt_u32 s98, 0x40000
    s_cbranch_scc1 L_ok_8
    s_cmp_eq_u64 vcc, -1
    s_cbranch_scc0 L_spin_9
L_ok_8:
    s_barrier
    s_add_u32 s7, s40, 0
    buffer_load_dwordx4 a[0:3], v21, s[16:19], s7 offen sc1
    s_add_u32 s7, s40, 49152
    buffer_load_dwordx4 a[4:7], v21, s[16:19], s7 offen sc1
    s_add_u32 s7, s40, 98304
    buffer_load_dwordx4 a[8:11], v21, s[16:19], s7 offen sc1
    s_add_u32 s7, s40, 3072
    buffer_load_dwordx4 a[12:15], v21, s[16:19], s7 offen sc1
    s_add_u32 s7, s40, 52224
    buffer_load_dwordx4 a[16:19], v21, s[16:19], s7 offen sc1
    s_add_u32 s7, s40, 101376
    buffer_load_dwordx4 a[20:23], v21, s[16:19], s7 offen sc1
    s_add_u32 s7, s40, 6144
    buffer_load_dwordx4 a[24:27], v21, s[16:19], s7 offen sc1
    s_add_u32 s7, s40, 55296
    buffer_load_dwordx4 a[28:31], v21, s[16:19], s7 offen sc1
    s_add_u32 s7, s40, 104448
    buffer_load_dwordx4 a[32:35], v21, s[16:19], s7 offen sc1
    s_cmp_lg_u32 s3, 0
    s_cbranch_scc1 L_nf_10
    s_lshl_b32 s7, s4, 3
    s_add_u32 s7, s7, s5
    s_lshl_b32 s7, s7, 7
    s_add_u32 s7, s7, 16384
    s_mov_b64 exec, 1
    buffer_store_dword v22, v23, s[16:19], s7 offen sc1
    s_mov_b64 exec, -1
L_nf_10:
    s_waitcnt vmcnt(8)
    v_mfma_f32_16x16x32_bf16 v[32:35], a[160:163], a[0:3], 0
    s_add_u32 s7, s40, 9216
    buffer_load_dwordx4 a[36:39], v21, s[16:19], s7 offen sc1
    v_mfma_f32_16x16x32_bf16 v[36:39], a[164:167], a[0:3], 0
    v_mfma_f32_16x16x32_bf16 v[40:43], a[168:171], a[0:3], 0
    s_add_u32 s7, s40, 58368
    buffer_load_dwordx4 a[40:43], v21, s[16:19], s7 offen sc1
    v_mfma_f32_16x16x32_bf16 v[44:47], a[172:175], a[0:3], 0
    v_mfma_f32_16x16x32_bf16 v[48:51], a[176:179], a[0:3], 0
    s_waitcnt vmcnt(9)
    v_mfma_f32_16x16x32_bf16 v[52:55], a[160:163], a[4:7], 0
    s_add_u32 s7, s40, 107520
    buffer_load_dwordx4 a[44:47], v21, s[16:19], s7 offen sc1
    v_mfma_f32_16x16x32_bf16 v[56:59], a[164:167], a[4:7], 0
    v_mfma_f32_16x16x32_bf16 v[60:63], a[168:171], a[4:7], 0
    s_add_u32 s7, s40, 1024
    buffer_load_dwordx4 a[48:51], v21, s[16:19], s7 offen sc1
    v_mfma_f32_16x16x32_bf16 v[64:67], a[172:175], a[4:7], 0
    v_mfma_f32_16x16x32_bf16 v[68:71], a[176:179], a[4:7], 0
    s_waitcnt vmcnt(10)
    v_mfma_f32_16x16x32_bf16 v[72:75], a[160:163], a[8:11], 0
    s_add_u32 s7, s40, 50176
    buffer_load_dwordx4 a[152:155], v21, s[16:19], s7 offen sc1
    v_mfma_f32_16x16x32_bf16 v[76:79], a[164:167], a[8:11], 0
    v_mfma_f32_16x16x32_bf16 v[80:83], a[168:171], a[8:11], 0
    s_add_u32 s7, s40, 99328
    buffer_load_dwordx4 a[156:159], v21, s[16:19], s7 offen sc1
    v_mfma_f32_16x16x32_bf16 v[84:87], a[172:175], a[8:11], 0
    v_mfma_f32_16x16x32_bf16 v[88:91], a[176:179], a[8:11], 0
    s_waitcnt vmcnt(11)
    v_mfma_f32_16x16x32_bf16 v[32:35], a[180:183], a[12:15], v[32:35]
    s_add_u32 s7, s40, 4096
    buffer_load_dwordx4 v[92:95], v21, s[16:19], s7 offen sc1
    v_mfma_f32_16x16x32_bf16 v[36:39], a[184:187], a[12:15], v[36:39]
    v_mfma_f32_16x16x32_bf16 v[40:43], a[188:191], a[12:15], v[40:43]
    s_add_u32 s7, s40, 53248
    buffer_load_dwordx4 v[96:99], v21, s[16:19], s7 offen sc1
    v_mfma_f32_16x16x32_bf16 v[44:47], a[192:195], a[12:15], v[44:47]
    v_mfma_f32_16x16x32_bf16 v[48:51], a[196:199], a[12:15], v[48:51]
    s_waitcnt vmcnt(12)
    v_mfma_f32_16x16x32_bf16 v[52:55], a[180:183], a[16:19], v[52:55]
    s_add_u32 s7, s40, 102400
    buffer_load_dwordx4 v[100:103], v21, s[16:19], s7 offen sc1
    v_mfma_f32_16x16x32_bf16 v[56:59], a[184:187], a[16:19], v[56:59]
    v_mfma_f32_16x16x32_bf16 v[60:63], a[188:191], a[16:19], v[60:63]
    s_add_u32 s7, s40, 7168
    buffer_load_dwordx4 v[104:107], v21, s[16:19], s7 offen sc1
    v_mfma_f32_16x16x32_bf16 v[64:67], a[192:195], a[16:19], v[64:67]
    v_mfma_f32_16x16x32_bf16 v[68:71], a[196:199], a[16:19], v[68:71]
    s_waitcnt vmcnt(13)
    v_mfma_f32_16x16x32_bf16 v[72:75], a[180:183], a[20:23], v[72:75]
    s_add_u32 s7, s40, 56320
    buffer_load_dwordx4 v[108:111], v21, s[16:19], s7 offen sc1
    v_mfma_f32_16x16x32_bf16 v[76:79], a[184:187], a[20:23], v[76:79]
    v_mfma_f32_16x16x32_bf16 v[80:83], a[188:191], a[20:23], v[80:83]
    s_add_u32 s7, s40, 105472
    buffer_load_dwordx4 a[0:3], v21, s[16:19], s7 offen sc1
    v_mfma_f32_16x16x32_bf16 v[84:87], a[192:195], a[20:23], v[84:87]
    v_mfma_f32_16x16x32_bf16 v[88:91], a[196:199], a[20:23], v[88:91]
    s_waitcnt vmcnt(14)
    v_mfma_f32_16x16x32_bf16 v[32:35], a[200:203], a[24:27], v[32:35]
    s_add_u32 s7, s40, 10240
    buffer_load_dwordx4 a[4:7], v21, s[16:19], s7 offen sc1
    v_mfma_f32_16x16x32_bf16 v[36:39], a[204:207], a[24:27], v[36:39]
    v_mfma_f32_16x16x32_bf16 v[40:43], a[208:211], a[24:27], v[40:43]
    s_add_u32 s7, s40, 59392
    buffer_load_dwordx4 a[8:11], v21, s[16:19], s7 offen sc1
    v_mfma_f32_16x16x32_bf16 v[44:47], a[212:215], a[24:27], v[44:47]
    v_mfma_f32_16x16x32_bf16 v[48:51], a[216:219], a[24:27], v[48:51]
    s_waitcnt vmcnt(15)
    v_mfma_f32_16x16x32_bf16 v[52:55], a[200:203], a[28:31], v[52:55]
    s_add_u32 s7, s40, 108544
    buffer_load_dwordx4 a[160:163], v21, s[16:19], s7 offen sc1
    v_mfma_f32_16x16x32_bf16 v[56:59], a[204:207], a[28:31], v[56:59]
    v_mfma_f32_16x16x32_bf16 v[60:63], a[208:211], a[28:31], v[60:63]
    s_add_u32 s7, s40, 2048
    buffer_load_dwordx4 a[164:167], v21, s[16:19], s7 offen sc1
    v_mfma_f32_16x16x32_bf16 v[64:67], a[212:215], a[28:31], v[64:67]
    v_mfma_f32_16x16x32_bf16 v[68:71], a[216:219], a[28:31], v[68:71]
    s_waitcnt vmcnt(16)
    v_mfma_f32_16x16x32_bf16 v[72:75], a[200:203], a[32:35], v[72:75]
    s_add_u32 s7, s40, 51200
    buffer_load_dwordx4 a[168:171], v21, s[16:19], s7 offen sc1
    v_mfma_f32_16x16x32_bf16 v[76:79], a[204:207], a[32:35], v[76:79]
    v_mfma_f32_16x16x32_bf16 v[80:83], a[208:211], a[32:35], v[80:83]
    s_add_u32 s7, s40, 100352
    buffer_load_dwordx4 a[172:175], v21, s[16:19], s7 offen sc1
    v_mfma_f32_16x16x32_bf16 v[84:87], a[212:215], a[32:35], v[84:87]
    v_mfma_f32_16x16x32_bf16 v[88:91], a[216:219], a[32:35], v[88:91]
    s_waitcnt vmcnt(17)
    v_mfma_f32_16x16x32_bf16 v[32:35], a[220:223], a[36:39], v[32:35]
    s_add_u32 s7, s40, 5120
    buffer_load_dwordx4 a[176:179], v21, s[16:19], s7 offen sc1
    v_mfma_f32_16x16x32_bf16 v[36:39], a[224:227], a[36:39], v[36:39]
    v_mfma_f32_16x16x32_bf16 v[40:43], a[228:231], a[36:39], v[40:43]
    s_add_u32 s7, s40, 54272
    buffer_load_dwordx4 a[12:15], v21, s[16:19], s7 offen sc1
    v_mfma_f32_16x16x32_bf16 v[44:47], a[232:235], a[36:39], v[44:47]
    v_mfma_f32_16x16x32_bf16 v[48:51], a[236:239], a[36:39], v[48:51]
    s_waitcnt vmcnt(18)
    v_mfma_f32_16x16x32_bf16 v[52:55], a[220:223], a[40:43], v[52:55]
    s_add_u32 s7, s40, 103424
    buffer_load_dwordx4 a[16:19], v21, s[16:19], s7 offen sc1
    v_mfma_f32_16x16x32_bf16 v[56:59], a[224:227], a[40:43], v[56:59]
    v_mfma_f32_16x16x32_bf16 v[60:63], a[228:231], a[40:43], v[60:63]
    s_add_u32 s7, s40, 8192
    buffer_load_dwordx4 a[20:23], v21, s[16:19], s7 offen sc1
    v_mfma_f32_16x16x32_bf16 v[64:67], a[232:235], a[40:43], v[64:67]
    v_mfma_f32_16x16x32_bf16 v[68:71], a[236:239], a[40:43], v[68:71]
    s_waitcnt vmcnt(19)
    v_mfma_f32_16x16x32_bf16 v[72:75], a[220:223], a[44:47], v[72:75]
    s_add_u32 s7, s40, 57344
    buffer_load_dwordx4 a[180:183], v21, s[16:19], s7 offen sc1
    v_mfma_f32_16x16x32_bf16 v[76:79], a[224:227], a[44:47], v[76:79]
    v_mfma_f32_16x16x32_bf16 v[80:83], a[228:231], a[44:47], v[80:83]
    s_add_u32 s7, s40, 106496
    buffer_load_dwordx4 a[184:187], v21, s[16:19], s7 offen sc1
    v_mfma_f32_16x16x32_bf16 v[84:87], a[232:235], a[44:47], v[84:87]
    v_mfma_f32_16x16x32_bf16 v[88:91], a[236:239], a[44:47], v[88:91]
    s_waitcnt vmcnt(20)
    v_mfma_f32_16x16x32_bf16 v[32:35], a[240:243], a[48:51], v[32:35]
    s_add_u32 s7, s40, 11264
    buffer_load_dwordx4 a[188:191], v21, s[16:19], s7 offen sc1
    v_mfma_f32_16x16x32_bf16 v[36:39], a[244:247], a[48:51], v[36:39]
    v_mfma_f32_16x16x32_bf16 v[40:43], a[248:251], a[48:51], v[40:43]
    v_mfma_f32_16x16x32_bf16 v[44:47], a[252:255], a[48:51], v[44:47]
    v_mfma_f32_16x16x32_bf16 v[48:51], v[204:207], a[48:51], v[48:51]
    s_waitcnt vmcnt(20)
    v_mfma_f32_16x16x32_bf16 v[52:55], a[240:243], a[152:155], v[52:55]
    s_add_u32 s7, s40, 60416
    buffer_load_dwordx4 a[192:195], v21, s[16:19], s7 offen sc1
    v_mfma_f32_16x16x32_bf16 v[56:59], a[244:247], a[152:155], v[56:59]
    v_mfma_f32_16x16x32_bf16 v[60:63], a[248:251], a[152:155], v[60:63]
    v_mfma_f32_16x16x32_bf16 v[64:67], a[252:255], a[152:155], v[64:67]
    v_mfma_f32_16x16x32_bf16 v[68:71], v[204:207], a[152:155], v[68:71]
    s_waitcnt vmcnt(20)
    v_mfma_f32_16x16x32_bf16 v[72:75], a[240:243], a[156:159], v[72:75]
    s_add_u32 s7, s40, 109568
    buffer_load_dwordx4 a[196:199], v21, s[16:19], s7 offen sc1
    v_mfma_f32_16x16x32_bf16 v[76:79], a[244:247], a[156:159], v[76:79]
    v_mfma_f32_16x16x32_bf16 v[80:83], a[248:251], a[156:159], v[80:83]
    v_mfma_f32_16x16x32_bf16 v[84:87], a[252:255], a[156:159], v[84:87]
    v_mfma_f32_16x16x32_bf16 v[88:91], v[204:207], a[156:159], v[88:91]
    s_waitcnt vmcnt(20)
    v_mfma_f32_16x16x32_bf16 v[32:35], v[208:211], v[92:95], v[32:35]
    buffer_load_dwordx4 a[60:63], v21, s[16:19], s99 offen offset:2048 sc1
    v_mfma_f32_16x16x32_bf16 v[36:39], v[212:215], v[92:95], v[36:39]
    v_mfma_f32_16x16x32_bf16 v[40:43], v[216:219], v[92:95], v[40:43]
    v_mfma_f32_16x16x32_bf16 v[44:47], v[220:223], v[92:95], v[44:47]
    v_mfma_f32_16x16x32_bf16 v[48:51], v[224:227], v[92:95], v[48:51]
    s_waitcnt vmcnt(20)
    v_mfma_f32_16x16x32_bf16 v[52:55], v[208:211], v[96:99], v[52:55]
    buffer_load_dwordx4 a[64:67], v21, s[16:19], s99 offen offset:3072 sc1
    v_mfma_f32_16x16x32_bf16 v[56:59], v[212:215], v[96:99], v[56:59]
    v_mfma_f32_16x16x32_bf16 v[60:63], v[216:219], v[96:99], v[60:63]
    v_mfma_f32_16x16x32_bf16 v[64:67], v[220:223], v[96:99], v[64:67]
    v_mfma_f32_16x16x32_bf16 v[68:71], v[224:227], v[96:99], v[68:71]
    s_waitcnt vmcnt(20)
    v_mfma_f32_16x16x32_bf16 v[72:75], v[208:211], v[100:103], v[72:75]
    s_add_u32 s99, s45, 4096
    buffer_load_dwordx4 a[68:71], v21, s[16:19], s99 offen offset:0 sc1
    v_mfma_f32_16x16x32_bf16 v[76:79], v[212:215], v[100:103], v[76:79]
    v_mfma_f32_16x16x32_bf16 v[80:83], v[216:219], v[100:103], v[80:83]
    v_mfma_f32_16x16x32_bf16 v[84:87], v[220:223], v[100:103], v[84:87]
    v_mfma_f32_16x16x32_bf16 v[88:91], v[224:227], v[100:103], v[88:91]
    buffer_load_dword v24, v26, s[16:19], 0 offen sc1
    s_waitcnt vmcnt(21)
    v_mfma_f32_16x16x32_bf16 v[32:35], v[228:231], v[104:107], v[32:35]
    buffer_load_dwordx4 a[72:75], v21, s[16:19], s99 offen offset:1024 sc1
    v_mfma_f32_16x16x32_bf16 v[36:39], v[232:235], v[104:107], v[36:39]
    v_mfma_f32_16x16x32_bf16 v[40:43], v[236:239], v[104:107], v[40:43]
    v_mfma_f32_16x16x32_bf16 v[44:47], v[240:243], v[104:107], v[44:47]
    buffer_load_dwordx4 a[76:79], v21, s[16:19], s99 offen offset:2048 sc1
    v_mfma_f32_16x16x32_bf16 v[48:51], v[244:247], v[104:107], v[48:51]
    s_waitcnt vmcnt(22)
    v_mfma_f32_16x16x32_bf16 v[52:55], v[228:231], v[108:111], v[52:55]
    v_mfma_f32_16x16x32_bf16 v[56:59], v[232:235], v[108:111], v[56:59]
    buffer_load_dwordx4 a[80:83], v21, s[16:19], s99 offen offset:3072 sc1
    v_mfma_f32_16x16x32_bf16 v[60:63], v[236:239], v[108:111], v[60:63]
    v_mfma_f32_16x16x32_bf16 v[64:67], v[240:243], v[108:111], v[64:67]
    v_mfma_f32_16x16x32_bf16 v[68:71], v[244:247], v[108:111], v[68:71]
    s_add_u32 s99, s45, 8192
    buffer_load_dwordx4 a[84:87], v21, s[16:19], s99 offen offset:0 sc1
    s_waitcnt vmcnt(23)
    v_mfma_f32_16x16x32_bf16 v[72:75], v[228:231], a[0:3], v[72:75]
    v_mfma_f32_16x16x32_bf16 v[76:79], v[232:235], a[0:3], v[76:79]
    v_mfma_f32_16x16x32_bf16 v[80:83], v[236:239], a[0:3], v[80:83]
    buffer_load_dwordx4 a[88:91], v21, s[16:19], s99 offen offset:1024 sc1
    v_mfma_f32_16x16x32_bf16 v[84:87], v[240:243], a[0:3], v[84:87]
    v_mfma_f32_16x16x32_bf16 v[88:91], v[244:247], a[0:3], v[88:91]
    s_waitcnt vmcnt(23)
    v_mfma_f32_16x16x32_bf16 v[32:35], v[248:251], a[4:7], v[32:35]
    buffer_load_dwordx4 a[92:95], v21, s[16:19], s99 offen offset:2048 sc1
    v_mfma_f32_16x16x32_bf16 v[36:39], v[252:255], a[4:7], v[36:39]
    v_mfma_f32_16x16x32_bf16 v[40:43], v[112:115], a[4:7], v[40:43]
    v_mfma_f32_16x16x32_bf16 v[44:47], v[116:119], a[4:7], v[44:47]
    buffer_load_dwordx4 a[96:99], v21, s[16:19], s99 offen offset:3072 sc1
    v_mfma_f32_16x16x32_bf16 v[48:51], v[120:123], a[4:7], v[48:51]
    s_waitcnt vmcnt(24)
    v_mfma_f32_16x16x32_bf16 v[52:55], v[248:251], a[8:11], v[52:55]
    v_mfma_f32_16x16x32_bf16 v[56:59], v[252:255], a[8:11], v[56:59]
    s_add_u32 s99, s45, 12288
    buffer_load_dwordx4 a[100:103], v21, s[16:19], s99 offen offset:0 sc1
    v_mfma_f32_16x16x32_bf16 v[60:63], v[112:115], a[8:11], v[60:63]
    v_mfma_f32_16x16x32_bf16 v[64:67], v[116:119], a[8:11], v[64:67]
    v_mfma_f32_16x16x32_bf16 v[68:71], v[120:123], a[8:11], v[68:71]
    buffer_load_dwordx4 a[104:107], v21, s[16:19], s99 offen offset:1024 sc1
    s_waitcnt vmcnt(25)
    v_mfma_f32_16x16x32_bf16 v[72:75], v[248:251], a[160:163], v[72:75]
    v_mfma_f32_16x16x32_bf16 v[76:79], v[252:255], a[160:163], v[76:79]
    v_mfma_f32_16x16x32_bf16 v[80:83], v[112:115], a[160:163], v[80:83]
    buffer_load_dwordx4 a[108:111], v21, s[16:19], s99 offen offset:2048 sc1
    v_mfma_f32_16x16x32_bf16 v[84:87], v[116:119], a[160:163], v[84:87]
    v_mfma_f32_16x16x32_bf16 v[88:91], v[120:123], a[160:163], v[88:91]
    s_waitcnt vmcnt(10)
    v_cmp_ne_u32 vcc, 0, v24
    s_mov_b32 s98, 0
    s_nop 0
    s_cmp_eq_u64 vcc, -1
    s_cbranch_scc1 L_ok_11
L_spin_12:
    buffer_load_dword v24, v26, s[16:19], 0 offen sc1
    s_add_u32 s98, s98, 1
    s_waitcnt vmcnt(0)
    v_cmp_ne_u32 vcc, 0, v24
    s_cmp_gt_u32 s98, 0x40000
    s_cbranch_scc1 L_ok_11
    s_cmp_eq_u64 vcc, -1
    s_cbranch_scc0 L_spin_12
L_ok_11:
    v_mfma_f32_16x16x32_bf16 v[32:35], v[124:127], a[164:167], v[32:35]
    buffer_load_dword v4, v28, s[16:19], s42 offen offset:0 sc1
    buffer_load_dword v5, v28, s[16:19], s42 offen offset:64 sc1
    v_mfma_f32_16x16x32_bf16 v[36:39], v[128:131], a[164:167], v[36:39]
    buffer_load_dword v6, v28, s[16:19], s42 offen offset:128 sc1
    s_add_u32 s7, s41, 0
    v_mfma_f32_16x16x32_bf16 v[40:43], v[132:135], a[164:167], v[40:43]
    buffer_load_dwordx4 a[24:27], v21, s[16:19], s7 offen sc1
    s_add_u32 s7, s41, 20480
    v_mfma_f32_16x16x32_bf16 v[44:47], v[136:139], a[164:167], v[44:47]
    buffer_load_dwordx4 a[28:31], v21, s[16:19], s7 offen sc1
    v_mfma_f32_16x16x32_bf16 v[48:51], v[140:143], a[164:167], v[48:51]
    v_mfma_f32_16x16x32_bf16 v[52:55], v[124:127], a[168:171], v[52:55]
    s_add_u32 s7, s41, 40960
    buffer_load_dwordx4 a[32:35], v21, s[16:19], s7 offen sc1
    v_mfma_f32_16x16x32_bf16 v[56:59], v[128:131], a[168:171], v[56:59]
    v_mfma_f32_16x16x32_bf16 v[60:63], v[132:135], a[168:171], v[60:63]
    s_add_u32 s7, s41, 1024
    buffer_load_dwordx4 a[200:203], v21, s[16:19], s7 offen sc1
    v_mfma_f32_16x16x32_bf16 v[64:67], v[136:139], a[168:171], v[64:67]
    v_mfma_f32_16x16x32_bf16 v[68:71], v[140:143], a[168:171], v[68:71]
    v_mfma_f32_16x16x32_bf16 v[72:75], v[124:127], a[172:175], v[72:75]
    s_add_u32 s7, s41, 21504
    buffer_load_dwordx4 a[204:207], v21, s[16:19], s7 offen sc1
    v_mfma_f32_16x16x32_bf16 v[76:79], v[128:131], a[172:175], v[76:79]
    v_mfma_f32_16x16x32_bf16 v[80:83], v[132:135], a[172:175], v[80:83]
    s_add_u32 s7, s41, 41984
    buffer_load_dwordx4 a[208:211], v21, s[16:19], s7 offen sc1
    v_mfma_f32_16x16x32_bf16 v[84:87], v[136:139], a[172:175], v[84:87]
    v_mfma_f32_16x16x32_bf16 v[88:91], v[140:143], a[172:175], v[88:91]
    v_mfma_f32_16x16x32_bf16 v[32:35], v[144:147], a[176:179], v[32:35]
    s_add_u32 s7, s41, 2048
    buffer_load_dwordx4 a[212:215], v21, s[16:19], s7 offen sc1
    v_mfma_f32_16x16x32_bf16 v[36:39], v[148:151], a[176:179], v[36:39]
    v_mfma_f32_16x16x32_bf16 v[40:43], v[152:155], a[176:179], v[40:43]
    s_add_u32 s7, s41, 22528
    buffer_load_dwordx4 a[216:219], v21, s[16:19], s7 offen sc1
    v_mfma_f32_16x16x32_bf16 v[44:47], v[156:159], a[176:179], v[44:47]
    v_mfma_f32_16x16x32_bf16 v[48:51], v[160:163], a[176:179], v[48:51]
    v_mfma_f32_16x16x32_bf16 v[52:55], v[144:147], a[12:15], v[52:55]
    s_add_u32 s7, s41, 43008
    buffer_load_dwordx4 a[36:39], v21, s[16:19], s7 offen sc1
    v_mfma_f32_16x16x32_bf16 v[56:59], v[148:151], a[12:15], v[56:59]
    v_mfma_f32_16x16x32_bf16 v[60:63], v[152:155], a[12:15], v[60:63]
    buffer_load_dwordx4 a[112:115], v21, s[16:19], s99 offen offset:3072 sc1
    v_mfma_f32_16x16x32_bf16 v[64:67], v[156:159], a[12:15], v[64:67]
    v_mfma_f32_16x16x32_bf16 v[68:71], v[160:163], a[12:15], v[68:71]
    v_mfma_f32_16x16x32_bf16 v[72:75], v[144:147], a[16:19], v[72:75]
    s_add_u32 s99, s45, 16384
    buffer_load_dwordx4 a[116:119], v21, s[16:19], s99 offen offset:0 sc1
    v_mfma_f32_16x16x32_bf16 v[76:79], v[148:151], a[16:19], v[76:79]
    v_mfma_f32_16x16x32_bf16 v[80:83], v[152:155], a[16:19], v[80:83]
    buffer_load_dwordx4 a[120:123], v21, s[16:19], s99 offen offset:1024 sc1
    v_mfma_f32_16x16x32_bf16 v[84:87], v[156:159], a[16:19], v[84:87]
    v_mfma_f32_16x16x32_bf16 v[88:91], v[160:163], a[16:19], v[88:91]
    v_mfma_f32_16x16x32_bf16 v[32:35], v[164:167], a[20:23], v[32:35]
    buffer_load_dwordx4 a[124:127], v21, s[16:19], s99 offen offset:2048 sc1
    v_mfma_f32_16x16x32_bf16 v[36:39], v[168:171], a[20:23], v[36:39]
    v_mfma_f32_16x16x32_bf16 v[40:43], v[172:175], a[20:23], v[40:43]
    buffer_load_dwordx4 a[128:131], v21, s[16:19], s99 offen offset:3072 sc1
    v_mfma_f32_16x16x32_bf16 v[44:47], v[176:179], a[20:23], v[44:47]
    v_mfma_f32_16x16x32_bf16 v[48:51], v[180:183], a[20:23], v[48:51]
    v_mfma_f32_16x16x32_bf16 v[52:55], v[164:167], a[180:183], v[52:55]
    s_add_u32 s7, s41, 3072
    buffer_load_dwordx4 a[40:43], v21, s[16:19], s7 offen sc1
    v_mfma_f32_16x16x32_bf16 v[56:59], v[168:171], a[180:183], v[56:59]
    v_mfma_f32_16x16x32_bf16 v[60:63], v[172:175], a[180:183], v[60:63]
    s_add_u32 s7, s41, 23552
    buffer_load_dwordx4 a[44:47], v21, s[16:19], s7 offen sc1
    v_mfma_f32_16x16x32_bf16 v[64:67], v[176:179], a[180:183], v[64:67]
    v_mfma_f32_16x16x32_bf16 v[68:71], v[180:183], a[180:183], v[68:71]
    v_mfma_f32_16x16x32_bf16 v[72:75], v[164:167], a[184:187], v[72:75]
    s_add_u32 s7, s41, 44032
    buffer_load_dwordx4 a[220:223], v21, s[16:19], s7 offen sc1
    v_mfma_f32_16x16x32_bf16 v[76:79], v[168:171], a[184:187], v[76:79]
    v_mfma_f32_16x16x32_bf16 v[80:83], v[172:175], a[184:187], v[80:83]
    s_add_u32 s99, s45, 20480
    buffer_load_dwordx4 a[132:135], v21, s[16:19], s99 offen offset:0 sc1
    v_mfma_f32_16x16x32_bf16 v[84:87], v[176:179], a[184:187], v[84:87]
    v_mfma_f32_16x16x32_bf16 v[88:91], v[180:183], a[184:187], v[88:91]
    v_mfma_f32_16x16x32_bf16 v[32:35], v[184:187], a[188:191], v[32:35]
    buffer_load_dwordx4 a[136:139], v21, s[16:19], s99 offen offset:1024 sc1
    v_mfma_f32_16x16x32_bf16 v[36:39], v[188:191], a[188:191], v[36:39]
    v_mfma_f32_16x16x32_bf16 v[40:43], v[192:195], a[188:191], v[40:43]
    buffer_load_dwordx4 a[140:143], v21, s[16:19], s99 offen offset:2048 sc1
    v_mfma_f32_16x16x32_bf16 v[44:47], v[196:199], a[188:191], v[44:47]
    v_mfma_f32_16x16x32_bf16 v[48:51], v[200:203], a[188:191], v[48:51]
    v_mfma_f32_16x16x32_bf16 v[52:55], v[184:187], a[192:195], v[52:55]
    buffer_load_dwordx4 a[144:147], v21, s[16:19], s99 offen offset:3072 sc1
    v_mfma_f32_16x16x32_bf16 v[56:59], v[188:191], a[192:195], v[56:59]
    v_mfma_f32_16x16x32_bf16 v[60:63], v[192:195], a[192:195], v[60:63]
    s_add_u32 s99, s45, 24576
    buffer_load_dwordx4 a[148:151], v21, s[16:19], s99 offen offset:0 sc1
    v_mfma_f32_16x16x32_bf16 v[64:67], v[196:199], a[192:195], v[64:67]
    v_mfma_f32_16x16x32_bf16 v[68:71], v[200:203], a[192:195], v[68:71]
    v_mfma_f32_16x16x32_bf16 v[72:75], v[184:187], a[196:199], v[72:75]
    s_add_u32 s7, s41, 4096
    buffer_load_dwordx2 a[224:225], v27, s[16:19], s7 offen sc1
    v_mfma_f32_16x16x32_bf16 v[76:79], v[188:191], a[196:199], v[76:79]
    buffer_load_dwordx2 a[226:227], v27, s[16:19], s7 offen offset:512 sc1
    v_mfma_f32_16x16x32_bf16 v[80:83], v[192:195], a[196:199], v[80:83]
    s_add_u32 s7, s41, 24576
    buffer_load_dwordx2 a[228:229], v27, s[16:19], s7 offen sc1
    v_mfma_f32_16x16x32_bf16 v[84:87], v[196:199], a[196:199], v[84:87]
    buffer_load_dwordx2 a[230:231], v27, s[16:19], s7 offen offset:512 sc1
    v_mfma_f32_16x16x32_bf16 v[88:91], v[200:203], a[196:199], v[88:91]
    s_waitcnt vmcnt(28)
    v_pk_mul_f32 v[32:33], v[32:33], v[4:5] op_sel_hi:[1,0]
    v_pk_mul_f32 v[34:35], v[34:35], v[4:5] op_sel_hi:[1,0]
    v_pk_mul_f32 v[36:37], v[36:37], v[4:5] op_sel_hi:[1,0]
    v_pk_mul_f32 v[38:39], v[38:39], v[4:5] op_sel_hi:[1,0]
    v_pk_mul_f32 v[40:41], v[40:41], v[4:5] op_sel_hi:[1,0]
    v_pk_mul_f32 v[42:43], v[42:43], v[4:5] op_sel_hi:[1,0]
    v_pk_mul_f32 v[44:45], v[44:45], v[4:5] op_sel_hi:[1,0]
    v_pk_mul_f32 v[46:47], v[46:47], v[4:5] op_sel_hi:[1,0]
    v_pk_mul_f32 v[48:49], v[48:49], v[4:5] op_sel_hi:[1,0]
    v_pk_mul_f32 v[50:51], v[50:51], v[4:5] op_sel_hi:[1,0]
    s_waitcnt vmcnt(27)
    v_pk_mul_f32 v[52:53], v[52:53], v[4:5] op_sel:[0,1] op_sel_hi:[1,1]
    v_pk_mul_f32 v[54:55], v[54:55], v[4:5] op_sel:[0,1] op_sel_hi:[1,1]
    v_pk_mul_f32 v[56:57], v[56:57], v[4:5] op_sel:[0,1] op_sel_hi:[1,1]
    v_pk_mul_f32 v[58:59], v[58:59], v[4:5] op_sel:[0,1] op_sel_hi:[1,1]
    v_pk_mul_f32 v[60:61], v[60:61], v[4:5] op_sel:[0,1] op_sel_hi:[1,1]
    v_pk_mul_f32 v[62:63], v[62:63], v[4:5] op_sel:[0,1] op_sel_hi:[1,1]
    v_pk_mul_f32 v[64:65], v[64:65], v[4:5] op_sel:[0,1] op_sel_hi:[1,1]
    v_pk_mul_f32 v[66:67], v[66:67], v[4:5] op_sel:[0,1] op_sel_hi:[1,1]
    v_pk_mul_f32 v[68:69], v[68:69], v[4:5] op_sel:[0,1] op_sel_hi:[1,1]
    v_pk_mul_f32 v[70:71], v[70:71], v[4:5] op_sel:[0,1] op_sel_hi:[1,1]
    s_waitcnt vmcnt(26)
    v_pk_mul_f32 v[72:73], v[72:73], v[6:7] op_sel_hi:[1,0]
    v_pk_mul_f32 v[74:75], v[74:75], v[6:7] op_sel_hi:[1,0]
    v_pk_mul_f32 v[76:77], v[76:77], v[6:7] op_sel_hi:[1,0]
    v_pk_mul_f32 v[78:79], v[78:79], v[6:7] op_sel_hi:[1,0]
    v_pk_mul_f32 v[80:81], v[80:81], v[6:7] op_sel_hi:[1,0]
    v_pk_mul_f32 v[82:83], v[82:83], v[6:7] op_sel_hi:[1,0]
    v_pk_mul_f32 v[84:85], v[84:85], v[6:7] op_sel_hi:[1,0]
    v_pk_mul_f32 v[86:87], v[86:87], v[6:7] op_sel_hi:[1,0]
    v_pk_mul_f32 v[88:89], v[88:89], v[6:7] op_sel_hi:[1,0]
    v_pk_mul_f32 v[90:91], v[90:91], v[6:7] op_sel_hi:[1,0]
    s_waitcnt vmcnt(25)
    v_mfma_f32_16x16x32_bf16 v[32:35], a[52:55], a[24:27], v[32:35]
    s_add_u32 s7, s41, 45056
    buffer_load_dwordx2 a[232:233], v27, s[16:19], s7 offen sc1
    v_mfma_f32_16x16x32_bf16 v[36:39], a[56:59], a[24:27], v[36:39]
    buffer_load_dwordx2 a[234:235], v27, s[16:19], s7 offen offset:512 sc1
    v_mfma_f32_16x16x32_bf16 v[40:43], a[60:63], a[24:27], v[40:43]
    v_mfma_f32_16x16x32_bf16 v[44:47], a[64:67], a[24:27], v[44:47]
    v_mfma_f32_16x16x32_bf16 v[48:51], a[68:71], a[24:27], v[48:51]
    s_waitcnt vmcnt(26)
    v_mfma_f32_16x16x32_bf16 v[52:55], a[52:55], a[28:31], v[52:55]
    v_mfma_f32_16x16x32_bf16 v[56:59], a[56:59], a[28:31], v[56:59]
    v_mfma_f32_16x16x32_bf16 v[60:63], a[60:63], a[28:31], v[60:63]
    v_mfma_f32_16x16x32_bf16 v[64:67], a[64:67], a[28:31], v[64:67]
    v_mfma_f32_16x16x32_bf16 v[68:71], a[68:71], a[28:31], v[68:71]
    s_waitcnt vmcnt(25)
    v_mfma_f32_16x16x32_bf16 v[72:75], a[52:55], a[32:35], v[72:75]
    v_mfma_f32_16x16x32_bf16 v[76:79], a[56:59], a[32:35], v[76:79]
    v_mfma_f32_16x16x32_bf16 v[80:83], a[60:63], a[32:35], v[80:83]
    v_mfma_f32_16x16x32_bf16 v[84:87], a[64:67], a[32:35], v[84:87]
    v_mfma_f32_16x16x32_bf16 v[88:91], a[68:71], a[32:35], v[88:91]
    s_waitcnt vmcnt(24)
    v_mfma_f32_16x16x32_bf16 v[32:35], a[72:75], a[200:203], v[32:35]
    v_mfma_f32_16x16x32_bf16 v[36:39], a[76:79], a[200:203], v[36:39]
    v_mfma_f32_16x16x32_bf16 v[40:43], a[80:83], a[200:203], v[40:43]
    v_mfma_f32_16x16x32_bf16 v[44:47], a[84:87], a[200:203], v[44:47]
    v_mfma_f32_16x16x32_bf16 v[48:51], a[88:91], a[200:203], v[48:51]
    s_waitcnt vmcnt(23)
    v_mfma_f32_16x16x32_bf16 v[52:55], a[72:75], a[204:207], v[52:55]
    v_mfma_f32_16x16x32_bf16 v[56:59], a[76:79], a[204:207], v[56:59]
    v_mfma_f32_16x16x32_bf16 v[60:63], a[80:83], a[204:207], v[60:63]
    v_mfma_f32_16x16x32_bf16 v[64:67], a[84:87], a[204:207], v[64:67]
    v_mfma_f32_16x16x32_bf16 v[68:71], a[88:91], a[204:207], v[68:71]
    s_waitcnt vmcnt(22)
    v_mfma_f32_16x16x32_bf16 v[72:75], a[72:75], a[208:211], v[72:75]
    v_mfma_f32_16x16x32_bf16 v[76:79], a[76:79], a[208:211], v[76:79]
    v_mfma_f32_16x16x32_bf16 v[80:83], a[80:83], a[208:211], v[80:83]
    v_mfma_f32_16x16x32_bf16 v[84:87], a[84:87], a[208:211], v[84:87]
    v_mfma_f32_16x16x32_bf16 v[88:91], a[88:91], a[208:211], v[88:91]
    s_waitcnt vmcnt(21)
    v_mfma_f32_16x16x32_bf16 v[32:35], a[92:95], a[212:215], v[32:35]
    v_mfma_f32_16x16x32_bf16 v[36:39], a[96:99], a[212:215], v[36:39]
    v_mfma_f32_16x16x32_bf16 v[40:43], a[100:103], a[212:215], v[40:43]
    v_mfma_f32_16x16x32_bf16 v[44:47], a[104:107], a[212:215], v[44:47]
    v_mfma_f32_16x16x32_bf16 v[48:51], a[108:111], a[212:215], v[48:51]
    s_waitcnt vmcnt(20)
    v_mfma_f32_16x16x32_bf16 v[52:55], a[92:95], a[216:219], v[52:55]
    v_mfma_f32_16x16x32_bf16 v[56:59], a[96:99], a[216:219], v[56:59]
    v_mfma_f32_16x16x32_bf16 v[60:63], a[100:103], a[216:219], v[60:63]
    v_mfma_f32_16x16x32_bf16 v[64:67], a[104:107], a[216:219], v[64:67]
    v_mfma_f32_16x16x32_bf16 v[68:71], a[108:111], a[216:219], v[68:71]
    s_waitcnt vmcnt(19)
    v_mfma_f32_16x16x32_bf16 v[72:75], a[92:95], a[36:39], v[72:75]
    v_mfma_f32_16x16x32_bf16 v[76:79], a[96:99], a[36:39], v[76:79]
    v_mfma_f32_16x16x32_bf16 v[80:83], a[100:103], a[36:39], v[80:83]
    v_mfma_f32_16x16x32_bf16 v[84:87], a[104:107], a[36:39], v[84:87]
    v_mfma_f32_16x16x32_bf16 v[88:91], a[108:111], a[36:39], v[88:91]
    s_waitcnt vmcnt(13)
    v_mfma_f32_16x16x32_bf16 v[32:35], a[112:115], a[40:43], v[32:35]
    v_mfma_f32_16x16x32_bf16 v[36:39], a[116:119], a[40:43], v[36:39]
    v_mfma_f32_16x16x32_bf16 v[40:43], a[120:123], a[40:43], v[40:43]
    v_mfma_f32_16x16x32_bf16 v[44:47], a[124:127], a[40:43], v[44:47]
    v_mfma_f32_16x16x32_bf16 v[48:51], a[128:131], a[40:43], v[48:51]
    s_waitcnt vmcnt(12)
    v_mfma_f32_16x16x32_bf16 v[52:55], a[112:115], a[44:47], v[52:55]
    v_mfma_f32_16x16x32_bf16 v[56:59], a[116:119], a[44:47], v[56:59]
    v_mfma_f32_16x16x32_bf16 v[60:63], a[120:123], a[44:47], v[60:63]
    v_mfma_f32_16x16x32_bf16 v[64:67], a[124:127], a[44:47], v[64:67]
    v_mfma_f32_16x16x32_bf16 v[68:71], a[128:131], a[44:47], v[68:71]
    s_waitcnt vmcnt(11)
    v_mfma_f32_16x16x32_bf16 v[72:75], a[112:115], a[220:223], v[72:75]
    v_mfma_f32_16x16x32_bf16 v[76:79], a[116:119], a[220:223], v[76:79]
    v_mfma_f32_16x16x32_bf16 v[80:83], a[120:123], a[220:223], v[80:83]
    v_mfma_f32_16x16x32_bf16 v[84:87], a[124:127], a[220:223], v[84:87]
    v_mfma_f32_16x16x32_bf16 v[88:91], a[128:131], a[220:223], v[88:91]
    s_waitcnt vmcnt(4)
    v_mfma_f32_16x16x32_bf16 v[32:35], a[132:135], a[224:227], v[32:35]
    v_mfma_f32_16x16x32_bf16 v[36:39], a[136:139], a[224:227], v[36:39]
    v_mfma_f32_16x16x32_bf16 v[40:43], a[140:143], a[224:227], v[40:43]
    v_mfma_f32_16x16x32_bf16 v[44:47], a[144:147], a[224:227], v[44:47]
    v_mfma_f32_16x16x32_bf16 v[48:51], a[148:151], a[224:227], v[48:51]
    s_waitcnt vmcnt(2)
    v_mfma_f32_16x16x32_bf16 v[52:55], a[132:135], a[228:231], v[52:55]
    s_nop 1
    ds_write_b128 v29, v[32:35] offset:0
    v_mfma_f32_16x16x32_bf16 v[56:59], a[136:139], a[228:231], v[56:59]
    ds_write_b128 v29, v[36:39] offset:32
    v_mfma_f32_16x16x32_bf16 v[60:63], a[140:143], a[228:231], v[60:63]
    ds_write_b128 v29, v[40:43] offset:64
    v_mfma_f32_16x16x32_bf16 v[64:67], a[144:147], a[228:231], v[64:67]
    ds_write_b128 v29, v[44:47] offset:96
    v_mfma_f32_16x16x32_bf16 v[68:71], a[148:151], a[228:231], v[68:71]
    s_waitcnt vmcnt(0)
    ds_write_b128 v29, v[48:51] offset:128
    v_mfma_f32_16x16x32_bf16 v[72:75], a[132:135], a[232:235], v[72:75]
    ds_write_b128 v29, v[52:55] offset:2560
    v_mfma_f32_16x16x32_bf16 v[76:79], a[136:139], a[232:235], v[76:79]
    ds_write_b128 v29, v[56:59] offset:2592
    v_mfma_f32_16x16x32_bf16 v[80:83], a[140:143], a[232:235], v[80:83]
    ds_write_b128 v29, v[60:63] offset:2624
    v_mfma_f32_16x16x32_bf16 v[84:87], a[144:147], a[232:235], v[84:87]
    ds_write_b128 v29, v[64:67] offset:2656
    v_mfma_f32_16x16x32_bf16 v[88:91], a[148:151], a[232:235], v[88:91]
    ds_write_b128 v29, v[68:71] offset:2688
    ds_write_b128 v29, v[72:75] offset:5120
    ds_write_b128 v29, v[76:79] offset:5152
    s_nop 0
    ds_write_b128 v29, v[80:83] offset:5184
    s_nop 0
    ds_write_b128 v29, v[84:87] offset:5216
    s_nop 0
    ds_write_b128 v29, v[88:91] offset:5248
    s_waitcnt lgkmcnt(0)
    s_barrier
    v_add_u32 v31, 81920, v14
    ds_read_b128 v[32:35], v14 offset:0
    ds_read_b128 v[36:39], v14 offset:7680
    ds_read_b128 v[40:43], v14 offset:40960
    ds_read_b128 v[44:47], v14 offset:48640
    ds_read_b128 v[48:51], v31 offset:0
    ds_read_b128 v[52:55], v31 offset:7680
    ds_read_b128 v[56:59], v31 offset:40960
    ds_read_b128 v[60:63], v31 offset:48640
    v_add_u32 v31, 81920, v15
    ds_read_b128 v[64:67], v15 offset:0
    ds_read_b128 v[68:71], v15 offset:7680
    ds_read_b128 v[72:75], v15 offset:40960
    ds_read_b128 v[76:79], v15 offset:48640
    ds_read_b128 v[80:83], v31 offset:0
    ds_read_b128 v[84:87], v31 offset:7680
    ds_read_b128 v[88:91], v31 offset:40960
    ds_read_b128 v[92:95], v31 offset:48640
    s_waitcnt lgkmcnt(12)
    v_pk_add_f32 v[32:33], v[32:33], v[40:41]
    v_pk_add_f32 v[34:35], v[34:35], v[42:43]
    v_pk_add_f32 v[36:37], v[36:37], v[44:45]
    v_pk_add_f32 v[38:39], v[38:39], v[46:47]
    s_waitcnt lgkmcnt(8)
    v_pk_add_f32 v[48:49], v[48:49], v[56:57]
    v_pk_add_f32 v[50:51], v[50:51], v[58:59]
    v_pk_add_f32 v[52:53], v[52:53], v[60:61]
    v_pk_add_f32 v[54:55], v[54:55], v[62:63]
    v_pk_add_f32 v[32:33], v[32:33], v[48:49]
    v_pk_add_f32 v[34:35], v[34:35], v[50:51]
    v_pk_add_f32 v[36:37], v[36:37], v[52:53]
    v_pk_add_f32 v[38:39], v[38:39], v[54:55]
    v_cvt_pk_bf16_f32 v40, v32, v33
    v_cvt_pk_bf16_f32 v41, v34, v35
    v_cvt_pk_bf16_f32 v42, v36, v37
    v_cvt_pk_bf16_f32 v43, v38, v39
    buffer_store_dwordx4 v[40:43], v10, s[24:27], s43 offen nt
    s_waitcnt lgkmcnt(4)
    v_pk_add_f32 v[64:65], v[64:65], v[72:73]
    v_pk_add_f32 v[66:67], v[66:67], v[74:75]
    v_pk_add_f32 v[68:69], v[68:69], v[76:77]
    v_pk_add_f32 v[70:71], v[70:71], v[78:79]
    s_waitcnt lgkmcnt(0)
    v_pk_add_f32 v[80:81], v[80:81], v[88:89]
    v_pk_add_f32 v[82:83], v[82:83], v[90:91]
    v_pk_add_f32 v[84:85], v[84:85], v[92:93]
    v_pk_add_f32 v[86:87], v[86:87], v[94:95]
    v_pk_add_f32 v[64:65], v[64:65], v[80:81]
    v_pk_add_f32 v[66:67], v[66:67], v[82:83]
    v_pk_add_f32 v[68:69], v[68:69], v[84:85]
    v_pk_add_f32 v[70:71], v[70:71], v[86:87]
    v_cvt_pk_bf16_f32 v72, v64, v65
    v_cvt_pk_bf16_f32 v73, v66, v67
    v_cvt_pk_bf16_f32 v74, v68, v69
    v_cvt_pk_bf16_f32 v75, v70, v71
    buffer_store_dwordx4 v[72:75], v11, s[24:27], s43 offen nt
    s_endpgm
L_h:
    s_mov_b32 m0, s96
    v_and_b32 v8, 1, v6
    v_lshlrev_b32 v8, 1, v8
    v_xor_b32 v8, v5, v8
    v_mul_u32_u24 v7, 3072, v4
    v_lshl_add_u32 v3, v8, 4, v7
    v_xor_b32 v24, 64, v3
    v_add_u32 v224, 3200, v3
    v_add_u32 v225, 2304, v3
    v_add_u32 v226, 28800, v24
    v_add_u32 v227, 27904, v24
    v_add_u32 v24, 25600, v24
    v_add_u32 v3, 4096, v3
    s_mul_i32 s35, s5, 384
    s_mul_i32 s39, s3, 49152
    s_add_u32 s35, s35, s39
    s_mul_i32 s37, s6, 196608
    s_add_u32 s37, s37, s35
    s_mul_i32 s97, s3, 6144
    s_add_u32 s97, s97, 49152
    s_waitcnt lgkmcnt(0)
    s_mov_b64 s[8:9], s[40:41]
    s_mov_b32 s10, 2621440
    s_mov_b32 s11, 0x20000
    buffer_load_dwordx4 v1, s[8:11], s36 offen offset:0 lds
    buffer_load_dwordx4 v2, s[8:11], s36 offen offset:1024 lds
    buffer_load_dwordx4 v30, s[8:11], s36 offen offset:2048 lds
    buffer_load_dwordx4 v31, s[8:11], s36 offen offset:3072 lds
    s_sub_u32 s12, s48, 4096
    s_subb_u32 s13, s49, 0
    s_mov_b32 s14, 1970176
    s_mov_b32 s15, 0x20000
    s_add_u32 m0, s97, 0
    s_nop 0
    buffer_load_dwordx4 v3, s[12:15], s37 offen offset:0 lds
    buffer_load_dwordx4 v224, s[12:15], s37 offen offset:1024 lds
    buffer_load_dwordx4 v225, s[12:15], s37 offen offset:2048 lds
    buffer_load_dwordx4 v24, s[12:15], s37 offen offset:3072 lds
    s_add_u32 m0, s97, 4096
    s_nop 0
    buffer_load_dwordx4 v226, s[12:15], s37 offen offset:0 lds
    buffer_load_dwordx4 v227, s[12:15], s37 offen offset:1024 lds
    s_mov_b64 s[24:25], s[50:51]
    s_mov_b32 s26, 3072
    s_mov_b32 s27, 0x20000
    s_and_b32 s38, s3, 1
    s_mul_i32 s38, s38, 192
    s_mul_i32 s39, s5, 384
    s_add_u32 s38, s38, s39
    s_lshl_b32 s39, s3, 13
    s_add_u32 s39, s39, 122880
    s_mov_b32 m0, s39
    v_lshlrev_b32 v27, 4, v20
    v_lshrrev_b32 v28, 4, v20
    v_lshl_add_u32 v28, v28, 3, s39
    s_mov_b64 exec, 0xfff
    buffer_load_dwordx4 v27, s[24:27], s38 offen lds
    s_mov_b64 exec, -1
    s_mov_b64 s[16:17], s[60:61]
    s_mov_b32 s18, 268435456
    s_mov_b32 s19, 0x20000
    s_mov_b64 s[24:25], s[50:51]
    s_mov_b32 s26, 3072
    s_mov_b32 s27, 0x20000
    s_mov_b64 s[28:29], s[58:59]
    s_mov_b32 s30, 256
    s_mov_b32 s31, 0x20000
    v_lshlrev_b32 v21, 4, v20
    v_mov_b32 v22, 1
    v_mov_b32 v23, 0
    s_cmp_lg_u32 s4, 0
    s_cbranch_scc1 L_nz_13
    v_mov_b32 v32, 0
    v_mov_b32 v33, 0
    v_mov_b32 v34, 0
    v_mov_b32 v35, 0
    v_lshlrev_b32 v36, 4, v0
    s_mul_i32 s7, s3, 24
    v_add_u32 v37, s7, v20
    v_lshlrev_b32 v37, 7, v37
    s_lshl_b32 s7, s5, 13
    s_add_u32 s38, s7, 131072
    s_add_u32 s39, s38, 4096
    s_mul_i32 s7, s5, 12288
    buffer_store_dwordx4 v[32:35], v36, s[16:19], s38 offen sc1
    buffer_store_dwordx4 v[32:35], v36, s[16:19], s39 offen sc1
    s_mov_b64 exec, 0xffffff
    buffer_store_dword v32, v37, s[16:19], s7 offen sc1
    s_mov_b64 exec, -1
L_nz_13:
    s_lshl_b32 s40, s4, 3
    s_add_u32 s40, s40, s5
    s_mov_b64 s[62:63], s[52:53]
    s_mul_hi_u32 s7, s40, 0x55555556
    s_mul_i32 s38, s7, 3
    s_sub_u32 s38, s40, s38
    s_lshl_b32 s38, s38, 2
    s_add_u32 s38, s38, s3
    s_add_u32 s38, s38, 12
    s_mul_hi_u32 s39, s7, 0x1999999A
    s_mul_i32 s98, s39, 10
    s_sub_u32 s98, s7, s98
    s_cmp_lt_u32 s40, 120
    s_cselect_b32 s52, s38, 17
    s_sub_u32 s99, s38, 12
    s_and_b32 s7, s99, 1
    s_lshl_b32 s7, s7, 5
    s_lshr_b32 s53, s99, 1
    s_mul_i32 s53, s53, 80
    s_add_u32 s53, s53, s7
    s_mov_b32 s55, 102400
    s_cmp_eq_u32 s99, 4
    s_cselect_b32 s53, 64, s53
    s_cselect_b32 s55, s55, 20480
    s_mul_i32 s7, s39, 160
    s_add_u32 s53, s53, s7
    s_mul_i32 s7, s39, 5
    s_add_u32 s99, s99, s7
    s_add_u32 s99, s99, 48
    s_mul_i32 s7, s39, 12
    s_add_u32 s7, s7, s38
    s_lshl_b32 s39, s7, 5
    s_mov_b32 s60, 10240
    s_cmp_lt_u32 s38, 12
    s_cselect_b32 s99, s7, s99
    s_cselect_b32 s53, s39, s53
    s_cselect_b32 s55, 20480, s55
    s_cselect_b32 s60, s60, 10240
    s_mul_i32 s53, s53, 1280
    s_lshl_b32 s7, s98, 7
    s_add_u32 s53, s53, s7
    s_mul_i32 s99, s99, 5
    s_lshl_b32 s98, s98, 2
    s_add_u32 s7, s98, 0
    s_mul_hi_u32 s38, s7, 0x33333334
    s_mul_i32 s38, s38, 335
    s_add_u32 s7, s7, s38
    s_add_u32 s7, s7, s99
    s_lshl_b32 s7, s7, 10
    s_add_u32 s61, s7, 1048576
    s_add_u32 s7, s98, 1
    s_mul_hi_u32 s38, s7, 0x33333334
    s_mul_i32 s38, s38, 335
    s_add_u32 s7, s7, s38
    s_add_u32 s7, s7, s99
    s_lshl_b32 s7, s7, 10
    s_add_u32 s100, s7, 1048576
    s_add_u32 s7, s98, 2
    s_mul_hi_u32 s38, s7, 0x33333334
    s_mul_i32 s38, s38, 335
    s_add_u32 s7, s7, s38
    s_add_u32 s7, s7, s99
    s_lshl_b32 s7, s7, 10
    s_add_u32 s101, s7, 1048576
    s_add_u32 s7, s98, 3
    s_mul_hi_u32 s38, s7, 0x33333334
    s_mul_i32 s38, s38, 335
    s_add_u32 s7, s7, s38
    s_add_u32 s7, s7, s99
    s_lshl_b32 s7, s7, 10
    s_add_u32 s46, s7, 1048576
    s_mul_hi_u32 s7, s40, 0x55555556
    s_mul_i32 s38, s7, 3
    s_sub_u32 s38, s40, s38
    s_lshl_b32 s38, s38, 2
    s_add_u32 s38, s38, s3
    s_mul_hi_u32 s39, s7, 0x1999999A
    s_mul_i32 s98, s39, 10
    s_sub_u32 s98, s7, s98
    s_cmp_lt_u32 s40, 120
    s_cselect_b32 s41, s38, 17
    s_sub_u32 s99, s38, 12
    s_and_b32 s7, s99, 1
    s_lshl_b32 s7, s7, 5
    s_lshr_b32 s42, s99, 1
    s_mul_i32 s42, s42, 80
    s_add_u32 s42, s42, s7
    s_mov_b32 s43, 102400
    s_cmp_eq_u32 s99, 4
    s_cselect_b32 s42, 64, s42
    s_cselect_b32 s43, s43, 20480
    s_mul_i32 s7, s39, 160
    s_add_u32 s42, s42, s7
    s_mul_i32 s7, s39, 5
    s_add_u32 s99, s99, s7
    s_add_u32 s99, s99, 48
    s_mul_i32 s7, s39, 12
    s_add_u32 s7, s7, s38
    s_lshl_b32 s39, s7, 5
    s_mov_b32 s47, 10240
    s_mov_b32 s22, 1966080
    s_cmp_lt_u32 s38, 12
    s_cselect_b32 s99, s7, s99
    s_cselect_b32 s42, s39, s42
    s_cselect_b32 s43, 20480, s43
    s_cselect_b32 s47, s47, 10240
    s_mov_b64 s[20:21], s[62:63]
    s_mov_b32 s23, 0x20000
    s_mul_i32 s42, s42, 1280
    s_lshl_b32 s7, s98, 7
    s_add_u32 s42, s42, s7
    s_mul_i32 s99, s99, 5
    s_lshl_b32 s98, s98, 2
    s_add_u32 s7, s98, 0
    s_mul_hi_u32 s38, s7, 0x33333334
    s_mul_i32 s38, s38, 335
    s_add_u32 s7, s7, s38
    s_add_u32 s7, s7, s99
    s_lshl_b32 s7, s7, 10
    s_add_u32 s50, s7, 1048576
    s_add_u32 s7, s98, 1
    s_mul_hi_u32 s38, s7, 0x33333334
    s_mul_i32 s38, s38, 335
    s_add_u32 s7, s7, s38
    s_add_u32 s7, s7, s99
    s_lshl_b32 s7, s7, 10
    s_add_u32 s51, s7, 1048576
    s_add_u32 s7, s98, 2
    s_mul_hi_u32 s38, s7, 0x33333334
    s_mul_i32 s38, s38, 335
    s_add_u32 s7, s7, s38
    s_add_u32 s7, s7, s99
    s_lshl_b32 s7, s7, 10
    s_add_u32 s58, s7, 1048576
    s_add_u32 s7, s98, 3
    s_mul_hi_u32 s38, s7, 0x33333334
    s_mul_i32 s38, s38, 335
    s_add_u32 s7, s7, s38
    s_add_u32 s7, s7, s99
    s_lshl_b32 s7, s7, 10
    s_add_u32 s59, s7, 1048576
    s_lshl_b32 s49, s3, 13
    s_add_u32 s49, s49, 122880
    v_lshrrev_b32 v240, 3, v20
    v_bfe_u32 v241, v20, 1, 2
    v_bfe_u32 v242, v20, 4, 2
    v_xor_b32 v241, v241, v242
    v_and_b32 v243, 1, v20
    v_lshl_add_u32 v241, v241, 1, v243
    v_mul_u32_u24 v240, 1280, v240
    v_lshl_add_u32 v239, v241, 4, v240
    v_lshrrev_b32 v240, 2, v20
    v_and_b32 v241, 3, v20
    v_lshlrev_b32 v241, 3, v241
    v_lshl_add_u32 v241, v240, 7, v241
    v_add_u32 v241, s49, v241
    v_bfe_u32 v240, v20, 3, 2
    v_xor_b32 v242, 0, v240
    v_lshl_add_u32 v235, v242, 5, v241
    v_xor_b32 v242, 1, v240
    v_lshl_add_u32 v236, v242, 5, v241
    v_xor_b32 v242, 2, v240
    v_lshl_add_u32 v237, v242, 5, v241
    v_xor_b32 v242, 3, v240
    v_lshl_add_u32 v238, v242, 5, v241
    s_mul_i32 s7, s33, 5
    s_lshr_b32 s7, s7, 2
    s_mul_i32 s38, s3, 10
    s_add_u32 s7, s7, s38
    s_mul_i32 s7, s7, 384
    s_add_u32 s7, s7, 49152
    v_min_u32 v231, 5, v20
    v_lshl_add_u32 v231, v231, 7, s7
    v_and_b32 v27, 15, v20
    v_lshrrev_b32 v29, 4, v20
    v_lshrrev_b32 v6, 1, v27
    v_xor_b32 v6, v6, v29
    s_lshr_b32 s7, s3, 1
    s_lshl_b32 s7, s7, 13
    v_lshl_add_u32 v27, v27, 7, s7
    v_lshl_add_u32 v4, v6, 4, v27
    v_xor_b32 v5, 64, v4
    v_bfe_u32 v27, v20, 2, 2
    v_and_b32 v6, 3, v20
    v_mul_u32_u24 v7, 3072, v29
    v_lshl_add_u32 v7, v27, 7, v7
    v_lshl_add_u32 v7, v6, 3, v7
    v_bfe_u32 v6, v20, 3, 2
    s_and_b32 s38, s3, 1
    s_mul_i32 s38, s38, 6
    s_add_u32 s7, s38, 0
    s_and_b32 s39, s7, 3
    s_lshr_b32 s7, s7, 2
    s_lshl_b32 s7, s7, 10
    s_add_u32 s7, s7, 49152
    v_xor_b32 v27, s39, v6
    v_lshl_add_u32 v27, v27, 5, v7
    v_add_u32 v8, s7, v27
    v_add_u32 v14, 49152, v8
    s_add_u32 s7, s38, 1
    s_and_b32 s39, s7, 3
    s_lshr_b32 s7, s7, 2
    s_lshl_b32 s7, s7, 10
    s_add_u32 s7, s7, 49152
    v_xor_b32 v27, s39, v6
    v_lshl_add_u32 v27, v27, 5, v7
    v_add_u32 v9, s7, v27
    v_add_u32 v15, 49152, v9
    s_add_u32 s7, s38, 2
    s_and_b32 s39, s7, 3
    s_lshr_b32 s7, s7, 2
    s_lshl_b32 s7, s7, 10
    s_add_u32 s7, s7, 49152
    v_xor_b32 v27, s39, v6
    v_lshl_add_u32 v27, v27, 5, v7
    v_add_u32 v10, s7, v27
    v_add_u32 v16, 49152, v10
    s_add_u32 s7, s38, 3
    s_and_b32 s39, s7, 3
    s_lshr_b32 s7, s7, 2
    s_lshl_b32 s7, s7, 10
    s_add_u32 s7, s7, 49152
    v_xor_b32 v27, s39, v6
    v_lshl_add_u32 v27, v27, 5, v7
    v_add_u32 v11, s7, v27
    v_add_u32 v17, 49152, v11
    s_add_u32 s7, s38, 4
    s_and_b32 s39, s7, 3
    s_lshr_b32 s7, s7, 2
    s_lshl_b32 s7, s7, 10
    s_add_u32 s7, s7, 49152
    v_xor_b32 v27, s39, v6
    v_lshl_add_u32 v27, v27, 5, v7
    v_add_u32 v12, s7, v27
    v_add_u32 v18, 49152, v12
    s_add_u32 s7, s38, 5
    s_and_b32 s39, s7, 3
    s_lshr_b32 s7, s7, 2
    s_lshl_b32 s7, s7, 10
    s_add_u32 s7, s7, 49152
    v_xor_b32 v27, s39, v6
    v_lshl_add_u32 v27, v27, 5, v7
    v_add_u32 v13, s7, v27
    v_add_u32 v19, 49152, v13
    s_add_u32 s36, s36, 128
    s_add_u32 s37, s37, 196608
    s_cmp_eq_u32 s36, s34
    s_cselect_b32 s37, s35, s37
    s_cselect_b32 s7, 1280, 0
    s_sub_u32 s36, s36, s7
    s_add_u32 m0, s96, 16384
    s_nop 0
    buffer_load_dwordx4 v1, s[8:11], s36 offen offset:0 lds
    buffer_load_dwordx4 v2, s[8:11], s36 offen offset:1024 lds
    buffer_load_dwordx4 v30, s[8:11], s36 offen offset:2048 lds
    buffer_load_dwordx4 v31, s[8:11], s36 offen offset:3072 lds
    s_add_u32 m0, s97, 24576
    s_nop 0
    buffer_load_dwordx4 v3, s[12:15], s37 offen offset:0 lds
    buffer_load_dwordx4 v224, s[12:15], s37 offen offset:1024 lds
    buffer_load_dwordx4 v225, s[12:15], s37 offen offset:2048 lds
    buffer_load_dwordx4 v24, s[12:15], s37 offen offset:3072 lds
    s_add_u32 m0, s97, 28672
    s_nop 0
    buffer_load_dwordx4 v226, s[12:15], s37 offen offset:0 lds
    buffer_load_dwordx4 v227, s[12:15], s37 offen offset:1024 lds
    s_waitcnt vmcnt(10)
    s_barrier
    ds_read_b64 v[130:131], v28 offset:0
    ds_read_b64 v[134:135], v28 offset:32
    ds_read_b64 v[138:139], v28 offset:64
    ds_read_b64 v[142:143], v28 offset:96
    ds_read_b64 v[146:147], v28 offset:128
    ds_read_b64 v[150:151], v28 offset:160
    ds_read_b128 v[160:163], v4 offset:0
    ds_read_b128 v[164:167], v4 offset:2048
    ds_read_b128 v[168:171], v4 offset:4096
    ds_read_b128 v[172:175], v4 offset:6144
    ds_read_b64_tr_b16 v[192:193], v8 offset:0
    ds_read_b64_tr_b16 v[194:195], v8 offset:512
    ds_read_b64_tr_b16 v[196:197], v9 offset:0
    ds_read_b64_tr_b16 v[198:199], v9 offset:512
    ds_read_b64_tr_b16 v[200:201], v10 offset:0
    ds_read_b64_tr_b16 v[202:203], v10 offset:512
    ds_read_b128 v[176:179], v5 offset:0
    s_waitcnt lgkmcnt(3)
    v_and_b32 v25, 7, v20
    v_lshlrev_b32 v25, 5, v25
    v_lshlrev_b32 v128, 16, v130
    v_and_b32 v129, 0xffff0000, v130
    v_lshlrev_b32 v130, 16, v131
    v_and_b32 v131, 0xffff0000, v131
    s_nop 1
    v_mfma_f32_16x16x32_bf16 v[32:35], v[192:195], v[160:163], v[128:131]
    ds_read_b64_tr_b16 v[204:205], v11 offset:0
    v_lshlrev_b32 v132, 16, v134
    v_mfma_f32_16x16x32_bf16 v[56:59], v[192:195], v[164:167], v[128:131]
    ds_read_b64_tr_b16 v[206:207], v11 offset:512
    v_and_b32 v133, 0xffff0000, v134
    v_mfma_f32_16x16x32_bf16 v[80:83], v[192:195], v[168:171], v[128:131]
    ds_read_b128 v[180:183], v5 offset:2048
    v_lshlrev_b32 v134, 16, v135
    v_mfma_f32_16x16x32_bf16 v[104:107], v[192:195], v[172:175], v[128:131]
    v_and_b32 v135, 0xffff0000, v135
    s_add_u32 s36, s36, 128
    s_nop 0
    v_mfma_f32_16x16x32_bf16 v[36:39], v[196:199], v[160:163], v[132:135]
    ds_read_b64_tr_b16 v[208:209], v12 offset:0
    s_add_u32 s37, s37, 196608
    v_mfma_f32_16x16x32_bf16 v[60:63], v[196:199], v[164:167], v[132:135]
    ds_read_b64_tr_b16 v[210:211], v12 offset:512
    s_cmp_eq_u32 s36, s34
    v_mfma_f32_16x16x32_bf16 v[84:87], v[196:199], v[168:171], v[132:135]
    ds_read_b128 v[184:187], v5 offset:4096
    s_cselect_b32 s37, s35, s37
    v_mfma_f32_16x16x32_bf16 v[108:111], v[196:199], v[172:175], v[132:135]
    s_waitcnt lgkmcnt(4)
    s_cselect_b32 s7, 1280, 0
    s_sub_u32 s36, s36, s7
    s_add_u32 m0, s96, 32768
    s_nop 0
    buffer_load_dwordx4 v1, s[8:11], s36 offen offset:0 lds
    v_lshlrev_b32 v136, 16, v138
    v_and_b32 v137, 0xffff0000, v138
    v_lshlrev_b32 v138, 16, v139
    v_and_b32 v139, 0xffff0000, v139
    s_nop 1
    v_mfma_f32_16x16x32_bf16 v[40:43], v[200:203], v[160:163], v[136:139]
    ds_read_b64_tr_b16 v[212:213], v13 offset:0
    buffer_load_dwordx4 v2, s[8:11], s36 offen offset:1024 lds
    v_mfma_f32_16x16x32_bf16 v[64:67], v[200:203], v[164:167], v[136:139]
    ds_read_b64_tr_b16 v[214:215], v13 offset:512
    buffer_load_dwordx4 v30, s[8:11], s36 offen offset:2048 lds
    v_mfma_f32_16x16x32_bf16 v[88:91], v[200:203], v[168:171], v[136:139]
    ds_read_b128 v[188:191], v5 offset:6144
    v_lshlrev_b32 v140, 16, v142
    v_mfma_f32_16x16x32_bf16 v[112:115], v[200:203], v[172:175], v[136:139]
    v_and_b32 v141, 0xffff0000, v142
    v_lshlrev_b32 v142, 16, v143
    v_and_b32 v143, 0xffff0000, v143
    s_nop 1
    v_mfma_f32_16x16x32_bf16 v[44:47], v[204:207], v[160:163], v[140:143]
    ds_read_b64_tr_b16 v[192:193], v8 offset:12288
    buffer_load_dwordx4 v31, s[8:11], s36 offen offset:3072 lds
    v_mfma_f32_16x16x32_bf16 v[68:71], v[204:207], v[164:167], v[140:143]
    v_lshlrev_b32 v144, 16, v146
    v_and_b32 v145, 0xffff0000, v146
    v_mfma_f32_16x16x32_bf16 v[92:95], v[204:207], v[168:171], v[140:143]
    ds_read_b64_tr_b16 v[194:195], v8 offset:12800
    v_lshlrev_b32 v146, 16, v147
    v_mfma_f32_16x16x32_bf16 v[116:119], v[204:207], v[172:175], v[140:143]
    s_waitcnt lgkmcnt(3)
    v_and_b32 v147, 0xffff0000, v147
    s_nop 1
    v_mfma_f32_16x16x32_bf16 v[48:51], v[208:211], v[160:163], v[144:147]
    ds_read_b64_tr_b16 v[196:197], v9 offset:12288
    s_add_u32 m0, s97, 49152
    v_mfma_f32_16x16x32_bf16 v[72:75], v[208:211], v[164:167], v[144:147]
    buffer_load_dwordx4 v3, s[12:15], s37 offen offset:0 lds
    v_lshlrev_b32 v148, 16, v150
    v_mfma_f32_16x16x32_bf16 v[96:99], v[208:211], v[168:171], v[144:147]
    ds_read_b64_tr_b16 v[198:199], v9 offset:12800
    v_and_b32 v149, 0xffff0000, v150
    v_mfma_f32_16x16x32_bf16 v[120:123], v[208:211], v[172:175], v[144:147]
    v_lshlrev_b32 v150, 16, v151
    v_and_b32 v151, 0xffff0000, v151
    s_nop 1
    v_mfma_f32_16x16x32_bf16 v[52:55], v[212:215], v[160:163], v[148:151]
    ds_read_b64_tr_b16 v[200:201], v10 offset:12288
    buffer_load_dwordx4 v224, s[12:15], s37 offen offset:1024 lds
    v_mfma_f32_16x16x32_bf16 v[76:79], v[212:215], v[164:167], v[148:151]
    buffer_load_dwordx4 v225, s[12:15], s37 offen offset:2048 lds
    v_mfma_f32_16x16x32_bf16 v[100:103], v[212:215], v[168:171], v[148:151]
    ds_read_b64_tr_b16 v[202:203], v10 offset:12800
    v_mfma_f32_16x16x32_bf16 v[124:127], v[212:215], v[172:175], v[148:151]
    s_waitcnt lgkmcnt(2)
    buffer_load_dwordx4 v24, s[12:15], s37 offen offset:3072 lds
    v_mfma_f32_16x16x32_bf16 v[32:35], v[192:195], v[176:179], v[32:35]
    ds_read_b64_tr_b16 v[204:205], v11 offset:12288
    v_mfma_f32_16x16x32_bf16 v[56:59], v[192:195], v[180:183], v[56:59]
    v_mfma_f32_16x16x32_bf16 v[80:83], v[192:195], v[184:187], v[80:83]
    ds_read_b64_tr_b16 v[206:207], v11 offset:12800
    s_add_u32 m0, s97, 53248
    v_mfma_f32_16x16x32_bf16 v[104:107], v[192:195], v[188:191], v[104:107]
    v_mfma_f32_16x16x32_bf16 v[36:39], v[196:199], v[176:179], v[36:39]
    ds_read_b64_tr_b16 v[208:209], v12 offset:12288
    buffer_load_dwordx4 v226, s[12:15], s37 offen offset:0 lds
    v_mfma_f32_16x16x32_bf16 v[60:63], v[196:199], v[180:183], v[60:63]
    v_mfma_f32_16x16x32_bf16 v[84:87], v[196:199], v[184:187], v[84:87]
    ds_read_b64_tr_b16 v[210:211], v12 offset:12800
    v_mfma_f32_16x16x32_bf16 v[108:111], v[196:199], v[188:191], v[108:111]
    s_waitcnt lgkmcnt(2)
    buffer_load_dwordx4 v227, s[12:15], s37 offen offset:1024 lds
    v_mfma_f32_16x16x32_bf16 v[40:43], v[200:203], v[176:179], v[40:43]
    ds_read_b64_tr_b16 v[212:213], v13 offset:12288
    v_mfma_f32_16x16x32_bf16 v[64:67], v[200:203], v[180:183], v[64:67]
    v_mfma_f32_16x16x32_bf16 v[88:91], v[200:203], v[184:187], v[88:91]
    ds_read_b64_tr_b16 v[214:215], v13 offset:12800
    v_mfma_f32_16x16x32_bf16 v[112:115], v[200:203], v[188:191], v[112:115]
    s_waitcnt vmcnt(10) lgkmcnt(0)
    s_barrier
    s_cmp_lg_u32 s4, 0
    s_cbranch_scc1 L_ni_14
    s_cmp_lg_u32 s3, 0
    s_cbranch_scc1 L_nf_15
    s_lshl_b32 s7, s5, 5
    s_mov_b64 exec, 1
    buffer_store_dword v22, v23, s[28:31], s7 offen sc1
    s_mov_b64 exec, -1
L_nf_15:
L_ni_14:
    v_mfma_f32_16x16x32_bf16 v[44:47], v[204:207], v[176:179], v[44:47]
    ds_read_b128 v[160:163], v4 offset:16384
    ds_read_b128 v[164:167], v4 offset:18432
    v_mfma_f32_16x16x32_bf16 v[68:71], v[204:207], v[180:183], v[68:71]
    ds_read_b128 v[168:171], v4 offset:20480
    s_add_u32 s36, s36, 128
    v_mfma_f32_16x16x32_bf16 v[92:95], v[204:207], v[184:187], v[92:95]
    ds_read_b128 v[172:175], v4 offset:22528
    ds_read_b64_tr_b16 v[192:193], v8 offset:24576
    v_mfma_f32_16x16x32_bf16 v[116:119], v[204:207], v[188:191], v[116:119]
    ds_read_b64_tr_b16 v[194:195], v8 offset:25088
    s_add_u32 s37, s37, 196608
    v_mfma_f32_16x16x32_bf16 v[48:51], v[208:211], v[176:179], v[48:51]
    ds_read_b64_tr_b16 v[196:197], v9 offset:24576
    s_cmp_eq_u32 s36, s34
    v_mfma_f32_16x16x32_bf16 v[72:75], v[208:211], v[180:183], v[72:75]
    s_cselect_b32 s37, s35, s37
    s_cselect_b32 s7, 1280, 0
    v_mfma_f32_16x16x32_bf16 v[96:99], v[208:211], v[184:187], v[96:99]
    ds_read_b64_tr_b16 v[198:199], v9 offset:25088
    s_sub_u32 s36, s36, s7
    v_mfma_f32_16x16x32_bf16 v[120:123], v[208:211], v[188:191], v[120:123]
    s_add_u32 m0, s96, 0
    s_nop 0
    buffer_load_dwordx4 v1, s[8:11], s36 offen offset:0 lds
    v_mfma_f32_16x16x32_bf16 v[52:55], v[212:215], v[176:179], v[52:55]
    ds_read_b64_tr_b16 v[200:201], v10 offset:24576
    buffer_load_dwordx4 v2, s[8:11], s36 offen offset:1024 lds
    v_mfma_f32_16x16x32_bf16 v[76:79], v[212:215], v[180:183], v[76:79]
    ds_read_b64_tr_b16 v[202:203], v10 offset:25088
    buffer_load_dwordx4 v30, s[8:11], s36 offen offset:2048 lds
    v_mfma_f32_16x16x32_bf16 v[100:103], v[212:215], v[184:187], v[100:103]
    ds_read_b128 v[176:179], v5 offset:16384
    v_mfma_f32_16x16x32_bf16 v[124:127], v[212:215], v[188:191], v[124:127]
    s_waitcnt lgkmcnt(3)
    v_mfma_f32_16x16x32_bf16 v[32:35], v[192:195], v[160:163], v[32:35]
    ds_read_b64_tr_b16 v[204:205], v11 offset:24576
    buffer_load_dwordx4 v31, s[8:11], s36 offen offset:3072 lds
    v_mfma_f32_16x16x32_bf16 v[56:59], v[192:195], v[164:167], v[56:59]
    ds_read_b64_tr_b16 v[206:207], v11 offset:25088
    v_mfma_f32_16x16x32_bf16 v[80:83], v[192:195], v[168:171], v[80:83]
    ds_read_b128 v[180:183], v5 offset:18432
    v_mfma_f32_16x16x32_bf16 v[104:107], v[192:195], v[172:175], v[104:107]
    s_add_u32 m0, s97, 0
    v_mfma_f32_16x16x32_bf16 v[36:39], v[196:199], v[160:163], v[36:39]
    ds_read_b64_tr_b16 v[208:209], v12 offset:24576
    v_mfma_f32_16x16x32_bf16 v[60:63], v[196:199], v[164:167], v[60:63]
    ds_read_b64_tr_b16 v[210:211], v12 offset:25088
    v_mfma_f32_16x16x32_bf16 v[84:87], v[196:199], v[168:171], v[84:87]
    ds_read_b128 v[184:187], v5 offset:20480
    buffer_load_dwordx4 v3, s[12:15], s37 offen offset:0 lds
    v_mfma_f32_16x16x32_bf16 v[108:111], v[196:199], v[172:175], v[108:111]
    s_waitcnt lgkmcnt(4)
    v_mfma_f32_16x16x32_bf16 v[40:43], v[200:203], v[160:163], v[40:43]
    ds_read_b64_tr_b16 v[212:213], v13 offset:24576
    v_mfma_f32_16x16x32_bf16 v[64:67], v[200:203], v[164:167], v[64:67]
    ds_read_b64_tr_b16 v[214:215], v13 offset:25088
    buffer_load_dwordx4 v224, s[12:15], s37 offen offset:1024 lds
    v_mfma_f32_16x16x32_bf16 v[88:91], v[200:203], v[168:171], v[88:91]
    ds_read_b128 v[188:191], v5 offset:22528
    v_mfma_f32_16x16x32_bf16 v[112:115], v[200:203], v[172:175], v[112:115]
    v_mfma_f32_16x16x32_bf16 v[44:47], v[204:207], v[160:163], v[44:47]
    ds_read_b64_tr_b16 v[192:193], v8 offset:36864
    buffer_load_dwordx4 v225, s[12:15], s37 offen offset:2048 lds
    v_mfma_f32_16x16x32_bf16 v[68:71], v[204:207], v[164:167], v[68:71]
    v_mfma_f32_16x16x32_bf16 v[92:95], v[204:207], v[168:171], v[92:95]
    ds_read_b64_tr_b16 v[194:195], v8 offset:37376
    v_mfma_f32_16x16x32_bf16 v[116:119], v[204:207], v[172:175], v[116:119]
    s_waitcnt lgkmcnt(3)
    buffer_load_dwordx4 v24, s[12:15], s37 offen offset:3072 lds
    v_mfma_f32_16x16x32_bf16 v[48:51], v[208:211], v[160:163], v[48:51]
    ds_read_b64_tr_b16 v[196:197], v9 offset:36864
    v_mfma_f32_16x16x32_bf16 v[72:75], v[208:211], v[164:167], v[72:75]
    v_mfma_f32_16x16x32_bf16 v[96:99], v[208:211], v[168:171], v[96:99]
    ds_read_b64_tr_b16 v[198:199], v9 offset:37376
    s_add_u32 m0, s97, 4096
    v_mfma_f32_16x16x32_bf16 v[120:123], v[208:211], v[172:175], v[120:123]
    v_mfma_f32_16x16x32_bf16 v[52:55], v[212:215], v[160:163], v[52:55]
    ds_read_b64_tr_b16 v[200:201], v10 offset:36864
    v_mfma_f32_16x16x32_bf16 v[76:79], v[212:215], v[164:167], v[76:79]
    buffer_load_dwordx4 v226, s[12:15], s37 offen offset:0 lds
    v_mfma_f32_16x16x32_bf16 v[100:103], v[212:215], v[168:171], v[100:103]
    ds_read_b64_tr_b16 v[202:203], v10 offset:37376
    v_mfma_f32_16x16x32_bf16 v[124:127], v[212:215], v[172:175], v[124:127]
    s_waitcnt lgkmcnt(2)
    v_mfma_f32_16x16x32_bf16 v[32:35], v[192:195], v[176:179], v[32:35]
    ds_read_b64_tr_b16 v[204:205], v11 offset:36864
    buffer_load_dwordx4 v227, s[12:15], s37 offen offset:1024 lds
    v_mfma_f32_16x16x32_bf16 v[56:59], v[192:195], v[180:183], v[56:59]
    v_mfma_f32_16x16x32_bf16 v[80:83], v[192:195], v[184:187], v[80:83]
    ds_read_b64_tr_b16 v[206:207], v11 offset:37376
    v_mfma_f32_16x16x32_bf16 v[104:107], v[192:195], v[188:191], v[104:107]
    s_cmp_ge_u32 s41, 17
    s_cbranch_scc1 L_rpl_16
    s_add_u32 m0, s49, 0
    s_nop 0
    buffer_load_dwordx4 v239, s[20:23], s42 offen nt lds
    s_add_u32 s7, s42, s47
    s_add_u32 m0, s49, 1024
    s_nop 0
    buffer_load_dwordx4 v239, s[20:23], s7 offen nt lds
    s_add_u32 s7, s42, s43
    s_add_u32 m0, s49, 2048
    s_nop 0
    buffer_load_dwordx4 v239, s[20:23], s7 offen nt lds
    s_add_u32 s7, s7, s47
    s_add_u32 m0, s49, 3072
    s_nop 0
    buffer_load_dwordx4 v239, s[20:23], s7 offen nt lds
L_rpl_16:
    v_mfma_f32_16x16x32_bf16 v[36:39], v[196:199], v[176:179], v[36:39]
    ds_read_b64_tr_b16 v[208:209], v12 offset:36864
    v_mfma_f32_16x16x32_bf16 v[60:63], v[196:199], v[180:183], v[60:63]
    v_mfma_f32_16x16x32_bf16 v[84:87], v[196:199], v[184:187], v[84:87]
    s_cmp_ge_u32 s52, 17
    ds_read_b64_tr_b16 v[210:211], v12 offset:37376
    s_cbranch_scc1 L_rpl_17
    s_mov_b64 s[24:25], s[44:45]
    s_mov_b32 s26, 819200
    s_mov_b32 s27, 0x20000
    s_add_u32 m0, s49, 4096
    s_nop 0
    buffer_load_dwordx4 v239, s[24:27], s53 offen nt lds
    s_add_u32 s7, s53, s60
    s_add_u32 m0, s49, 5120
    s_nop 0
    buffer_load_dwordx4 v239, s[24:27], s7 offen nt lds
    s_add_u32 s7, s53, s55
    s_add_u32 m0, s49, 6144
    s_nop 0
    buffer_load_dwordx4 v239, s[24:27], s7 offen nt lds
    s_add_u32 s7, s7, s60
    s_add_u32 m0, s49, 7168
    s_nop 0
    buffer_load_dwordx4 v239, s[24:27], s7 offen nt lds
L_rpl_17:
    v_mfma_f32_16x16x32_bf16 v[108:111], v[196:199], v[188:191], v[108:111]
    s_waitcnt lgkmcnt(2)
    v_mfma_f32_16x16x32_bf16 v[40:43], v[200:203], v[176:179], v[40:43]
    ds_read_b64_tr_b16 v[212:213], v13 offset:36864
    v_mfma_f32_16x16x32_bf16 v[64:67], v[200:203], v[180:183], v[64:67]
    v_mfma_f32_16x16x32_bf16 v[88:91], v[200:203], v[184:187], v[88:91]
    ds_read_b64_tr_b16 v[214:215], v13 offset:37376
    v_mfma_f32_16x16x32_bf16 v[112:115], v[200:203], v[188:191], v[112:115]
    s_waitcnt vmcnt(10) lgkmcnt(0)
    s_barrier
    v_mfma_f32_16x16x32_bf16 v[44:47], v[204:207], v[176:179], v[44:47]
    ds_read_b128 v[160:163], v4 offset:32768
    ds_read_b128 v[164:167], v4 offset:34816
    v_mfma_f32_16x16x32_bf16 v[68:71], v[204:207], v[180:183], v[68:71]
    ds_read_b128 v[168:171], v4 offset:36864
    s_add_u32 s36, s36, 128
    v_mfma_f32_16x16x32_bf16 v[92:95], v[204:207], v[184:187], v[92:95]
    ds_read_b128 v[172:175], v4 offset:38912
    ds_read_b64_tr_b16 v[192:193], v14 offset:0
    v_mfma_f32_16x16x32_bf16 v[116:119], v[204:207], v[188:191], v[116:119]
    ds_read_b64_tr_b16 v[194:195], v14 offset:512
    s_add_u32 s37, s37, 196608
    v_mfma_f32_16x16x32_bf16 v[48:51], v[208:211], v[176:179], v[48:51]
    ds_read_b64_tr_b16 v[196:197], v15 offset:0
    s_cmp_eq_u32 s36, s34
    v_mfma_f32_16x16x32_bf16 v[72:75], v[208:211], v[180:183], v[72:75]
    s_cselect_b32 s37, s35, s37
    s_cselect_b32 s7, 1280, 0
    v_mfma_f32_16x16x32_bf16 v[96:99], v[208:211], v[184:187], v[96:99]
    ds_read_b64_tr_b16 v[198:199], v15 offset:512
    s_sub_u32 s36, s36, s7
    v_mfma_f32_16x16x32_bf16 v[120:123], v[208:211], v[188:191], v[120:123]
    s_add_u32 m0, s96, 16384
    s_nop 0
    buffer_load_dwordx4 v1, s[8:11], s36 offen offset:0 lds
    v_mfma_f32_16x16x32_bf16 v[52:55], v[212:215], v[176:179], v[52:55]
    ds_read_b64_tr_b16 v[200:201], v16 offset:0
    buffer_load_dwordx4 v2, s[8:11], s36 offen offset:1024 lds
    v_mfma_f32_16x16x32_bf16 v[76:79], v[212:215], v[180:183], v[76:79]
    ds_read_b64_tr_b16 v[202:203], v16 offset:512
    v_mfma_f32_16x16x32_bf16 v[100:103], v[212:215], v[184:187], v[100:103]
    ds_read_b128 v[176:179], v5 offset:32768
    buffer_load_dwordx4 v30, s[8:11], s36 offen offset:2048 lds
    v_mfma_f32_16x16x32_bf16 v[124:127], v[212:215], v[188:191], v[124:127]
    s_waitcnt lgkmcnt(3)
    v_mfma_f32_16x16x32_bf16 v[32:35], v[192:195], v[160:163], v[32:35]
    ds_read_b64_tr_b16 v[204:205], v17 offset:0
    v_mfma_f32_16x16x32_bf16 v[56:59], v[192:195], v[164:167], v[56:59]
    ds_read_b64_tr_b16 v[206:207], v17 offset:512
    v_mfma_f32_16x16x32_bf16 v[80:83], v[192:195], v[168:171], v[80:83]
    ds_read_b128 v[180:183], v5 offset:34816
    buffer_load_dwordx4 v31, s[8:11], s36 offen offset:3072 lds
    v_mfma_f32_16x16x32_bf16 v[104:107], v[192:195], v[172:175], v[104:107]
    v_mfma_f32_16x16x32_bf16 v[36:39], v[196:199], v[160:163], v[36:39]
    ds_read_b64_tr_b16 v[208:209], v18 offset:0
    v_mfma_f32_16x16x32_bf16 v[60:63], v[196:199], v[164:167], v[60:63]
    ds_read_b64_tr_b16 v[210:211], v18 offset:512
    s_add_u32 m0, s97, 24576
    v_mfma_f32_16x16x32_bf16 v[84:87], v[196:199], v[168:171], v[84:87]
    ds_read_b128 v[184:187], v5 offset:36864
    v_mfma_f32_16x16x32_bf16 v[108:111], v[196:199], v[172:175], v[108:111]
    s_waitcnt lgkmcnt(4)
    v_mfma_f32_16x16x32_bf16 v[40:43], v[200:203], v[160:163], v[40:43]
    ds_read_b64_tr_b16 v[212:213], v19 offset:0
    v_mfma_f32_16x16x32_bf16 v[64:67], v[200:203], v[164:167], v[64:67]
    ds_read_b64_tr_b16 v[214:215], v19 offset:512
    buffer_load_dwordx4 v3, s[12:15], s37 offen offset:0 lds
    v_mfma_f32_16x16x32_bf16 v[88:91], v[200:203], v[168:171], v[88:91]
    ds_read_b128 v[188:191], v5 offset:38912
    v_mfma_f32_16x16x32_bf16 v[112:115], v[200:203], v[172:175], v[112:115]
    v_mfma_f32_16x16x32_bf16 v[44:47], v[204:207], v[160:163], v[44:47]
    ds_read_b64_tr_b16 v[192:193], v14 offset:12288
    buffer_load_dwordx4 v224, s[12:15], s37 offen offset:1024 lds
    v_mfma_f32_16x16x32_bf16 v[68:71], v[204:207], v[164:167], v[68:71]
    v_mfma_f32_16x16x32_bf16 v[92:95], v[204:207], v[168:171], v[92:95]
    ds_read_b64_tr_b16 v[194:195], v14 offset:12800
    v_mfma_f32_16x16x32_bf16 v[116:119], v[204:207], v[172:175], v[116:119]
    s_waitcnt lgkmcnt(3)
    v_mfma_f32_16x16x32_bf16 v[48:51], v[208:211], v[160:163], v[48:51]
    ds_read_b64_tr_b16 v[196:197], v15 offset:12288
    buffer_load_dwordx4 v225, s[12:15], s37 offen offset:2048 lds
    v_mfma_f32_16x16x32_bf16 v[72:75], v[208:211], v[164:167], v[72:75]
    v_mfma_f32_16x16x32_bf16 v[96:99], v[208:211], v[168:171], v[96:99]
    ds_read_b64_tr_b16 v[198:199], v15 offset:12800
    v_mfma_f32_16x16x32_bf16 v[120:123], v[208:211], v[172:175], v[120:123]
    buffer_load_dwordx4 v24, s[12:15], s37 offen offset:3072 lds
    v_mfma_f32_16x16x32_bf16 v[52:55], v[212:215], v[160:163], v[52:55]
    ds_read_b64_tr_b16 v[200:201], v16 offset:12288
    v_mfma_f32_16x16x32_bf16 v[76:79], v[212:215], v[164:167], v[76:79]
    v_mfma_f32_16x16x32_bf16 v[100:103], v[212:215], v[168:171], v[100:103]
    ds_read_b64_tr_b16 v[202:203], v16 offset:12800
    v_mfma_f32_16x16x32_bf16 v[124:127], v[212:215], v[172:175], v[124:127]
    s_waitcnt lgkmcnt(2)
    s_add_u32 m0, s97, 28672
    v_mfma_f32_16x16x32_bf16 v[32:35], v[192:195], v[176:179], v[32:35]
    ds_read_b64_tr_b16 v[204:205], v17 offset:12288
    v_mfma_f32_16x16x32_bf16 v[56:59], v[192:195], v[180:183], v[56:59]
    v_mfma_f32_16x16x32_bf16 v[80:83], v[192:195], v[184:187], v[80:83]
    ds_read_b64_tr_b16 v[206:207], v17 offset:12800
    buffer_load_dwordx4 v226, s[12:15], s37 offen offset:0 lds
    v_mfma_f32_16x16x32_bf16 v[104:107], v[192:195], v[188:191], v[104:107]
    v_mfma_f32_16x16x32_bf16 v[36:39], v[196:199], v[176:179], v[36:39]
    ds_read_b64_tr_b16 v[208:209], v18 offset:12288
    v_mfma_f32_16x16x32_bf16 v[60:63], v[196:199], v[180:183], v[60:63]
    v_mfma_f32_16x16x32_bf16 v[84:87], v[196:199], v[184:187], v[84:87]
    ds_read_b64_tr_b16 v[210:211], v18 offset:12800
    buffer_load_dwordx4 v227, s[12:15], s37 offen offset:1024 lds
    v_mfma_f32_16x16x32_bf16 v[108:111], v[196:199], v[188:191], v[108:111]
    s_waitcnt lgkmcnt(2)
    v_mfma_f32_16x16x32_bf16 v[40:43], v[200:203], v[176:179], v[40:43]
    ds_read_b64_tr_b16 v[212:213], v19 offset:12288
    v_mfma_f32_16x16x32_bf16 v[64:67], v[200:203], v[180:183], v[64:67]
    v_mfma_f32_16x16x32_bf16 v[88:91], v[200:203], v[184:187], v[88:91]
    ds_read_b64_tr_b16 v[214:215], v19 offset:12800
    v_mfma_f32_16x16x32_bf16 v[112:115], v[200:203], v[188:191], v[112:115]
    s_waitcnt vmcnt(10) lgkmcnt(0)
    s_barrier
    v_mfma_f32_16x16x32_bf16 v[44:47], v[204:207], v[176:179], v[44:47]
    ds_read_b128 v[160:163], v4 offset:0
    ds_read_b128 v[164:167], v4 offset:2048
    v_mfma_f32_16x16x32_bf16 v[68:71], v[204:207], v[180:183], v[68:71]
    ds_read_b128 v[168:171], v4 offset:4096
    s_add_u32 s36, s36, 128
    v_mfma_f32_16x16x32_bf16 v[92:95], v[204:207], v[184:187], v[92:95]
    ds_read_b128 v[172:175], v4 offset:6144
    ds_read_b64_tr_b16 v[192:193], v8 offset:0
    v_mfma_f32_16x16x32_bf16 v[116:119], v[204:207], v[188:191], v[116:119]
    ds_read_b64_tr_b16 v[194:195], v8 offset:512
    s_add_u32 s37, s37, 196608
    v_mfma_f32_16x16x32_bf16 v[48:51], v[208:211], v[176:179], v[48:51]
    ds_read_b64_tr_b16 v[196:197], v9 offset:0
    s_cmp_eq_u32 s36, s34
    v_mfma_f32_16x16x32_bf16 v[72:75], v[208:211], v[180:183], v[72:75]
    s_cselect_b32 s37, s35, s37
    s_cselect_b32 s7, 1280, 0
    v_mfma_f32_16x16x32_bf16 v[96:99], v[208:211], v[184:187], v[96:99]
    ds_read_b64_tr_b16 v[198:199], v9 offset:512
    s_sub_u32 s36, s36, s7
    v_mfma_f32_16x16x32_bf16 v[120:123], v[208:211], v[188:191], v[120:123]
    s_add_u32 m0, s96, 32768
    s_nop 0
    buffer_load_dwordx4 v1, s[8:11], s36 offen offset:0 lds
    v_mfma_f32_16x16x32_bf16 v[52:55], v[212:215], v[176:179], v[52:55]
    ds_read_b64_tr_b16 v[200:201], v10 offset:0
    buffer_load_dwordx4 v2, s[8:11], s36 offen offset:1024 lds
    v_mfma_f32_16x16x32_bf16 v[76:79], v[212:215], v[180:183], v[76:79]
    ds_read_b64_tr_b16 v[202:203], v10 offset:512
    buffer_load_dwordx4 v30, s[8:11], s36 offen offset:2048 lds
    v_mfma_f32_16x16x32_bf16 v[100:103], v[212:215], v[184:187], v[100:103]
    ds_read_b128 v[176:179], v5 offset:0
    v_mfma_f32_16x16x32_bf16 v[124:127], v[212:215], v[188:191], v[124:127]
    s_waitcnt lgkmcnt(3)
    v_mfma_f32_16x16x32_bf16 v[32:35], v[192:195], v[160:163], v[32:35]
    ds_read_b64_tr_b16 v[204:205], v11 offset:0
    v_mfma_f32_16x16x32_bf16 v[56:59], v[192:195], v[164:167], v[56:59]
    ds_read_b64_tr_b16 v[206:207], v11 offset:512
    buffer_load_dwordx4 v31, s[8:11], s36 offen offset:3072 lds
    v_mfma_f32_16x16x32_bf16 v[80:83], v[192:195], v[168:171], v[80:83]
    ds_read_b128 v[180:183], v5 offset:2048
    v_mfma_f32_16x16x32_bf16 v[104:107], v[192:195], v[172:175], v[104:107]
    v_mfma_f32_16x16x32_bf16 v[36:39], v[196:199], v[160:163], v[36:39]
    ds_read_b64_tr_b16 v[208:209], v12 offset:0
    s_add_u32 m0, s97, 49152
    v_mfma_f32_16x16x32_bf16 v[60:63], v[196:199], v[164:167], v[60:63]
    ds_read_b64_tr_b16 v[210:211], v12 offset:512
    v_mfma_f32_16x16x32_bf16 v[84:87], v[196:199], v[168:171], v[84:87]
    ds_read_b128 v[184:187], v5 offset:4096
    v_mfma_f32_16x16x32_bf16 v[108:111], v[196:199], v[172:175], v[108:111]
    s_waitcnt lgkmcnt(4)
    buffer_load_dwordx4 v3, s[12:15], s37 offen offset:0 lds
    v_mfma_f32_16x16x32_bf16 v[40:43], v[200:203], v[160:163], v[40:43]
    ds_read_b64_tr_b16 v[212:213], v13 offset:0
    v_mfma_f32_16x16x32_bf16 v[64:67], v[200:203], v[164:167], v[64:67]
    ds_read_b64_tr_b16 v[214:215], v13 offset:512
    v_mfma_f32_16x16x32_bf16 v[88:91], v[200:203], v[168:171], v[88:91]
    ds_read_b128 v[188:191], v5 offset:6144
    v_mfma_f32_16x16x32_bf16 v[112:115], v[200:203], v[172:175], v[112:115]
    buffer_load_dwordx4 v224, s[12:15], s37 offen offset:1024 lds
    v_mfma_f32_16x16x32_bf16 v[44:47], v[204:207], v[160:163], v[44:47]
    ds_read_b64_tr_b16 v[192:193], v8 offset:12288
    v_mfma_f32_16x16x32_bf16 v[68:71], v[204:207], v[164:167], v[68:71]
    v_mfma_f32_16x16x32_bf16 v[92:95], v[204:207], v[168:171], v[92:95]
    ds_read_b64_tr_b16 v[194:195], v8 offset:12800
    buffer_load_dwordx4 v225, s[12:15], s37 offen offset:2048 lds
    v_mfma_f32_16x16x32_bf16 v[116:119], v[204:207], v[172:175], v[116:119]
    s_waitcnt lgkmcnt(3)
    v_mfma_f32_16x16x32_bf16 v[48:51], v[208:211], v[160:163], v[48:51]
    ds_read_b64_tr_b16 v[196:197], v9 offset:12288
    v_mfma_f32_16x16x32_bf16 v[72:75], v[208:211], v[164:167], v[72:75]
    buffer_load_dwordx4 v24, s[12:15], s37 offen offset:3072 lds
    v_mfma_f32_16x16x32_bf16 v[96:99], v[208:211], v[168:171], v[96:99]
    ds_read_b64_tr_b16 v[198:199], v9 offset:12800
    v_mfma_f32_16x16x32_bf16 v[120:123], v[208:211], v[172:175], v[120:123]
    v_mfma_f32_16x16x32_bf16 v[52:55], v[212:215], v[160:163], v[52:55]
    ds_read_b64_tr_b16 v[200:201], v10 offset:12288
    s_add_u32 m0, s97, 53248
    v_mfma_f32_16x16x32_bf16 v[76:79], v[212:215], v[164:167], v[76:79]
    v_mfma_f32_16x16x32_bf16 v[100:103], v[212:215], v[168:171], v[100:103]
    ds_read_b64_tr_b16 v[202:203], v10 offset:12800
    v_mfma_f32_16x16x32_bf16 v[124:127], v[212:215], v[172:175], v[124:127]
    s_waitcnt lgkmcnt(2)
    v_mfma_f32_16x16x32_bf16 v[32:35], v[192:195], v[176:179], v[32:35]
    ds_read_b64_tr_b16 v[204:205], v11 offset:12288
    buffer_load_dwordx4 v226, s[12:15], s37 offen offset:0 lds
    v_mfma_f32_16x16x32_bf16 v[56:59], v[192:195], v[180:183], v[56:59]
    v_mfma_f32_16x16x32_bf16 v[80:83], v[192:195], v[184:187], v[80:83]
    ds_read_b64_tr_b16 v[206:207], v11 offset:12800
    v_mfma_f32_16x16x32_bf16 v[104:107], v[192:195], v[188:191], v[104:107]
    buffer_load_dwordx4 v227, s[12:15], s37 offen offset:1024 lds
    v_mfma_f32_16x16x32_bf16 v[36:39], v[196:199], v[176:179], v[36:39]
    ds_read_b64_tr_b16 v[208:209], v12 offset:12288
    v_mfma_f32_16x16x32_bf16 v[60:63], v[196:199], v[180:183], v[60:63]
    v_mfma_f32_16x16x32_bf16 v[84:87], v[196:199], v[184:187], v[84:87]
    ds_read_b64_tr_b16 v[210:211], v12 offset:12800
    s_mul_i32 s63, s33, 68
    v_mfma_f32_16x16x32_bf16 v[108:111], v[196:199], v[188:191], v[108:111]
    s_waitcnt lgkmcnt(2)
    s_mul_i32 s44, s3, 12
    v_mfma_f32_16x16x32_bf16 v[40:43], v[200:203], v[176:179], v[40:43]
    ds_read_b64_tr_b16 v[212:213], v13 offset:12288
    s_add_u32 s44, s44, s63
    v_mfma_f32_16x16x32_bf16 v[64:67], v[200:203], v[180:183], v[64:67]
    s_mul_i32 s44, s44, 5120
    s_add_u32 s44, s44, 1048576
    v_mfma_f32_16x16x32_bf16 v[88:91], v[200:203], v[184:187], v[88:91]
    ds_read_b64_tr_b16 v[214:215], v13 offset:12800
    s_mul_i32 s45, s3, 5
    v_mfma_f32_16x16x32_bf16 v[112:115], v[200:203], v[188:191], v[112:115]
    s_add_u32 s45, s45, s63
    s_mul_i32 s45, s45, 5120
    s_add_u32 s45, s45, 1294336
    s_mul_i32 s48, s3, 40960
    s_waitcnt vmcnt(10) lgkmcnt(0)
    s_barrier
    v_mfma_f32_16x16x32_bf16 v[44:47], v[204:207], v[176:179], v[44:47]
    s_cmp_ge_u32 s41, 17
    ds_read_b128 v[160:163], v4 offset:16384
    ds_read_b128 v[164:167], v4 offset:18432
    s_cbranch_scc1 L_rps_18
    ds_read_b64_tr_b16 v[240:241], v235 offset:0
    ds_read_b64_tr_b16 v[242:243], v235 offset:2048
    ds_read_b64_tr_b16 v[244:245], v236 offset:0
    ds_read_b64_tr_b16 v[246:247], v236 offset:2048
    ds_read_b64_tr_b16 v[248:249], v237 offset:0
    ds_read_b64_tr_b16 v[250:251], v237 offset:2048
    ds_read_b64_tr_b16 v[252:253], v238 offset:0
    ds_read_b64_tr_b16 v[254:255], v238 offset:2048
    s_waitcnt lgkmcnt(0)
    buffer_store_dwordx4 v[240:243], v21, s[16:19], s50 offen sc1
    buffer_store_dwordx4 v[244:247], v21, s[16:19], s51 offen sc1
    buffer_store_dwordx4 v[248:251], v21, s[16:19], s58 offen sc1
    buffer_store_dwordx4 v[252:255], v21, s[16:19], s59 offen sc1
L_rps_18:
    v_mfma_f32_16x16x32_bf16 v[68:71], v[204:207], v[180:183], v[68:71]
    ds_read_b128 v[168:171], v4 offset:20480
    v_mfma_f32_16x16x32_bf16 v[92:95], v[204:207], v[184:187], v[92:95]
    ds_read_b128 v[172:175], v4 offset:22528
    ds_read_b64_tr_b16 v[192:193], v8 offset:24576
    v_mfma_f32_16x16x32_bf16 v[116:119], v[204:207], v[188:191], v[116:119]
    s_cmp_ge_u32 s52, 17
    ds_read_b64_tr_b16 v[194:195], v8 offset:25088
    s_cbranch_scc1 L_rps_19
    ds_read_b64_tr_b16 v[240:241], v235 offset:4096
    ds_read_b64_tr_b16 v[242:243], v235 offset:6144
    ds_read_b64_tr_b16 v[244:245], v236 offset:4096
    ds_read_b64_tr_b16 v[246:247], v236 offset:6144
    ds_read_b64_tr_b16 v[248:249], v237 offset:4096
    ds_read_b64_tr_b16 v[250:251], v237 offset:6144
    ds_read_b64_tr_b16 v[252:253], v238 offset:4096
    ds_read_b64_tr_b16 v[254:255], v238 offset:6144
    s_waitcnt lgkmcnt(0)
    buffer_store_dwordx4 v[240:243], v21, s[16:19], s61 offen sc1
    buffer_store_dwordx4 v[244:247], v21, s[16:19], s100 offen sc1
    buffer_store_dwordx4 v[248:251], v21, s[16:19], s101 offen sc1
    buffer_store_dwordx4 v[252:255], v21, s[16:19], s46 offen sc1
L_rps_19:
    v_mfma_f32_16x16x32_bf16 v[48:51], v[208:211], v[176:179], v[48:51]
    ds_read_b64_tr_b16 v[196:197], v9 offset:24576
    v_mfma_f32_16x16x32_bf16 v[72:75], v[208:211], v[180:183], v[72:75]
    v_mfma_f32_16x16x32_bf16 v[96:99], v[208:211], v[184:187], v[96:99]
    ds_read_b64_tr_b16 v[198:199], v9 offset:25088
    s_add_u32 s36, s36, 128
    v_mfma_f32_16x16x32_bf16 v[120:123], v[208:211], v[188:191], v[120:123]
    s_add_u32 s37, s37, 196608
    s_cmp_eq_u32 s36, s34
    v_mfma_f32_16x16x32_bf16 v[52:55], v[212:215], v[176:179], v[52:55]
    ds_read_b64_tr_b16 v[200:201], v10 offset:24576
    s_cselect_b32 s37, s35, s37
    v_mfma_f32_16x16x32_bf16 v[76:79], v[212:215], v[180:183], v[76:79]
    ds_read_b64_tr_b16 v[202:203], v10 offset:25088
    s_cselect_b32 s7, 1280, 0
    v_mfma_f32_16x16x32_bf16 v[100:103], v[212:215], v[184:187], v[100:103]
    ds_read_b128 v[176:179], v5 offset:16384
    s_sub_u32 s36, s36, s7
    v_mfma_f32_16x16x32_bf16 v[124:127], v[212:215], v[188:191], v[124:127]
    s_waitcnt lgkmcnt(3)
    s_add_u32 m0, s96, 0
    v_mfma_f32_16x16x32_bf16 v[32:35], v[192:195], v[160:163], v[32:35]
    ds_read_b64_tr_b16 v[204:205], v11 offset:24576
    buffer_load_dwordx4 v1, s[8:11], s36 offen offset:0 lds
    v_mfma_f32_16x16x32_bf16 v[56:59], v[192:195], v[164:167], v[56:59]
    ds_read_b64_tr_b16 v[206:207], v11 offset:25088
    buffer_load_dwordx4 v2, s[8:11], s36 offen offset:1024 lds
    v_mfma_f32_16x16x32_bf16 v[80:83], v[192:195], v[168:171], v[80:83]
    ds_read_b128 v[180:183], v5 offset:18432
    v_mfma_f32_16x16x32_bf16 v[104:107], v[192:195], v[172:175], v[104:107]
    buffer_load_dwordx4 v30, s[8:11], s36 offen offset:2048 lds
    v_mfma_f32_16x16x32_bf16 v[36:39], v[196:199], v[160:163], v[36:39]
    ds_read_b64_tr_b16 v[208:209], v12 offset:24576
    v_mfma_f32_16x16x32_bf16 v[60:63], v[196:199], v[164:167], v[60:63]
    ds_read_b64_tr_b16 v[210:211], v12 offset:25088
    v_mfma_f32_16x16x32_bf16 v[84:87], v[196:199], v[168:171], v[84:87]
    ds_read_b128 v[184:187], v5 offset:20480
    buffer_load_dwordx4 v31, s[8:11], s36 offen offset:3072 lds
    v_mfma_f32_16x16x32_bf16 v[108:111], v[196:199], v[172:175], v[108:111]
    s_waitcnt lgkmcnt(4)
    v_mfma_f32_16x16x32_bf16 v[40:43], v[200:203], v[160:163], v[40:43]
    ds_read_b64_tr_b16 v[212:213], v13 offset:24576
    v_mfma_f32_16x16x32_bf16 v[64:67], v[200:203], v[164:167], v[64:67]
    ds_read_b64_tr_b16 v[214:215], v13 offset:25088
    s_add_u32 m0, s97, 0
    v_mfma_f32_16x16x32_bf16 v[88:91], v[200:203], v[168:171], v[88:91]
    ds_read_b128 v[188:191], v5 offset:22528
    v_mfma_f32_16x16x32_bf16 v[112:115], v[200:203], v[172:175], v[112:115]
    v_mfma_f32_16x16x32_bf16 v[44:47], v[204:207], v[160:163], v[44:47]
    ds_read_b64_tr_b16 v[192:193], v8 offset:36864
    buffer_load_dwordx4 v3, s[12:15], s37 offen offset:0 lds
    v_mfma_f32_16x16x32_bf16 v[68:71], v[204:207], v[164:167], v[68:71]
    v_mfma_f32_16x16x32_bf16 v[92:95], v[204:207], v[168:171], v[92:95]
    ds_read_b64_tr_b16 v[194:195], v8 offset:37376
    v_mfma_f32_16x16x32_bf16 v[116:119], v[204:207], v[172:175], v[116:119]
    s_waitcnt lgkmcnt(3)
    buffer_load_dwordx4 v224, s[12:15], s37 offen offset:1024 lds
    v_mfma_f32_16x16x32_bf16 v[48:51], v[208:211], v[160:163], v[48:51]
    ds_read_b64_tr_b16 v[196:197], v9 offset:36864
    v_mfma_f32_16x16x32_bf16 v[72:75], v[208:211], v[164:167], v[72:75]
    v_mfma_f32_16x16x32_bf16 v[96:99], v[208:211], v[168:171], v[96:99]
    ds_read_b64_tr_b16 v[198:199], v9 offset:37376
    buffer_load_dwordx4 v225, s[12:15], s37 offen offset:2048 lds
    v_mfma_f32_16x16x32_bf16 v[120:123], v[208:211], v[172:175], v[120:123]
    v_mfma_f32_16x16x32_bf16 v[52:55], v[212:215], v[160:163], v[52:55]
    ds_read_b64_tr_b16 v[200:201], v10 offset:36864
    v_mfma_f32_16x16x32_bf16 v[76:79], v[212:215], v[164:167], v[76:79]
    buffer_load_dwordx4 v24, s[12:15], s37 offen offset:3072 lds
    v_mfma_f32_16x16x32_bf16 v[100:103], v[212:215], v[168:171], v[100:103]
    ds_read_b64_tr_b16 v[202:203], v10 offset:37376
    v_mfma_f32_16x16x32_bf16 v[124:127], v[212:215], v[172:175], v[124:127]
    s_waitcnt lgkmcnt(2)
    v_mfma_f32_16x16x32_bf16 v[32:35], v[192:195], v[176:179], v[32:35]
    ds_read_b64_tr_b16 v[204:205], v11 offset:36864
    s_add_u32 m0, s97, 4096
    v_mfma_f32_16x16x32_bf16 v[56:59], v[192:195], v[180:183], v[56:59]
    v_mfma_f32_16x16x32_bf16 v[80:83], v[192:195], v[184:187], v[80:83]
    ds_read_b64_tr_b16 v[206:207], v11 offset:37376
    v_mfma_f32_16x16x32_bf16 v[104:107], v[192:195], v[188:191], v[104:107]
    buffer_load_dwordx4 v226, s[12:15], s37 offen offset:0 lds
    v_mfma_f32_16x16x32_bf16 v[36:39], v[196:199], v[176:179], v[36:39]
    ds_read_b64_tr_b16 v[208:209], v12 offset:36864
    v_mfma_f32_16x16x32_bf16 v[60:63], v[196:199], v[180:183], v[60:63]
    v_mfma_f32_16x16x32_bf16 v[84:87], v[196:199], v[184:187], v[84:87]
    ds_read_b64_tr_b16 v[210:211], v12 offset:37376
    buffer_load_dwordx4 v227, s[12:15], s37 offen offset:1024 lds
    v_mfma_f32_16x16x32_bf16 v[108:111], v[196:199], v[188:191], v[108:111]
    s_waitcnt lgkmcnt(2)
    v_mfma_f32_16x16x32_bf16 v[40:43], v[200:203], v[176:179], v[40:43]
    ds_read_b64_tr_b16 v[212:213], v13 offset:36864
    v_mfma_f32_16x16x32_bf16 v[64:67], v[200:203], v[180:183], v[64:67]
    v_mfma_f32_16x16x32_bf16 v[88:91], v[200:203], v[184:187], v[88:91]
    ds_read_b64_tr_b16 v[214:215], v13 offset:37376
    v_mfma_f32_16x16x32_bf16 v[112:115], v[200:203], v[188:191], v[112:115]
    s_waitcnt vmcnt(10) lgkmcnt(0)
    s_barrier
    v_mfma_f32_16x16x32_bf16 v[44:47], v[204:207], v[176:179], v[44:47]
    ds_read_b128 v[160:163], v4 offset:32768
    ds_read_b128 v[164:167], v4 offset:34816
    v_mfma_f32_16x16x32_bf16 v[68:71], v[204:207], v[180:183], v[68:71]
    ds_read_b128 v[168:171], v4 offset:36864
    buffer_load_dword v26, v25, s[28:31], 0 offen sc1
    v_mfma_f32_16x16x32_bf16 v[92:95], v[204:207], v[184:187], v[92:95]
    ds_read_b128 v[172:175], v4 offset:38912
    ds_read_b64_tr_b16 v[192:193], v14 offset:0
    v_mfma_f32_16x16x32_bf16 v[116:119], v[204:207], v[188:191], v[116:119]
    ds_read_b64_tr_b16 v[194:195], v14 offset:512
    s_add_u32 s36, s36, 128
    v_mfma_f32_16x16x32_bf16 v[48:51], v[208:211], v[176:179], v[48:51]
    ds_read_b64_tr_b16 v[196:197], v15 offset:0
    s_add_u32 s37, s37, 196608
    v_mfma_f32_16x16x32_bf16 v[72:75], v[208:211], v[180:183], v[72:75]
    s_cmp_eq_u32 s36, s34
    s_cselect_b32 s37, s35, s37
    v_mfma_f32_16x16x32_bf16 v[96:99], v[208:211], v[184:187], v[96:99]
    ds_read_b64_tr_b16 v[198:199], v15 offset:512
    s_cselect_b32 s7, 1280, 0
    v_mfma_f32_16x16x32_bf16 v[120:123], v[208:211], v[188:191], v[120:123]
    s_sub_u32 s36, s36, s7
    s_add_u32 m0, s96, 16384
    v_mfma_f32_16x16x32_bf16 v[52:55], v[212:215], v[176:179], v[52:55]
    ds_read_b64_tr_b16 v[200:201], v16 offset:0
    buffer_load_dwordx4 v1, s[8:11], s36 offen offset:0 lds
    v_mfma_f32_16x16x32_bf16 v[76:79], v[212:215], v[180:183], v[76:79]
    ds_read_b64_tr_b16 v[202:203], v16 offset:512
    buffer_load_dwordx4 v2, s[8:11], s36 offen offset:1024 lds
    v_mfma_f32_16x16x32_bf16 v[100:103], v[212:215], v[184:187], v[100:103]
    ds_read_b128 v[176:179], v5 offset:32768
    v_mfma_f32_16x16x32_bf16 v[124:127], v[212:215], v[188:191], v[124:127]
    s_waitcnt lgkmcnt(3)
    v_mfma_f32_16x16x32_bf16 v[32:35], v[192:195], v[160:163], v[32:35]
    ds_read_b64_tr_b16 v[204:205], v17 offset:0
    v_mfma_f32_16x16x32_bf16 v[56:59], v[192:195], v[164:167], v[56:59]
    ds_read_b64_tr_b16 v[206:207], v17 offset:512
    buffer_load_dwordx4 v30, s[8:11], s36 offen offset:2048 lds
    v_mfma_f32_16x16x32_bf16 v[80:83], v[192:195], v[168:171], v[80:83]
    ds_read_b128 v[180:183], v5 offset:34816
    v_mfma_f32_16x16x32_bf16 v[104:107], v[192:195], v[172:175], v[104:107]
    v_mfma_f32_16x16x32_bf16 v[36:39], v[196:199], v[160:163], v[36:39]
    ds_read_b64_tr_b16 v[208:209], v18 offset:0
    buffer_load_dwordx4 v31, s[8:11], s36 offen offset:3072 lds
    v_mfma_f32_16x16x32_bf16 v[60:63], v[196:199], v[164:167], v[60:63]
    ds_read_b64_tr_b16 v[210:211], v18 offset:512
    v_mfma_f32_16x16x32_bf16 v[84:87], v[196:199], v[168:171], v[84:87]
    ds_read_b128 v[184:187], v5 offset:36864
    v_mfma_f32_16x16x32_bf16 v[108:111], v[196:199], v[172:175], v[108:111]
    s_waitcnt lgkmcnt(4)
    s_add_u32 m0, s97, 24576
    v_mfma_f32_16x16x32_bf16 v[40:43], v[200:203], v[160:163], v[40:43]
    ds_read_b64_tr_b16 v[212:213], v19 offset:0
    v_mfma_f32_16x16x32_bf16 v[64:67], v[200:203], v[164:167], v[64:67]
    ds_read_b64_tr_b16 v[214:215], v19 offset:512
    v_mfma_f32_16x16x32_bf16 v[88:91], v[200:203], v[168:171], v[88:91]
    ds_read_b128 v[188:191], v5 offset:38912
    v_mfma_f32_16x16x32_bf16 v[112:115], v[200:203], v[172:175], v[112:115]
    buffer_load_dwordx4 v3, s[12:15], s37 offen offset:0 lds
    v_mfma_f32_16x16x32_bf16 v[44:47], v[204:207], v[160:163], v[44:47]
    ds_read_b64_tr_b16 v[192:193], v14 offset:12288
    v_mfma_f32_16x16x32_bf16 v[68:71], v[204:207], v[164:167], v[68:71]
    v_mfma_f32_16x16x32_bf16 v[92:95], v[204:207], v[168:171], v[92:95]
    ds_read_b64_tr_b16 v[194:195], v14 offset:12800
    buffer_load_dwordx4 v224, s[12:15], s37 offen offset:1024 lds
    v_mfma_f32_16x16x32_bf16 v[116:119], v[204:207], v[172:175], v[116:119]
    s_waitcnt lgkmcnt(3)
    v_mfma_f32_16x16x32_bf16 v[48:51], v[208:211], v[160:163], v[48:51]
    ds_read_b64_tr_b16 v[196:197], v15 offset:12288
    v_mfma_f32_16x16x32_bf16 v[72:75], v[208:211], v[164:167], v[72:75]
    buffer_load_dwordx4 v225, s[12:15], s37 offen offset:2048 lds
    v_mfma_f32_16x16x32_bf16 v[96:99], v[208:211], v[168:171], v[96:99]
    ds_read_b64_tr_b16 v[198:199], v15 offset:12800
    v_mfma_f32_16x16x32_bf16 v[120:123], v[208:211], v[172:175], v[120:123]
    v_mfma_f32_16x16x32_bf16 v[52:55], v[212:215], v[160:163], v[52:55]
    ds_read_b64_tr_b16 v[200:201], v16 offset:12288
    buffer_load_dwordx4 v24, s[12:15], s37 offen offset:3072 lds
    v_mfma_f32_16x16x32_bf16 v[76:79], v[212:215], v[164:167], v[76:79]
    v_mfma_f32_16x16x32_bf16 v[100:103], v[212:215], v[168:171], v[100:103]
    ds_read_b64_tr_b16 v[202:203], v16 offset:12800
    v_mfma_f32_16x16x32_bf16 v[124:127], v[212:215], v[172:175], v[124:127]
    s_waitcnt lgkmcnt(2)
    v_mfma_f32_16x16x32_bf16 v[32:35], v[192:195], v[176:179], v[32:35]
    ds_read_b64_tr_b16 v[204:205], v17 offset:12288
    s_add_u32 m0, s97, 28672
    v_mfma_f32_16x16x32_bf16 v[56:59], v[192:195], v[180:183], v[56:59]
    v_mfma_f32_16x16x32_bf16 v[80:83], v[192:195], v[184:187], v[80:83]
    ds_read_b64_tr_b16 v[206:207], v17 offset:12800
    v_mfma_f32_16x16x32_bf16 v[104:107], v[192:195], v[188:191], v[104:107]
    buffer_load_dwordx4 v226, s[12:15], s37 offen offset:0 lds
    v_mfma_f32_16x16x32_bf16 v[36:39], v[196:199], v[176:179], v[36:39]
    ds_read_b64_tr_b16 v[208:209], v18 offset:12288
    v_mfma_f32_16x16x32_bf16 v[60:63], v[196:199], v[180:183], v[60:63]
    v_mfma_f32_16x16x32_bf16 v[84:87], v[196:199], v[184:187], v[84:87]
    ds_read_b64_tr_b16 v[210:211], v18 offset:12800
    buffer_load_dwordx4 v227, s[12:15], s37 offen offset:1024 lds
    v_mfma_f32_16x16x32_bf16 v[108:111], v[196:199], v[188:191], v[108:111]
    s_waitcnt lgkmcnt(2)
    v_mfma_f32_16x16x32_bf16 v[40:43], v[200:203], v[176:179], v[40:43]
    ds_read_b64_tr_b16 v[212:213], v19 offset:12288
    v_mfma_f32_16x16x32_bf16 v[64:67], v[200:203], v[180:183], v[64:67]
    v_mfma_f32_16x16x32_bf16 v[88:91], v[200:203], v[184:187], v[88:91]
    ds_read_b64_tr_b16 v[214:215], v19 offset:12800
    v_mfma_f32_16x16x32_bf16 v[112:115], v[200:203], v[188:191], v[112:115]
    s_waitcnt vmcnt(10)
    v_cmp_ne_u32 vcc, 0, v26
    s_mov_b32 s98, 0
    s_nop 0
    s_cmp_eq_u64 vcc, -1
    s_cbranch_scc1 L_ok_20
L_spin_21:
    buffer_load_dword v26, v25, s[28:31], 0 offen sc1
    s_add_u32 s98, s98, 1
    s_waitcnt vmcnt(0)
    v_cmp_ne_u32 vcc, 0, v26
    s_cmp_gt_u32 s98, 0x40000
    s_cbranch_scc1 L_ok_20
    s_cmp_eq_u64 vcc, -1
    s_cbranch_scc0 L_spin_21
L_ok_20:
    s_waitcnt lgkmcnt(0)
    s_barrier
    s_cmp_lg_u32 s3, 0
    s_cbranch_scc1 L_nf_22
    s_lshl_b32 s7, s40, 7
    s_add_u32 s7, s7, 49152
    s_mov_b64 exec, 1
    buffer_store_dword v22, v23, s[16:19], s7 offen sc1
    s_mov_b64 exec, -1
L_nf_22:
    v_mfma_f32_16x16x32_bf16 v[44:47], v[204:207], v[176:179], v[44:47]
    ds_read_b128 v[160:163], v4 offset:0
    ds_read_b128 v[164:167], v4 offset:2048
    v_mfma_f32_16x16x32_bf16 v[68:71], v[204:207], v[180:183], v[68:71]
    ds_read_b128 v[168:171], v4 offset:4096
    s_add_u32 s36, s36, 128
    v_mfma_f32_16x16x32_bf16 v[92:95], v[204:207], v[184:187], v[92:95]
    ds_read_b128 v[172:175], v4 offset:6144
    ds_read_b64_tr_b16 v[192:193], v8 offset:0
    v_mfma_f32_16x16x32_bf16 v[116:119], v[204:207], v[188:191], v[116:119]
    ds_read_b64_tr_b16 v[194:195], v8 offset:512
    s_add_u32 s37, s37, 196608
    v_mfma_f32_16x16x32_bf16 v[48:51], v[208:211], v[176:179], v[48:51]
    ds_read_b64_tr_b16 v[196:197], v9 offset:0
    s_cmp_eq_u32 s36, s34
    v_mfma_f32_16x16x32_bf16 v[72:75], v[208:211], v[180:183], v[72:75]
    s_cselect_b32 s37, s35, s37
    s_cselect_b32 s7, 1280, 0
    v_mfma_f32_16x16x32_bf16 v[96:99], v[208:211], v[184:187], v[96:99]
    ds_read_b64_tr_b16 v[198:199], v9 offset:512
    s_sub_u32 s36, s36, s7
    v_mfma_f32_16x16x32_bf16 v[120:123], v[208:211], v[188:191], v[120:123]
    s_add_u32 m0, s96, 32768
    s_nop 0
    buffer_load_dwordx4 v1, s[8:11], s36 offen offset:0 lds
    v_mfma_f32_16x16x32_bf16 v[52:55], v[212:215], v[176:179], v[52:55]
    ds_read_b64_tr_b16 v[200:201], v10 offset:0
    buffer_load_dwordx4 v2, s[8:11], s36 offen offset:1024 lds
    v_mfma_f32_16x16x32_bf16 v[76:79], v[212:215], v[180:183], v[76:79]
    ds_read_b64_tr_b16 v[202:203], v10 offset:512
    v_mfma_f32_16x16x32_bf16 v[100:103], v[212:215], v[184:187], v[100:103]
    ds_read_b128 v[176:179], v5 offset:0
    buffer_load_dwordx4 v30, s[8:11], s36 offen offset:2048 lds
    v_mfma_f32_16x16x32_bf16 v[124:127], v[212:215], v[188:191], v[124:127]
    s_waitcnt lgkmcnt(3)
    v_mfma_f32_16x16x32_bf16 v[32:35], v[192:195], v[160:163], v[32:35]
    ds_read_b64_tr_b16 v[204:205], v11 offset:0
    v_mfma_f32_16x16x32_bf16 v[56:59], v[192:195], v[164:167], v[56:59]
    ds_read_b64_tr_b16 v[206:207], v11 offset:512
    v_mfma_f32_16x16x32_bf16 v[80:83], v[192:195], v[168:171], v[80:83]
    ds_read_b128 v[180:183], v5 offset:2048
    buffer_load_dwordx4 v31, s[8:11], s36 offen offset:3072 lds
    v_mfma_f32_16x16x32_bf16 v[104:107], v[192:195], v[172:175], v[104:107]
    v_mfma_f32_16x16x32_bf16 v[36:39], v[196:199], v[160:163], v[36:39]
    ds_read_b64_tr_b16 v[208:209], v12 offset:0
    v_mfma_f32_16x16x32_bf16 v[60:63], v[196:199], v[164:167], v[60:63]
    ds_read_b64_tr_b16 v[210:211], v12 offset:512
    s_add_u32 m0, s97, 49152
    v_mfma_f32_16x16x32_bf16 v[84:87], v[196:199], v[168:171], v[84:87]
    ds_read_b128 v[184:187], v5 offset:4096
    v_mfma_f32_16x16x32_bf16 v[108:111], v[196:199], v[172:175], v[108:111]
    s_waitcnt lgkmcnt(4)
    v_mfma_f32_16x16x32_bf16 v[40:43], v[200:203], v[160:163], v[40:43]
    ds_read_b64_tr_b16 v[212:213], v13 offset:0
    v_mfma_f32_16x16x32_bf16 v[64:67], v[200:203], v[164:167], v[64:67]
    ds_read_b64_tr_b16 v[214:215], v13 offset:512
    buffer_load_dwordx4 v3, s[12:15], s37 offen offset:0 lds
    v_mfma_f32_16x16x32_bf16 v[88:91], v[200:203], v[168:171], v[88:91]
    ds_read_b128 v[188:191], v5 offset:6144
    v_mfma_f32_16x16x32_bf16 v[112:115], v[200:203], v[172:175], v[112:115]
    v_mfma_f32_16x16x32_bf16 v[44:47], v[204:207], v[160:163], v[44:47]
    ds_read_b64_tr_b16 v[192:193], v8 offset:12288
    buffer_load_dwordx4 v224, s[12:15], s37 offen offset:1024 lds
    v_mfma_f32_16x16x32_bf16 v[68:71], v[204:207], v[164:167], v[68:71]
    v_mfma_f32_16x16x32_bf16 v[92:95], v[204:207], v[168:171], v[92:95]
    ds_read_b64_tr_b16 v[194:195], v8 offset:12800
    v_mfma_f32_16x16x32_bf16 v[116:119], v[204:207], v[172:175], v[116:119]
    s_waitcnt lgkmcnt(3)
    v_mfma_f32_16x16x32_bf16 v[48:51], v[208:211], v[160:163], v[48:51]
    ds_read_b64_tr_b16 v[196:197], v9 offset:12288
    buffer_load_dwordx4 v225, s[12:15], s37 offen offset:2048 lds
    v_mfma_f32_16x16x32_bf16 v[72:75], v[208:211], v[164:167], v[72:75]
    v_mfma_f32_16x16x32_bf16 v[96:99], v[208:211], v[168:171], v[96:99]
    ds_read_b64_tr_b16 v[198:199], v9 offset:12800
    v_mfma_f32_16x16x32_bf16 v[120:123], v[208:211], v[172:175], v[120:123]
    buffer_load_dwordx4 v24, s[12:15], s37 offen offset:3072 lds
    v_mfma_f32_16x16x32_bf16 v[52:55], v[212:215], v[160:163], v[52:55]
    ds_read_b64_tr_b16 v[200:201], v10 offset:12288
    v_mfma_f32_16x16x32_bf16 v[76:79], v[212:215], v[164:167], v[76:79]
    v_mfma_f32_16x16x32_bf16 v[100:103], v[212:215], v[168:171], v[100:103]
    ds_read_b64_tr_b16 v[202:203], v10 offset:12800
    v_mfma_f32_16x16x32_bf16 v[124:127], v[212:215], v[172:175], v[124:127]
    s_waitcnt lgkmcnt(2)
    s_add_u32 m0, s97, 53248
    v_mfma_f32_16x16x32_bf16 v[32:35], v[192:195], v[176:179], v[32:35]
    ds_read_b64_tr_b16 v[204:205], v11 offset:12288
    v_mfma_f32_16x16x32_bf16 v[56:59], v[192:195], v[180:183], v[56:59]
    v_mfma_f32_16x16x32_bf16 v[80:83], v[192:195], v[184:187], v[80:83]
    ds_read_b64_tr_b16 v[206:207], v11 offset:12800
    buffer_load_dwordx4 v226, s[12:15], s37 offen offset:0 lds
    v_mfma_f32_16x16x32_bf16 v[104:107], v[192:195], v[188:191], v[104:107]
    v_mfma_f32_16x16x32_bf16 v[36:39], v[196:199], v[176:179], v[36:39]
    ds_read_b64_tr_b16 v[208:209], v12 offset:12288
    v_mfma_f32_16x16x32_bf16 v[60:63], v[196:199], v[180:183], v[60:63]
    v_mfma_f32_16x16x32_bf16 v[84:87], v[196:199], v[184:187], v[84:87]
    ds_read_b64_tr_b16 v[210:211], v12 offset:12800
    buffer_load_dwordx4 v227, s[12:15], s37 offen offset:1024 lds
    v_mfma_f32_16x16x32_bf16 v[108:111], v[196:199], v[188:191], v[108:111]
    s_waitcnt lgkmcnt(2)
    v_mfma_f32_16x16x32_bf16 v[40:43], v[200:203], v[176:179], v[40:43]
    ds_read_b64_tr_b16 v[212:213], v13 offset:12288
    v_mfma_f32_16x16x32_bf16 v[64:67], v[200:203], v[180:183], v[64:67]
    v_mfma_f32_16x16x32_bf16 v[88:91], v[200:203], v[184:187], v[88:91]
    ds_read_b64_tr_b16 v[214:215], v13 offset:12800
    v_mfma_f32_16x16x32_bf16 v[112:115], v[200:203], v[188:191], v[112:115]
    s_waitcnt vmcnt(10) lgkmcnt(0)
    s_barrier
    v_mfma_f32_16x16x32_bf16 v[44:47], v[204:207], v[176:179], v[44:47]
    ds_read_b128 v[160:163], v4 offset:16384
    ds_read_b128 v[164:167], v4 offset:18432
    v_mfma_f32_16x16x32_bf16 v[68:71], v[204:207], v[180:183], v[68:71]
    ds_read_b128 v[168:171], v4 offset:20480
    s_add_u32 s36, s36, 128
    v_mfma_f32_16x16x32_bf16 v[92:95], v[204:207], v[184:187], v[92:95]
    ds_read_b128 v[172:175], v4 offset:22528
    ds_read_b64_tr_b16 v[192:193], v8 offset:24576
    v_mfma_f32_16x16x32_bf16 v[116:119], v[204:207], v[188:191], v[116:119]
    ds_read_b64_tr_b16 v[194:195], v8 offset:25088
    s_add_u32 s37, s37, 196608
    v_mfma_f32_16x16x32_bf16 v[48:51], v[208:211], v[176:179], v[48:51]
    ds_read_b64_tr_b16 v[196:197], v9 offset:24576
    s_cmp_eq_u32 s36, s34
    v_mfma_f32_16x16x32_bf16 v[72:75], v[208:211], v[180:183], v[72:75]
    s_cselect_b32 s37, s35, s37
    s_cselect_b32 s7, 1280, 0
    v_mfma_f32_16x16x32_bf16 v[96:99], v[208:211], v[184:187], v[96:99]
    ds_read_b64_tr_b16 v[198:199], v9 offset:25088
    s_sub_u32 s36, s36, s7
    v_mfma_f32_16x16x32_bf16 v[120:123], v[208:211], v[188:191], v[120:123]
    s_add_u32 m0, s96, 0
    s_nop 0
    buffer_load_dwordx4 v1, s[8:11], s36 offen offset:0 lds
    v_mfma_f32_16x16x32_bf16 v[52:55], v[212:215], v[176:179], v[52:55]
    ds_read_b64_tr_b16 v[200:201], v10 offset:24576
    buffer_load_dwordx4 v2, s[8:11], s36 offen offset:1024 lds
    v_mfma_f32_16x16x32_bf16 v[76:79], v[212:215], v[180:183], v[76:79]
    ds_read_b64_tr_b16 v[202:203], v10 offset:25088
    buffer_load_dwordx4 v30, s[8:11], s36 offen offset:2048 lds
    v_mfma_f32_16x16x32_bf16 v[100:103], v[212:215], v[184:187], v[100:103]
    ds_read_b128 v[176:179], v5 offset:16384
    v_mfma_f32_16x16x32_bf16 v[124:127], v[212:215], v[188:191], v[124:127]
    s_waitcnt lgkmcnt(3)
    v_mfma_f32_16x16x32_bf16 v[32:35], v[192:195], v[160:163], v[32:35]
    ds_read_b64_tr_b16 v[204:205], v11 offset:24576
    v_mfma_f32_16x16x32_bf16 v[56:59], v[192:195], v[164:167], v[56:59]
    ds_read_b64_tr_b16 v[206:207], v11 offset:25088
    buffer_load_dwordx4 v31, s[8:11], s36 offen offset:3072 lds
    v_mfma_f32_16x16x32_bf16 v[80:83], v[192:195], v[168:171], v[80:83]
    ds_read_b128 v[180:183], v5 offset:18432
    v_mfma_f32_16x16x32_bf16 v[104:107], v[192:195], v[172:175], v[104:107]
    v_mfma_f32_16x16x32_bf16 v[36:39], v[196:199], v[160:163], v[36:39]
    ds_read_b64_tr_b16 v[208:209], v12 offset:24576
    s_add_u32 m0, s97, 0
    v_mfma_f32_16x16x32_bf16 v[60:63], v[196:199], v[164:167], v[60:63]
    ds_read_b64_tr_b16 v[210:211], v12 offset:25088
    v_mfma_f32_16x16x32_bf16 v[84:87], v[196:199], v[168:171], v[84:87]
    ds_read_b128 v[184:187], v5 offset:20480
    v_mfma_f32_16x16x32_bf16 v[108:111], v[196:199], v[172:175], v[108:111]
    s_waitcnt lgkmcnt(4)
    buffer_load_dwordx4 v3, s[12:15], s37 offen offset:0 lds
    v_mfma_f32_16x16x32_bf16 v[40:43], v[200:203], v[160:163], v[40:43]
    ds_read_b64_tr_b16 v[212:213], v13 offset:24576
    v_mfma_f32_16x16x32_bf16 v[64:67], v[200:203], v[164:167], v[64:67]
    ds_read_b64_tr_b16 v[214:215], v13 offset:25088
    v_mfma_f32_16x16x32_bf16 v[88:91], v[200:203], v[168:171], v[88:91]
    ds_read_b128 v[188:191], v5 offset:22528
    v_mfma_f32_16x16x32_bf16 v[112:115], v[200:203], v[172:175], v[112:115]
    buffer_load_dwordx4 v224, s[12:15], s37 offen offset:1024 lds
    v_mfma_f32_16x16x32_bf16 v[44:47], v[204:207], v[160:163], v[44:47]
    ds_read_b64_tr_b16 v[192:193], v8 offset:36864
    v_mfma_f32_16x16x32_bf16 v[68:71], v[204:207], v[164:167], v[68:71]
    v_mfma_f32_16x16x32_bf16 v[92:95], v[204:207], v[168:171], v[92:95]
    ds_read_b64_tr_b16 v[194:195], v8 offset:37376
    buffer_load_dwordx4 v225, s[12:15], s37 offen offset:2048 lds
    v_mfma_f32_16x16x32_bf16 v[116:119], v[204:207], v[172:175], v[116:119]
    s_waitcnt lgkmcnt(3)
    v_mfma_f32_16x16x32_bf16 v[48:51], v[208:211], v[160:163], v[48:51]
    ds_read_b64_tr_b16 v[196:197], v9 offset:36864
    v_mfma_f32_16x16x32_bf16 v[72:75], v[208:211], v[164:167], v[72:75]
    buffer_load_dwordx4 v24, s[12:15], s37 offen offset:3072 lds
    v_mfma_f32_16x16x32_bf16 v[96:99], v[208:211], v[168:171], v[96:99]
    ds_read_b64_tr_b16 v[198:199], v9 offset:37376
    v_mfma_f32_16x16x32_bf16 v[120:123], v[208:211], v[172:175], v[120:123]
    v_mfma_f32_16x16x32_bf16 v[52:55], v[212:215], v[160:163], v[52:55]
    ds_read_b64_tr_b16 v[200:201], v10 offset:36864
    s_add_u32 m0, s97, 4096
    v_mfma_f32_16x16x32_bf16 v[76:79], v[212:215], v[164:167], v[76:79]
    v_mfma_f32_16x16x32_bf16 v[100:103], v[212:215], v[168:171], v[100:103]
    ds_read_b64_tr_b16 v[202:203], v10 offset:37376
    v_mfma_f32_16x16x32_bf16 v[124:127], v[212:215], v[172:175], v[124:127]
    s_waitcnt lgkmcnt(2)
    v_mfma_f32_16x16x32_bf16 v[32:35], v[192:195], v[176:179], v[32:35]
    ds_read_b64_tr_b16 v[204:205], v11 offset:36864
    buffer_load_dwordx4 v226, s[12:15], s37 offen offset:0 lds
    v_mfma_f32_16x16x32_bf16 v[56:59], v[192:195], v[180:183], v[56:59]
    v_mfma_f32_16x16x32_bf16 v[80:83], v[192:195], v[184:187], v[80:83]
    ds_read_b64_tr_b16 v[206:207], v11 offset:37376
    v_mfma_f32_16x16x32_bf16 v[104:107], v[192:195], v[188:191], v[104:107]
    buffer_load_dwordx4 v227, s[12:15], s37 offen offset:1024 lds
    v_mfma_f32_16x16x32_bf16 v[36:39], v[196:199], v[176:179], v[36:39]
    ds_read_b64_tr_b16 v[208:209], v12 offset:36864
    v_mfma_f32_16x16x32_bf16 v[60:63], v[196:199], v[180:183], v[60:63]
    v_mfma_f32_16x16x32_bf16 v[84:87], v[196:199], v[184:187], v[84:87]
    ds_read_b64_tr_b16 v[210:211], v12 offset:37376
    v_mfma_f32_16x16x32_bf16 v[108:111], v[196:199], v[188:191], v[108:111]
    s_waitcnt lgkmcnt(2)
    v_mfma_f32_16x16x32_bf16 v[40:43], v[200:203], v[176:179], v[40:43]
    ds_read_b64_tr_b16 v[212:213], v13 offset:36864
    v_mfma_f32_16x16x32_bf16 v[64:67], v[200:203], v[180:183], v[64:67]
    v_mfma_f32_16x16x32_bf16 v[88:91], v[200:203], v[184:187], v[88:91]
    ds_read_b64_tr_b16 v[214:215], v13 offset:37376
    v_mfma_f32_16x16x32_bf16 v[112:115], v[200:203], v[188:191], v[112:115]
    s_waitcnt vmcnt(10) lgkmcnt(0)
    s_barrier
    v_mfma_f32_16x16x32_bf16 v[44:47], v[204:207], v[176:179], v[44:47]
    ds_read_b128 v[160:163], v4 offset:32768
    ds_read_b128 v[164:167], v4 offset:34816
    v_mfma_f32_16x16x32_bf16 v[68:71], v[204:207], v[180:183], v[68:71]
    ds_read_b128 v[168:171], v4 offset:36864
    s_lshl_b32 s7, s32, 3
    v_mfma_f32_16x16x32_bf16 v[92:95], v[204:207], v[184:187], v[92:95]
    ds_read_b128 v[172:175], v4 offset:38912
    ds_read_b64_tr_b16 v[192:193], v14 offset:0
    v_mfma_f32_16x16x32_bf16 v[116:119], v[204:207], v[188:191], v[116:119]
    ds_read_b64_tr_b16 v[194:195], v14 offset:512
    s_lshl_b32 s62, s3, 1
    v_mfma_f32_16x16x32_bf16 v[48:51], v[208:211], v[176:179], v[48:51]
    ds_read_b64_tr_b16 v[196:197], v15 offset:0
    s_add_u32 s7, s7, s62
    v_mfma_f32_16x16x32_bf16 v[72:75], v[208:211], v[180:183], v[72:75]
    s_lshl_b32 s62, s7, 7
    v_and_b32 v249, 1, v20
    v_mfma_f32_16x16x32_bf16 v[96:99], v[208:211], v[184:187], v[96:99]
    ds_read_b64_tr_b16 v[198:199], v15 offset:512
    v_lshl_add_u32 v249, v249, 7, s62
    v_mfma_f32_16x16x32_bf16 v[120:123], v[208:211], v[188:191], v[120:123]
    v_add_u32 v251, 16384, v249
    v_add_u32 v250, 81920, v249
    v_mfma_f32_16x16x32_bf16 v[52:55], v[212:215], v[176:179], v[52:55]
    ds_read_b64_tr_b16 v[200:201], v16 offset:0
    s_lshl_b32 s40, s32, 3
    v_mfma_f32_16x16x32_bf16 v[76:79], v[212:215], v[180:183], v[76:79]
    ds_read_b64_tr_b16 v[202:203], v16 offset:512
    s_add_u32 s40, s40, 0
    v_mfma_f32_16x16x32_bf16 v[100:103], v[212:215], v[184:187], v[100:103]
    ds_read_b128 v[176:179], v5 offset:32768
    s_lshl_b32 s41, s40, 2
    v_mfma_f32_16x16x32_bf16 v[124:127], v[212:215], v[188:191], v[124:127]
    s_waitcnt lgkmcnt(3)
    s_mul_i32 s40, s40, 48
    v_mfma_f32_16x16x32_bf16 v[32:35], v[192:195], v[160:163], v[32:35]
    ds_read_b64_tr_b16 v[204:205], v17 offset:0
    s_mul_i32 s7, s3, 12
    v_mfma_f32_16x16x32_bf16 v[56:59], v[192:195], v[164:167], v[56:59]
    ds_read_b64_tr_b16 v[206:207], v17 offset:512
    s_add_u32 s40, s40, s7
    v_mfma_f32_16x16x32_bf16 v[80:83], v[192:195], v[168:171], v[80:83]
    ds_read_b128 v[180:183], v5 offset:34816
    s_lshl_b32 s40, s40, 10
    v_mfma_f32_16x16x32_bf16 v[104:107], v[192:195], v[172:175], v[104:107]
    s_add_u32 s40, s40, 4194304
    s_add_u32 s41, s41, s3
    v_mfma_f32_16x16x32_bf16 v[36:39], v[196:199], v[160:163], v[36:39]
    ds_read_b64_tr_b16 v[208:209], v18 offset:0
    s_mul_i32 s41, s41, 5120
    v_mfma_f32_16x16x32_bf16 v[60:63], v[196:199], v[164:167], v[60:63]
    ds_read_b64_tr_b16 v[210:211], v18 offset:512
    s_add_u32 s41, s41, 10485760
    v_mfma_f32_16x16x32_bf16 v[84:87], v[196:199], v[168:171], v[84:87]
    ds_read_b128 v[184:187], v5 offset:36864
    s_lshl_b32 s43, s32, 7
    v_mfma_f32_16x16x32_bf16 v[108:111], v[196:199], v[172:175], v[108:111]
    s_waitcnt lgkmcnt(4)
    s_add_u32 s43, s43, 0
    v_mfma_f32_16x16x32_bf16 v[40:43], v[200:203], v[160:163], v[40:43]
    ds_read_b64_tr_b16 v[212:213], v19 offset:0
    s_lshl_b32 s42, s43, 2
    v_mfma_f32_16x16x32_bf16 v[64:67], v[200:203], v[164:167], v[64:67]
    ds_read_b64_tr_b16 v[214:215], v19 offset:512
    s_lshl_b32 s62, s3, 14
    v_mfma_f32_16x16x32_bf16 v[88:91], v[200:203], v[168:171], v[88:91]
    ds_read_b128 v[188:191], v5 offset:38912
    s_add_u32 s42, s42, s62
    v_mfma_f32_16x16x32_bf16 v[112:115], v[200:203], v[172:175], v[112:115]
    s_add_u32 s42, s42, 196608
    s_mul_i32 s43, s43, 1280
    v_mfma_f32_16x16x32_bf16 v[44:47], v[204:207], v[160:163], v[44:47]
    ds_read_b64_tr_b16 v[192:193], v14 offset:12288
    s_mul_i32 s62, s33, 160
    v_mfma_f32_16x16x32_bf16 v[68:71], v[204:207], v[164:167], v[68:71]
    s_add_u32 s43, s43, s62
    v_and_b32 v254, 15, v20
    v_mfma_f32_16x16x32_bf16 v[92:95], v[204:207], v[168:171], v[92:95]
    ds_read_b64_tr_b16 v[194:195], v14 offset:12800
    v_lshlrev_b32 v253, 2, v254
    v_mfma_f32_16x16x32_bf16 v[116:119], v[204:207], v[172:175], v[116:119]
    s_waitcnt lgkmcnt(3)
    v_lshlrev_b32 v252, 3, v20
    v_mfma_f32_16x16x32_bf16 v[48:51], v[208:211], v[160:163], v[48:51]
    ds_read_b64_tr_b16 v[196:197], v15 offset:12288
    v_add_u32 v255, s48, v21
    v_mfma_f32_16x16x32_bf16 v[72:75], v[208:211], v[164:167], v[72:75]
    v_mul_u32_u24 v254, 160, v254
    v_bfe_u32 v30, v20, 4, 1
    v_mfma_f32_16x16x32_bf16 v[96:99], v[208:211], v[168:171], v[96:99]
    ds_read_b64_tr_b16 v[198:199], v15 offset:12800
    v_mul_u32_u24 v30, 12800, v30
    v_mfma_f32_16x16x32_bf16 v[120:123], v[208:211], v[172:175], v[120:123]
    v_add_u32 v254, v254, v30
    v_lshrrev_b32 v30, 5, v20
    v_mfma_f32_16x16x32_bf16 v[52:55], v[212:215], v[160:163], v[52:55]
    ds_read_b64_tr_b16 v[200:201], v16 offset:12288
    v_bfe_u32 v31, v20, 2, 1
    v_mfma_f32_16x16x32_bf16 v[76:79], v[212:215], v[164:167], v[76:79]
    v_xor_b32 v30, v30, v31
    v_lshl_add_u32 v254, v30, 4, v254
    v_mfma_f32_16x16x32_bf16 v[100:103], v[212:215], v[168:171], v[100:103]
    ds_read_b64_tr_b16 v[202:203], v16 offset:12800
    v_add_u32 v254, s48, v254
    v_mfma_f32_16x16x32_bf16 v[124:127], v[212:215], v[172:175], v[124:127]
    s_waitcnt lgkmcnt(2)
    v_add_u32 v30, 0, v0
    v_mfma_f32_16x16x32_bf16 v[32:35], v[192:195], v[176:179], v[32:35]
    ds_read_b64_tr_b16 v[204:205], v17 offset:12288
    s_mov_b32 s7, 0x1999999a
    v_mfma_f32_16x16x32_bf16 v[56:59], v[192:195], v[180:183], v[56:59]
    v_mul_hi_u32 v240, v30, s7
    v_mul_u32_u24 v244, 10, v240
    v_mfma_f32_16x16x32_bf16 v[80:83], v[192:195], v[184:187], v[80:83]
    ds_read_b64_tr_b16 v[206:207], v17 offset:12800
    v_sub_u32 v31, v30, v244
    v_mfma_f32_16x16x32_bf16 v[104:107], v[192:195], v[188:191], v[104:107]
    v_lshlrev_b32 v31, 4, v31
    v_mul_u32_u24 v244, 160, v240
    v_mfma_f32_16x16x32_bf16 v[36:39], v[196:199], v[176:179], v[36:39]
    ds_read_b64_tr_b16 v[208:209], v18 offset:12288
    v_add_u32 v244, v244, v31
    v_mfma_f32_16x16x32_bf16 v[60:63], v[196:199], v[180:183], v[60:63]
    v_and_b32 v248, 4, v240
    v_lshlrev_b32 v248, 2, v248
    v_mfma_f32_16x16x32_bf16 v[84:87], v[196:199], v[184:187], v[84:87]
    ds_read_b64_tr_b16 v[210:211], v18 offset:12800
    v_xor_b32 v244, v244, v248
    v_mfma_f32_16x16x32_bf16 v[108:111], v[196:199], v[188:191], v[108:111]
    s_waitcnt lgkmcnt(2)
    v_mul_u32_u24 v240, 1280, v240
    v_mfma_f32_16x16x32_bf16 v[40:43], v[200:203], v[176:179], v[40:43]
    ds_read_b64_tr_b16 v[212:213], v19 offset:12288
    v_add_u32 v240, v240, v31
    v_mfma_f32_16x16x32_bf16 v[64:67], v[200:203], v[180:183], v[64:67]
    v_add_u32 v30, 256, v0
    s_mov_b32 s7, 0x1999999a
    v_mfma_f32_16x16x32_bf16 v[88:91], v[200:203], v[184:187], v[88:91]
    ds_read_b64_tr_b16 v[214:215], v19 offset:12800
    v_mul_hi_u32 v241, v30, s7
    v_mfma_f32_16x16x32_bf16 v[112:115], v[200:203], v[188:191], v[112:115]
    v_mul_u32_u24 v245, 10, v241
    v_sub_u32 v31, v30, v245
    v_lshlrev_b32 v31, 4, v31
    v_mul_u32_u24 v245, 160, v241
    v_add_u32 v245, v245, v31
    v_and_b32 v248, 4, v241
    v_lshlrev_b32 v248, 2, v248
    v_xor_b32 v245, v245, v248
    v_mul_u32_u24 v241, 1280, v241
    v_add_u32 v241, v241, v31
    v_add_u32 v30, 512, v0
    s_mov_b32 s7, 0x1999999a
    v_mul_hi_u32 v242, v30, s7
    v_mul_u32_u24 v246, 10, v242
    v_sub_u32 v31, v30, v246
    v_lshlrev_b32 v31, 4, v31
    v_mul_u32_u24 v246, 160, v242
    v_add_u32 v246, v246, v31
    v_and_b32 v248, 4, v242
    v_lshlrev_b32 v248, 2, v248
    v_xor_b32 v246, v246, v248
    v_mul_u32_u24 v242, 1280, v242
    v_add_u32 v242, v242, v31
    v_lshrrev_b32 v30, 3, v0
    v_add_u32 v30, 768, v30
    s_mov_b32 s7, 0x1999999a
    v_mul_hi_u32 v243, v30, s7
    v_and_b32 v248, 4, v243
    v_lshlrev_b32 v248, 2, v248
    v_mul_u32_u24 v243, 1120, v243
    v_lshl_add_u32 v243, v30, 4, v243
    v_and_b32 v31, 7, v0
    v_lshl_add_u32 v243, v31, 1, v243
    v_bfe_u32 v247, v0, 2, 1
    v_mul_u32_u24 v247, 12800, v247
    v_lshl_add_u32 v247, v30, 4, v247
    v_and_b32 v31, 3, v0
    v_lshl_add_u32 v247, v31, 2, v247
    v_xor_b32 v247, v247, v248
    s_mov_b64 s[24:25], s[56:57]
    s_mov_b32 s26, 2621440
    s_mov_b32 s27, 0x20000
    s_waitcnt vmcnt(0) lgkmcnt(0)
    s_barrier
    v_mfma_f32_16x16x32_bf16 v[44:47], v[204:207], v[176:179], v[44:47]
    ds_read_b128 v[160:163], v4 offset:0
    ds_read_b128 v[164:167], v4 offset:2048
    v_mfma_f32_16x16x32_bf16 v[68:71], v[204:207], v[180:183], v[68:71]
    ds_read_b128 v[168:171], v4 offset:4096
    buffer_load_dword v26, v231, s[16:19], 0 offen sc1
    v_mfma_f32_16x16x32_bf16 v[92:95], v[204:207], v[184:187], v[92:95]
    ds_read_b128 v[172:175], v4 offset:6144
    ds_read_b64_tr_b16 v[192:193], v8 offset:0
    v_mfma_f32_16x16x32_bf16 v[116:119], v[204:207], v[188:191], v[116:119]
    ds_read_b64_tr_b16 v[194:195], v8 offset:512
    v_mfma_f32_16x16x32_bf16 v[48:51], v[208:211], v[176:179], v[48:51]
    ds_read_b64_tr_b16 v[196:197], v9 offset:0
    v_mfma_f32_16x16x32_bf16 v[72:75], v[208:211], v[180:183], v[72:75]
    v_mfma_f32_16x16x32_bf16 v[96:99], v[208:211], v[184:187], v[96:99]
    ds_read_b64_tr_b16 v[198:199], v9 offset:512
    v_mfma_f32_16x16x32_bf16 v[120:123], v[208:211], v[188:191], v[120:123]
    v_mfma_f32_16x16x32_bf16 v[52:55], v[212:215], v[176:179], v[52:55]
    ds_read_b64_tr_b16 v[200:201], v10 offset:0
    v_mfma_f32_16x16x32_bf16 v[76:79], v[212:215], v[180:183], v[76:79]
    ds_read_b64_tr_b16 v[202:203], v10 offset:512
    v_mfma_f32_16x16x32_bf16 v[100:103], v[212:215], v[184:187], v[100:103]
    ds_read_b128 v[176:179], v5 offset:0
    v_mfma_f32_16x16x32_bf16 v[124:127], v[212:215], v[188:191], v[124:127]
    s_waitcnt lgkmcnt(3)
    v_mfma_f32_16x16x32_bf16 v[32:35], v[192:195], v[160:163], v[32:35]
    ds_read_b64_tr_b16 v[204:205], v11 offset:0
    v_mfma_f32_16x16x32_bf16 v[56:59], v[192:195], v[164:167], v[56:59]
    ds_read_b64_tr_b16 v[206:207], v11 offset:512
    v_mfma_f32_16x16x32_bf16 v[80:83], v[192:195], v[168:171], v[80:83]
    ds_read_b128 v[180:183], v5 offset:2048
    v_mfma_f32_16x16x32_bf16 v[104:107], v[192:195], v[172:175], v[104:107]
    v_mfma_f32_16x16x32_bf16 v[36:39], v[196:199], v[160:163], v[36:39]
    ds_read_b64_tr_b16 v[208:209], v12 offset:0
    v_mfma_f32_16x16x32_bf16 v[60:63], v[196:199], v[164:167], v[60:63]
    ds_read_b64_tr_b16 v[210:211], v12 offset:512
    v_mfma_f32_16x16x32_bf16 v[84:87], v[196:199], v[168:171], v[84:87]
    ds_read_b128 v[184:187], v5 offset:4096
    v_mfma_f32_16x16x32_bf16 v[108:111], v[196:199], v[172:175], v[108:111]
    s_waitcnt lgkmcnt(4)
    v_mfma_f32_16x16x32_bf16 v[40:43], v[200:203], v[160:163], v[40:43]
    ds_read_b64_tr_b16 v[212:213], v13 offset:0
    v_mfma_f32_16x16x32_bf16 v[64:67], v[200:203], v[164:167], v[64:67]
    ds_read_b64_tr_b16 v[214:215], v13 offset:512
    v_mfma_f32_16x16x32_bf16 v[88:91], v[200:203], v[168:171], v[88:91]
    ds_read_b128 v[188:191], v5 offset:6144
    v_mfma_f32_16x16x32_bf16 v[112:115], v[200:203], v[172:175], v[112:115]
    v_mfma_f32_16x16x32_bf16 v[44:47], v[204:207], v[160:163], v[44:47]
    ds_read_b64_tr_b16 v[192:193], v8 offset:12288
    v_mfma_f32_16x16x32_bf16 v[68:71], v[204:207], v[164:167], v[68:71]
    v_mfma_f32_16x16x32_bf16 v[92:95], v[204:207], v[168:171], v[92:95]
    ds_read_b64_tr_b16 v[194:195], v8 offset:12800
    v_mfma_f32_16x16x32_bf16 v[116:119], v[204:207], v[172:175], v[116:119]
    s_waitcnt lgkmcnt(3)
    v_mfma_f32_16x16x32_bf16 v[48:51], v[208:211], v[160:163], v[48:51]
    ds_read_b64_tr_b16 v[196:197], v9 offset:12288
    v_mfma_f32_16x16x32_bf16 v[72:75], v[208:211], v[164:167], v[72:75]
    v_mfma_f32_16x16x32_bf16 v[96:99], v[208:211], v[168:171], v[96:99]
    ds_read_b64_tr_b16 v[198:199], v9 offset:12800
    v_mfma_f32_16x16x32_bf16 v[120:123], v[208:211], v[172:175], v[120:123]
    v_mfma_f32_16x16x32_bf16 v[52:55], v[212:215], v[160:163], v[52:55]
    ds_read_b64_tr_b16 v[200:201], v10 offset:12288
    v_mfma_f32_16x16x32_bf16 v[76:79], v[212:215], v[164:167], v[76:79]
    v_mfma_f32_16x16x32_bf16 v[100:103], v[212:215], v[168:171], v[100:103]
    ds_read_b64_tr_b16 v[202:203], v10 offset:12800
    v_mfma_f32_16x16x32_bf16 v[124:127], v[212:215], v[172:175], v[124:127]
    s_waitcnt lgkmcnt(2)
    v_mfma_f32_16x16x32_bf16 v[32:35], v[192:195], v[176:179], v[32:35]
    ds_read_b64_tr_b16 v[204:205], v11 offset:12288
    v_mfma_f32_16x16x32_bf16 v[56:59], v[192:195], v[180:183], v[56:59]
    v_mfma_f32_16x16x32_bf16 v[80:83], v[192:195], v[184:187], v[80:83]
    ds_read_b64_tr_b16 v[206:207], v11 offset:12800
    v_mfma_f32_16x16x32_bf16 v[104:107], v[192:195], v[188:191], v[104:107]
    v_mfma_f32_16x16x32_bf16 v[36:39], v[196:199], v[176:179], v[36:39]
    ds_read_b64_tr_b16 v[208:209], v12 offset:12288
    v_mfma_f32_16x16x32_bf16 v[60:63], v[196:199], v[180:183], v[60:63]
    v_mfma_f32_16x16x32_bf16 v[84:87], v[196:199], v[184:187], v[84:87]
    ds_read_b64_tr_b16 v[210:211], v12 offset:12800
    v_mfma_f32_16x16x32_bf16 v[108:111], v[196:199], v[188:191], v[108:111]
    s_waitcnt lgkmcnt(2)
    v_mfma_f32_16x16x32_bf16 v[40:43], v[200:203], v[176:179], v[40:43]
    ds_read_b64_tr_b16 v[212:213], v13 offset:12288
    v_mfma_f32_16x16x32_bf16 v[64:67], v[200:203], v[180:183], v[64:67]
    v_mfma_f32_16x16x32_bf16 v[88:91], v[200:203], v[184:187], v[88:91]
    ds_read_b64_tr_b16 v[214:215], v13 offset:12800
    v_mfma_f32_16x16x32_bf16 v[112:115], v[200:203], v[188:191], v[112:115]
    v_mfma_f32_16x16x32_bf16 v[44:47], v[204:207], v[176:179], v[44:47]
    v_mfma_f32_16x16x32_bf16 v[68:71], v[204:207], v[180:183], v[68:71]
    v_mfma_f32_16x16x32_bf16 v[92:95], v[204:207], v[184:187], v[92:95]
    v_mfma_f32_16x16x32_bf16 v[116:119], v[204:207], v[188:191], v[116:119]
    s_waitcnt lgkmcnt(0)
    v_mfma_f32_16x16x32_bf16 v[48:51], v[208:211], v[176:179], v[48:51]
    v_mfma_f32_16x16x32_bf16 v[72:75], v[208:211], v[180:183], v[72:75]
    v_mfma_f32_16x16x32_bf16 v[96:99], v[208:211], v[184:187], v[96:99]
    v_mfma_f32_16x16x32_bf16 v[120:123], v[208:211], v[188:191], v[120:123]
    v_mfma_f32_16x16x32_bf16 v[52:55], v[212:215], v[176:179], v[52:55]
    v_mfma_f32_16x16x32_bf16 v[76:79], v[212:215], v[180:183], v[76:79]
    v_mfma_f32_16x16x32_bf16 v[100:103], v[212:215], v[184:187], v[100:103]
    v_mfma_f32_16x16x32_bf16 v[124:127], v[212:215], v[188:191], v[124:127]
    s_barrier
    s_waitcnt vmcnt(0)
    v_cmp_ne_u32 vcc, 0, v26
    s_mov_b32 s98, 0
    s_nop 0
    s_cmp_eq_u64 vcc, -1
    s_cbranch_scc1 L_ok_23
L_spin_24:
    buffer_load_dword v26, v231, s[16:19], 0 offen sc1
    s_add_u32 s98, s98, 1
    s_waitcnt vmcnt(0)
    v_cmp_ne_u32 vcc, 0, v26
    s_cmp_gt_u32 s98, 0x40000
    s_cbranch_scc1 L_ok_23
    s_cmp_eq_u64 vcc, -1
    s_cbranch_scc0 L_spin_24
L_ok_23:
    v_mov_b32 v128, 1069066811
    v_mov_b32 v129, 1069066811
    v_mov_b32 v130, -1.0
    v_mov_b32 v131, -1.0
    v_mov_b32 v132, 0.5
    v_mov_b32 v133, 0.5
    s_lshl_b32 s36, s4, 3
    s_lshr_b32 s7, s3, 1
    s_lshl_b32 s7, s7, 2
    s_add_u32 s36, s36, s7
    s_mul_i32 s36, s36, 48
    s_mul_i32 s7, s5, 6
    s_add_u32 s36, s36, s7
    s_and_b32 s7, s3, 1
    s_mul_i32 s7, s7, 3
    s_add_u32 s36, s36, s7
    s_lshl_b32 s36, s36, 10
    s_add_u32 s36, s36, 4194304
    s_mov_b32 s62, 0x42700000
    v_pk_fma_f32 v[136:137], v[32:33], v[128:129], v[130:131]
    v_pk_fma_f32 v[138:139], v[34:35], v[128:129], v[130:131]
    v_pk_fma_f32 v[140:141], v[36:37], v[128:129], v[130:131]
    v_pk_fma_f32 v[142:143], v[38:39], v[128:129], v[130:131]
    s_add_u32 s99, s44, 0
    buffer_load_dwordx4 a[0:3], v21, s[16:19], s99 offen offset:0 sc1
    v_min_f32 v136, s62, v136
    v_min_f32 v137, s62, v137
    v_min_f32 v138, s62, v138
    v_min_f32 v139, s62, v139
    v_min_f32 v140, s62, v140
    v_min_f32 v141, s62, v141
    v_min_f32 v142, s62, v142
    v_min_f32 v143, s62, v143
    v_exp_f32 v136, v136
    v_exp_f32 v137, v137
    v_exp_f32 v138, v138
    v_exp_f32 v139, v139
    v_exp_f32 v140, v140
    v_exp_f32 v141, v141
    v_exp_f32 v142, v142
    v_exp_f32 v143, v143
    v_pk_fma_f32 v[136:137], v[136:137], v[136:137], v[136:137]
    v_pk_fma_f32 v[138:139], v[138:139], v[138:139], v[138:139]
    v_pk_fma_f32 v[140:141], v[140:141], v[140:141], v[140:141]
    v_pk_fma_f32 v[142:143], v[142:143], v[142:143], v[142:143]
    v_pk_add_f32 v[144:145], v[136:137], v[132:133]
    v_pk_add_f32 v[146:147], v[138:139], v[132:133]
    v_pk_add_f32 v[148:149], v[140:141], v[132:133]
    v_pk_add_f32 v[150:151], v[142:143], v[132:133]
    v_rcp_f32 v144, v144
    v_rcp_f32 v145, v145
    v_rcp_f32 v146, v146
    v_rcp_f32 v147, v147
    v_rcp_f32 v148, v148
    v_rcp_f32 v149, v149
    v_rcp_f32 v150, v150
    v_rcp_f32 v151, v151
    v_pk_mul_f32 v[136:137], v[136:137], v[144:145]
    v_pk_mul_f32 v[138:139], v[138:139], v[146:147]
    v_pk_mul_f32 v[140:141], v[140:141], v[148:149]
    v_pk_mul_f32 v[142:143], v[142:143], v[150:151]
    v_pk_mul_f32 v[136:137], v[136:137], v[32:33]
    v_pk_mul_f32 v[138:139], v[138:139], v[34:35]
    v_pk_mul_f32 v[140:141], v[140:141], v[36:37]
    v_pk_mul_f32 v[142:143], v[142:143], v[38:39]
    v_cvt_pk_bf16_f32 v152, v136, v137
    v_cvt_pk_bf16_f32 v153, v138, v139
    v_cvt_pk_bf16_f32 v154, v140, v141
    v_cvt_pk_bf16_f32 v155, v142, v143
    s_add_u32 s7, s36, 0
    buffer_store_dwordx4 v[152:155], v21, s[16:19], s7 offen sc1
    v_pk_fma_f32 v[136:137], v[56:57], v[128:129], v[130:131]
    v_pk_fma_f32 v[138:139], v[58:59], v[128:129], v[130:131]
    v_pk_fma_f32 v[140:141], v[60:61], v[128:129], v[130:131]
    v_pk_fma_f32 v[142:143], v[62:63], v[128:129], v[130:131]
    buffer_load_dwordx4 a[4:7], v21, s[16:19], s99 offen offset:1024 sc1
    v_min_f32 v136, s62, v136
    v_min_f32 v137, s62, v137
    v_min_f32 v138, s62, v138
    v_min_f32 v139, s62, v139
    v_min_f32 v140, s62, v140
    v_min_f32 v141, s62, v141
    v_min_f32 v142, s62, v142
    v_min_f32 v143, s62, v143
    v_exp_f32 v136, v136
    v_exp_f32 v137, v137
    v_exp_f32 v138, v138
    v_exp_f32 v139, v139
    v_exp_f32 v140, v140
    v_exp_f32 v141, v141
    v_exp_f32 v142, v142
    v_exp_f32 v143, v143
    v_pk_fma_f32 v[136:137], v[136:137], v[136:137], v[136:137]
    v_pk_fma_f32 v[138:139], v[138:139], v[138:139], v[138:139]
    v_pk_fma_f32 v[140:141], v[140:141], v[140:141], v[140:141]
    v_pk_fma_f32 v[142:143], v[142:143], v[142:143], v[142:143]
    v_pk_add_f32 v[144:145], v[136:137], v[132:133]
    v_pk_add_f32 v[146:147], v[138:139], v[132:133]
    v_pk_add_f32 v[148:149], v[140:141], v[132:133]
    v_pk_add_f32 v[150:151], v[142:143], v[132:133]
    buffer_load_dwordx4 a[8:11], v21, s[16:19], s99 offen offset:2048 sc1
    v_rcp_f32 v144, v144
    v_rcp_f32 v145, v145
    v_rcp_f32 v146, v146
    v_rcp_f32 v147, v147
    v_rcp_f32 v148, v148
    v_rcp_f32 v149, v149
    v_rcp_f32 v150, v150
    v_rcp_f32 v151, v151
    v_pk_mul_f32 v[136:137], v[136:137], v[144:145]
    v_pk_mul_f32 v[138:139], v[138:139], v[146:147]
    v_pk_mul_f32 v[140:141], v[140:141], v[148:149]
    v_pk_mul_f32 v[142:143], v[142:143], v[150:151]
    v_pk_mul_f32 v[136:137], v[136:137], v[56:57]
    v_pk_mul_f32 v[138:139], v[138:139], v[58:59]
    v_pk_mul_f32 v[140:141], v[140:141], v[60:61]
    v_pk_mul_f32 v[142:143], v[142:143], v[62:63]
    v_cvt_pk_bf16_f32 v156, v136, v137
    v_cvt_pk_bf16_f32 v157, v138, v139
    v_cvt_pk_bf16_f32 v158, v140, v141
    v_cvt_pk_bf16_f32 v159, v142, v143
    s_add_u32 s7, s36, 49152
    buffer_store_dwordx4 v[156:159], v21, s[16:19], s7 offen sc1
    v_pk_fma_f32 v[136:137], v[80:81], v[128:129], v[130:131]
    v_pk_fma_f32 v[138:139], v[82:83], v[128:129], v[130:131]
    v_pk_fma_f32 v[140:141], v[84:85], v[128:129], v[130:131]
    v_pk_fma_f32 v[142:143], v[86:87], v[128:129], v[130:131]
    buffer_load_dwordx4 a[12:15], v21, s[16:19], s99 offen offset:3072 sc1
    v_min_f32 v136, s62, v136
    v_min_f32 v137, s62, v137
    v_min_f32 v138, s62, v138
    v_min_f32 v139, s62, v139
    v_min_f32 v140, s62, v140
    v_min_f32 v141, s62, v141
    v_min_f32 v142, s62, v142
    v_min_f32 v143, s62, v143
    v_exp_f32 v136, v136
    v_exp_f32 v137, v137
    v_exp_f32 v138, v138
    v_exp_f32 v139, v139
    v_exp_f32 v140, v140
    v_exp_f32 v141, v141
    v_exp_f32 v142, v142
    v_exp_f32 v143, v143
    v_pk_fma_f32 v[136:137], v[136:137], v[136:137], v[136:137]
    v_pk_fma_f32 v[138:139], v[138:139], v[138:139], v[138:139]
    v_pk_fma_f32 v[140:141], v[140:141], v[140:141], v[140:141]
    v_pk_fma_f32 v[142:143], v[142:143], v[142:143], v[142:143]
    v_pk_add_f32 v[144:145], v[136:137], v[132:133]
    v_pk_add_f32 v[146:147], v[138:139], v[132:133]
    v_pk_add_f32 v[148:149], v[140:141], v[132:133]
    v_pk_add_f32 v[150:151], v[142:143], v[132:133]
    s_add_u32 s99, s44, 4096
    buffer_load_dwordx4 a[16:19], v21, s[16:19], s99 offen offset:0 sc1
    v_rcp_f32 v144, v144
    v_rcp_f32 v145, v145
    v_rcp_f32 v146, v146
    v_rcp_f32 v147, v147
    v_rcp_f32 v148, v148
    v_rcp_f32 v149, v149
    v_rcp_f32 v150, v150
    v_rcp_f32 v151, v151
    v_pk_mul_f32 v[136:137], v[136:137], v[144:145]
    v_pk_mul_f32 v[138:139], v[138:139], v[146:147]
    v_pk_mul_f32 v[140:141], v[140:141], v[148:149]
    v_pk_mul_f32 v[142:143], v[142:143], v[150:151]
    v_pk_mul_f32 v[136:137], v[136:137], v[80:81]
    v_pk_mul_f32 v[138:139], v[138:139], v[82:83]
    v_pk_mul_f32 v[140:141], v[140:141], v[84:85]
    v_pk_mul_f32 v[142:143], v[142:143], v[86:87]
    v_cvt_pk_bf16_f32 v152, v136, v137
    v_cvt_pk_bf16_f32 v153, v138, v139
    v_cvt_pk_bf16_f32 v154, v140, v141
    v_cvt_pk_bf16_f32 v155, v142, v143
    s_add_u32 s7, s36, 98304
    buffer_store_dwordx4 v[152:155], v21, s[16:19], s7 offen sc1
    v_pk_fma_f32 v[136:137], v[104:105], v[128:129], v[130:131]
    v_pk_fma_f32 v[138:139], v[106:107], v[128:129], v[130:131]
    v_pk_fma_f32 v[140:141], v[108:109], v[128:129], v[130:131]
    v_pk_fma_f32 v[142:143], v[110:111], v[128:129], v[130:131]
    s_add_u32 s99, s44, 15360
    buffer_load_dwordx4 a[20:23], v21, s[16:19], s99 offen offset:0 sc1
    v_min_f32 v136, s62, v136
    v_min_f32 v137, s62, v137
    v_min_f32 v138, s62, v138
    v_min_f32 v139, s62, v139
    v_min_f32 v140, s62, v140
    v_min_f32 v141, s62, v141
    v_min_f32 v142, s62, v142
    v_min_f32 v143, s62, v143
    v_exp_f32 v136, v136
    v_exp_f32 v137, v137
    v_exp_f32 v138, v138
    v_exp_f32 v139, v139
    v_exp_f32 v140, v140
    v_exp_f32 v141, v141
    v_exp_f32 v142, v142
    v_exp_f32 v143, v143
    v_pk_fma_f32 v[136:137], v[136:137], v[136:137], v[136:137]
    v_pk_fma_f32 v[138:139], v[138:139], v[138:139], v[138:139]
    v_pk_fma_f32 v[140:141], v[140:141], v[140:141], v[140:141]
    v_pk_fma_f32 v[142:143], v[142:143], v[142:143], v[142:143]
    v_pk_add_f32 v[144:145], v[136:137], v[132:133]
    v_pk_add_f32 v[146:147], v[138:139], v[132:133]
    v_pk_add_f32 v[148:149], v[140:141], v[132:133]
    v_pk_add_f32 v[150:151], v[142:143], v[132:133]
    buffer_load_dwordx4 a[24:27], v21, s[16:19], s99 offen offset:1024 sc1
    v_rcp_f32 v144, v144
    v_rcp_f32 v145, v145
    v_rcp_f32 v146, v146
    v_rcp_f32 v147, v147
    v_rcp_f32 v148, v148
    v_rcp_f32 v149, v149
    v_rcp_f32 v150, v150
    v_rcp_f32 v151, v151
    v_pk_mul_f32 v[136:137], v[136:137], v[144:145]
    v_pk_mul_f32 v[138:139], v[138:139], v[146:147]
    v_pk_mul_f32 v[140:141], v[140:141], v[148:149]
    v_pk_mul_f32 v[142:143], v[142:143], v[150:151]
    v_pk_mul_f32 v[136:137], v[136:137], v[104:105]
    v_pk_mul_f32 v[138:139], v[138:139], v[106:107]
    v_pk_mul_f32 v[140:141], v[140:141], v[108:109]
    v_pk_mul_f32 v[142:143], v[142:143], v[110:111]
    v_cvt_pk_bf16_f32 v156, v136, v137
    v_cvt_pk_bf16_f32 v157, v138, v139
    v_cvt_pk_bf16_f32 v158, v140, v141
    v_cvt_pk_bf16_f32 v159, v142, v143
    s_add_u32 s7, s36, 147456
    buffer_store_dwordx4 v[156:159], v21, s[16:19], s7 offen sc1
    v_pk_fma_f32 v[136:137], v[40:41], v[128:129], v[130:131]
    v_pk_fma_f32 v[138:139], v[42:43], v[128:129], v[130:131]
    v_pk_fma_f32 v[140:141], v[44:45], v[128:129], v[130:131]
    v_pk_fma_f32 v[142:143], v[46:47], v[128:129], v[130:131]
    buffer_load_dwordx4 a[28:31], v21, s[16:19], s99 offen offset:2048 sc1
    v_min_f32 v136, s62, v136
    v_min_f32 v137, s62, v137
    v_min_f32 v138, s62, v138
    v_min_f32 v139, s62, v139
    v_min_f32 v140, s62, v140
    v_min_f32 v141, s62, v141
    v_min_f32 v142, s62, v142
    v_min_f32 v143, s62, v143
    v_exp_f32 v136, v136
    v_exp_f32 v137, v137
    v_exp_f32 v138, v138
    v_exp_f32 v139, v139
    v_exp_f32 v140, v140
    v_exp_f32 v141, v141
    v_exp_f32 v142, v142
    v_exp_f32 v143, v143
    v_pk_fma_f32 v[136:137], v[136:137], v[136:137], v[136:137]
    v_pk_fma_f32 v[138:139], v[138:139], v[138:139], v[138:139]
    v_pk_fma_f32 v[140:141], v[140:141], v[140:141], v[140:141]
    v_pk_fma_f32 v[142:143], v[142:143], v[142:143], v[142:143]
    v_pk_add_f32 v[144:145], v[136:137], v[132:133]
    v_pk_add_f32 v[146:147], v[138:139], v[132:133]
    v_pk_add_f32 v[148:149], v[140:141], v[132:133]
    v_pk_add_f32 v[150:151], v[142:143], v[132:133]
    buffer_load_dwordx4 a[32:35], v21, s[16:19], s99 offen offset:3072 sc1
    v_rcp_f32 v144, v144
    v_rcp_f32 v145, v145
    v_rcp_f32 v146, v146
    v_rcp_f32 v147, v147
    v_rcp_f32 v148, v148
    v_rcp_f32 v149, v149
    v_rcp_f32 v150, v150
    v_rcp_f32 v151, v151
    v_pk_mul_f32 v[136:137], v[136:137], v[144:145]
    v_pk_mul_f32 v[138:139], v[138:139], v[146:147]
    v_pk_mul_f32 v[140:141], v[140:141], v[148:149]
    v_pk_mul_f32 v[142:143], v[142:143], v[150:151]
    v_pk_mul_f32 v[136:137], v[136:137], v[40:41]
    v_pk_mul_f32 v[138:139], v[138:139], v[42:43]
    v_pk_mul_f32 v[140:141], v[140:141], v[44:45]
    v_pk_mul_f32 v[142:143], v[142:143], v[46:47]
    v_cvt_pk_bf16_f32 v152, v136, v137
    v_cvt_pk_bf16_f32 v153, v138, v139
    v_cvt_pk_bf16_f32 v154, v140, v141
    v_cvt_pk_bf16_f32 v155, v142, v143
    s_add_u32 s7, s36, 1024
    buffer_store_dwordx4 v[152:155], v21, s[16:19], s7 offen sc1
    v_pk_fma_f32 v[136:137], v[64:65], v[128:129], v[130:131]
    v_pk_fma_f32 v[138:139], v[66:67], v[128:129], v[130:131]
    v_pk_fma_f32 v[140:141], v[68:69], v[128:129], v[130:131]
    v_pk_fma_f32 v[142:143], v[70:71], v[128:129], v[130:131]
    s_add_u32 s99, s44, 19456
    buffer_load_dwordx4 a[36:39], v21, s[16:19], s99 offen offset:0 sc1
    v_min_f32 v136, s62, v136
    v_min_f32 v137, s62, v137
    v_min_f32 v138, s62, v138
    v_min_f32 v139, s62, v139
    v_min_f32 v140, s62, v140
    v_min_f32 v141, s62, v141
    v_min_f32 v142, s62, v142
    v_min_f32 v143, s62, v143
    v_exp_f32 v136, v136
    v_exp_f32 v137, v137
    v_exp_f32 v138, v138
    v_exp_f32 v139, v139
    v_exp_f32 v140, v140
    v_exp_f32 v141, v141
    v_exp_f32 v142, v142
    v_exp_f32 v143, v143
    v_pk_fma_f32 v[136:137], v[136:137], v[136:137], v[136:137]
    v_pk_fma_f32 v[138:139], v[138:139], v[138:139], v[138:139]
    v_pk_fma_f32 v[140:141], v[140:141], v[140:141], v[140:141]
    v_pk_fma_f32 v[142:143], v[142:143], v[142:143], v[142:143]
    v_pk_add_f32 v[144:145], v[136:137], v[132:133]
    v_pk_add_f32 v[146:147], v[138:139], v[132:133]
    v_pk_add_f32 v[148:149], v[140:141], v[132:133]
    v_pk_add_f32 v[150:151], v[142:143], v[132:133]
    s_add_u32 s99, s44, 30720
    buffer_load_dwordx4 a[40:43], v21, s[16:19], s99 offen offset:0 sc1
    v_rcp_f32 v144, v144
    v_rcp_f32 v145, v145
    v_rcp_f32 v146, v146
    v_rcp_f32 v147, v147
    v_rcp_f32 v148, v148
    v_rcp_f32 v149, v149
    v_rcp_f32 v150, v150
    v_rcp_f32 v151, v151
    v_pk_mul_f32 v[136:137], v[136:137], v[144:145]
    v_pk_mul_f32 v[138:139], v[138:139], v[146:147]
    v_pk_mul_f32 v[140:141], v[140:141], v[148:149]
    v_pk_mul_f32 v[142:143], v[142:143], v[150:151]
    v_pk_mul_f32 v[136:137], v[136:137], v[64:65]
    v_pk_mul_f32 v[138:139], v[138:139], v[66:67]
    v_pk_mul_f32 v[140:141], v[140:141], v[68:69]
    v_pk_mul_f32 v[142:143], v[142:143], v[70:71]
    v_cvt_pk_bf16_f32 v156, v136, v137
    v_cvt_pk_bf16_f32 v157, v138, v139
    v_cvt_pk_bf16_f32 v158, v140, v141
    v_cvt_pk_bf16_f32 v159, v142, v143
    s_add_u32 s7, s36, 50176
    buffer_store_dwordx4 v[156:159], v21, s[16:19], s7 offen sc1
    v_pk_fma_f32 v[136:137], v[88:89], v[128:129], v[130:131]
    v_pk_fma_f32 v[138:139], v[90:91], v[128:129], v[130:131]
    v_pk_fma_f32 v[140:141], v[92:93], v[128:129], v[130:131]
    v_pk_fma_f32 v[142:143], v[94:95], v[128:129], v[130:131]
    buffer_load_dwordx4 a[44:47], v21, s[16:19], s99 offen offset:1024 sc1
    v_min_f32 v136, s62, v136
    v_min_f32 v137, s62, v137
    v_min_f32 v138, s62, v138
    v_min_f32 v139, s62, v139
    v_min_f32 v140, s62, v140
    v_min_f32 v141, s62, v141
    v_min_f32 v142, s62, v142
    v_min_f32 v143, s62, v143
    v_exp_f32 v136, v136
    v_exp_f32 v137, v137
    v_exp_f32 v138, v138
    v_exp_f32 v139, v139
    v_exp_f32 v140, v140
    v_exp_f32 v141, v141
    v_exp_f32 v142, v142
    v_exp_f32 v143, v143
    v_pk_fma_f32 v[136:137], v[136:137], v[136:137], v[136:137]
    v_pk_fma_f32 v[138:139], v[138:139], v[138:139], v[138:139]
    v_pk_fma_f32 v[140:141], v[140:141], v[140:141], v[140:141]
    v_pk_fma_f32 v[142:143], v[142:143], v[142:143], v[142:143]
    v_pk_add_f32 v[144:145], v[136:137], v[132:133]
    v_pk_add_f32 v[146:147], v[138:139], v[132:133]
    v_pk_add_f32 v[148:149], v[140:141], v[132:133]
    v_pk_add_f32 v[150:151], v[142:143], v[132:133]
    v_rcp_f32 v144, v144
    v_rcp_f32 v145, v145
    v_rcp_f32 v146, v146
    v_rcp_f32 v147, v147
    v_rcp_f32 v148, v148
    v_rcp_f32 v149, v149
    v_rcp_f32 v150, v150
    v_rcp_f32 v151, v151
    v_pk_mul_f32 v[136:137], v[136:137], v[144:145]
    v_pk_mul_f32 v[138:139], v[138:139], v[146:147]
    v_pk_mul_f32 v[140:141], v[140:141], v[148:149]
    v_pk_mul_f32 v[142:143], v[142:143], v[150:151]
    v_pk_mul_f32 v[136:137], v[136:137], v[88:89]
    v_pk_mul_f32 v[138:139], v[138:139], v[90:91]
    v_pk_mul_f32 v[140:141], v[140:141], v[92:93]
    v_pk_mul_f32 v[142:143], v[142:143], v[94:95]
    v_cvt_pk_bf16_f32 v152, v136, v137
    v_cvt_pk_bf16_f32 v153, v138, v139
    v_cvt_pk_bf16_f32 v154, v140, v141
    v_cvt_pk_bf16_f32 v155, v142, v143
    s_add_u32 s7, s36, 99328
    buffer_store_dwordx4 v[152:155], v21, s[16:19], s7 offen sc1
    v_pk_fma_f32 v[136:137], v[112:113], v[128:129], v[130:131]
    v_pk_fma_f32 v[138:139], v[114:115], v[128:129], v[130:131]
    v_pk_fma_f32 v[140:141], v[116:117], v[128:129], v[130:131]
    v_pk_fma_f32 v[142:143], v[118:119], v[128:129], v[130:131]
    buffer_load_dwordx4 a[48:51], v21, s[16:19], s99 offen offset:2048 sc1
    v_min_f32 v136, s62, v136
    v_min_f32 v137, s62, v137
    v_min_f32 v138, s62, v138
    v_min_f32 v139, s62, v139
    v_min_f32 v140, s62, v140
    v_min_f32 v141, s62, v141
    v_min_f32 v142, s62, v142
    v_min_f32 v143, s62, v143
    v_exp_f32 v136, v136
    v_exp_f32 v137, v137
    v_exp_f32 v138, v138
    v_exp_f32 v139, v139
    v_exp_f32 v140, v140
    v_exp_f32 v141, v141
    v_exp_f32 v142, v142
    v_exp_f32 v143, v143
    v_pk_fma_f32 v[136:137], v[136:137], v[136:137], v[136:137]
    v_pk_fma_f32 v[138:139], v[138:139], v[138:139], v[138:139]
    v_pk_fma_f32 v[140:141], v[140:141], v[140:141], v[140:141]
    v_pk_fma_f32 v[142:143], v[142:143], v[142:143], v[142:143]
    v_pk_add_f32 v[144:145], v[136:137], v[132:133]
    v_pk_add_f32 v[146:147], v[138:139], v[132:133]
    v_pk_add_f32 v[148:149], v[140:141], v[132:133]
    v_pk_add_f32 v[150:151], v[142:143], v[132:133]
    buffer_load_dwordx4 a[52:55], v21, s[16:19], s99 offen offset:3072 sc1
    v_rcp_f32 v144, v144
    v_rcp_f32 v145, v145
    v_rcp_f32 v146, v146
    v_rcp_f32 v147, v147
    v_rcp_f32 v148, v148
    v_rcp_f32 v149, v149
    v_rcp_f32 v150, v150
    v_rcp_f32 v151, v151
    v_pk_mul_f32 v[136:137], v[136:137], v[144:145]
    v_pk_mul_f32 v[138:139], v[138:139], v[146:147]
    v_pk_mul_f32 v[140:141], v[140:141], v[148:149]
    v_pk_mul_f32 v[142:143], v[142:143], v[150:151]
    v_pk_mul_f32 v[136:137], v[136:137], v[112:113]
    v_pk_mul_f32 v[138:139], v[138:139], v[114:115]
    v_pk_mul_f32 v[140:141], v[140:141], v[116:117]
    v_pk_mul_f32 v[142:143], v[142:143], v[118:119]
    v_cvt_pk_bf16_f32 v156, v136, v137
    v_cvt_pk_bf16_f32 v157, v138, v139
    v_cvt_pk_bf16_f32 v158, v140, v141
    v_cvt_pk_bf16_f32 v159, v142, v143
    s_add_u32 s7, s36, 148480
    buffer_store_dwordx4 v[156:159], v21, s[16:19], s7 offen sc1
    v_pk_fma_f32 v[136:137], v[48:49], v[128:129], v[130:131]
    v_pk_fma_f32 v[138:139], v[50:51], v[128:129], v[130:131]
    v_pk_fma_f32 v[140:141], v[52:53], v[128:129], v[130:131]
    v_pk_fma_f32 v[142:143], v[54:55], v[128:129], v[130:131]
    s_add_u32 s99, s44, 34816
    buffer_load_dwordx4 a[56:59], v21, s[16:19], s99 offen offset:0 sc1
    v_min_f32 v136, s62, v136
    v_min_f32 v137, s62, v137
    v_min_f32 v138, s62, v138
    v_min_f32 v139, s62, v139
    v_min_f32 v140, s62, v140
    v_min_f32 v141, s62, v141
    v_min_f32 v142, s62, v142
    v_min_f32 v143, s62, v143
    v_exp_f32 v136, v136
    v_exp_f32 v137, v137
    v_exp_f32 v138, v138
    v_exp_f32 v139, v139
    v_exp_f32 v140, v140
    v_exp_f32 v141, v141
    v_exp_f32 v142, v142
    v_exp_f32 v143, v143
    v_pk_fma_f32 v[136:137], v[136:137], v[136:137], v[136:137]
    v_pk_fma_f32 v[138:139], v[138:139], v[138:139], v[138:139]
    v_pk_fma_f32 v[140:141], v[140:141], v[140:141], v[140:141]
    v_pk_fma_f32 v[142:143], v[142:143], v[142:143], v[142:143]
    v_pk_add_f32 v[144:145], v[136:137], v[132:133]
    v_pk_add_f32 v[146:147], v[138:139], v[132:133]
    v_pk_add_f32 v[148:149], v[140:141], v[132:133]
    v_pk_add_f32 v[150:151], v[142:143], v[132:133]
    s_add_u32 s99, s44, 46080
    buffer_load_dwordx4 a[60:63], v21, s[16:19], s99 offen offset:0 sc1
    v_rcp_f32 v144, v144
    v_rcp_f32 v145, v145
    v_rcp_f32 v146, v146
    v_rcp_f32 v147, v147
    v_rcp_f32 v148, v148
    v_rcp_f32 v149, v149
    v_rcp_f32 v150, v150
    v_rcp_f32 v151, v151
    v_pk_mul_f32 v[136:137], v[136:137], v[144:145]
    v_pk_mul_f32 v[138:139], v[138:139], v[146:147]
    v_pk_mul_f32 v[140:141], v[140:141], v[148:149]
    v_pk_mul_f32 v[142:143], v[142:143], v[150:151]
    v_pk_mul_f32 v[136:137], v[136:137], v[48:49]
    v_pk_mul_f32 v[138:139], v[138:139], v[50:51]
    v_pk_mul_f32 v[140:141], v[140:141], v[52:53]
    v_pk_mul_f32 v[142:143], v[142:143], v[54:55]
    v_cvt_pk_bf16_f32 v152, v136, v137
    v_cvt_pk_bf16_f32 v153, v138, v139
    v_cvt_pk_bf16_f32 v154, v140, v141
    v_cvt_pk_bf16_f32 v155, v142, v143
    s_add_u32 s7, s36, 2048
    buffer_store_dwordx4 v[152:155], v21, s[16:19], s7 offen sc1
    v_pk_fma_f32 v[136:137], v[72:73], v[128:129], v[130:131]
    v_pk_fma_f32 v[138:139], v[74:75], v[128:129], v[130:131]
    v_pk_fma_f32 v[140:141], v[76:77], v[128:129], v[130:131]
    v_pk_fma_f32 v[142:143], v[78:79], v[128:129], v[130:131]
    buffer_load_dwordx4 a[64:67], v21, s[16:19], s99 offen offset:1024 sc1
    v_min_f32 v136, s62, v136
    v_min_f32 v137, s62, v137
    v_min_f32 v138, s62, v138
    v_min_f32 v139, s62, v139
    v_min_f32 v140, s62, v140
    v_min_f32 v141, s62, v141
    v_min_f32 v142, s62, v142
    v_min_f32 v143, s62, v143
    v_exp_f32 v136, v136
    v_exp_f32 v137, v137
    v_exp_f32 v138, v138
    v_exp_f32 v139, v139
    v_exp_f32 v140, v140
    v_exp_f32 v141, v141
    v_exp_f32 v142, v142
    v_exp_f32 v143, v143
    v_pk_fma_f32 v[136:137], v[136:137], v[136:137], v[136:137]
    v_pk_fma_f32 v[138:139], v[138:139], v[138:139], v[138:139]
    v_pk_fma_f32 v[140:141], v[140:141], v[140:141], v[140:141]
    v_pk_fma_f32 v[142:143], v[142:143], v[142:143], v[142:143]
    v_pk_add_f32 v[144:145], v[136:137], v[132:133]
    v_pk_add_f32 v[146:147], v[138:139], v[132:133]
    v_pk_add_f32 v[148:149], v[140:141], v[132:133]
    v_pk_add_f32 v[150:151], v[142:143], v[132:133]
    buffer_load_dwordx4 a[68:71], v21, s[16:19], s99 offen offset:2048 sc1
    v_rcp_f32 v144, v144
    v_rcp_f32 v145, v145
    v_rcp_f32 v146, v146
    v_rcp_f32 v147, v147
    v_rcp_f32 v148, v148
    v_rcp_f32 v149, v149
    v_rcp_f32 v150, v150
    v_rcp_f32 v151, v151
    v_pk_mul_f32 v[136:137], v[136:137], v[144:145]
    v_pk_mul_f32 v[138:139], v[138:139], v[146:147]
    v_pk_mul_f32 v[140:141], v[140:141], v[148:149]
    v_pk_mul_f32 v[142:143], v[142:143], v[150:151]
    v_pk_mul_f32 v[136:137], v[136:137], v[72:73]
    v_pk_mul_f32 v[138:139], v[138:139], v[74:75]
    v_pk_mul_f32 v[140:141], v[140:141], v[76:77]
    v_pk_mul_f32 v[142:143], v[142:143], v[78:79]
    v_cvt_pk_bf16_f32 v156, v136, v137
    v_cvt_pk_bf16_f32 v157, v138, v139
    v_cvt_pk_bf16_f32 v158, v140, v141
    v_cvt_pk_bf16_f32 v159, v142, v143
    s_add_u32 s7, s36, 51200
    buffer_store_dwordx4 v[156:159], v21, s[16:19], s7 offen sc1
    v_pk_fma_f32 v[136:137], v[96:97], v[128:129], v[130:131]
    v_pk_fma_f32 v[138:139], v[98:99], v[128:129], v[130:131]
    v_pk_fma_f32 v[140:141], v[100:101], v[128:129], v[130:131]
    v_pk_fma_f32 v[142:143], v[102:103], v[128:129], v[130:131]
    buffer_load_dwordx4 a[72:75], v21, s[16:19], s99 offen offset:3072 sc1
    v_min_f32 v136, s62, v136
    v_min_f32 v137, s62, v137
    v_min_f32 v138, s62, v138
    v_min_f32 v139, s62, v139
    v_min_f32 v140, s62, v140
    v_min_f32 v141, s62, v141
    v_min_f32 v142, s62, v142
    v_min_f32 v143, s62, v143
    v_exp_f32 v136, v136
    v_exp_f32 v137, v137
    v_exp_f32 v138, v138
    v_exp_f32 v139, v139
    v_exp_f32 v140, v140
    v_exp_f32 v141, v141
    v_exp_f32 v142, v142
    v_exp_f32 v143, v143
    v_pk_fma_f32 v[136:137], v[136:137], v[136:137], v[136:137]
    v_pk_fma_f32 v[138:139], v[138:139], v[138:139], v[138:139]
    v_pk_fma_f32 v[140:141], v[140:141], v[140:141], v[140:141]
    v_pk_fma_f32 v[142:143], v[142:143], v[142:143], v[142:143]
    v_pk_add_f32 v[144:145], v[136:137], v[132:133]
    v_pk_add_f32 v[146:147], v[138:139], v[132:133]
    v_pk_add_f32 v[148:149], v[140:141], v[132:133]
    v_pk_add_f32 v[150:151], v[142:143], v[132:133]
    s_add_u32 s99, s44, 50176
    buffer_load_dwordx4 a[76:79], v21, s[16:19], s99 offen offset:0 sc1
    v_rcp_f32 v144, v144
    v_rcp_f32 v145, v145
    v_rcp_f32 v146, v146
    v_rcp_f32 v147, v147
    v_rcp_f32 v148, v148
    v_rcp_f32 v149, v149
    v_rcp_f32 v150, v150
    v_rcp_f32 v151, v151
    v_pk_mul_f32 v[136:137], v[136:137], v[144:145]
    v_pk_mul_f32 v[138:139], v[138:139], v[146:147]
    v_pk_mul_f32 v[140:141], v[140:141], v[148:149]
    v_pk_mul_f32 v[142:143], v[142:143], v[150:151]
    v_pk_mul_f32 v[136:137], v[136:137], v[96:97]
    v_pk_mul_f32 v[138:139], v[138:139], v[98:99]
    v_pk_mul_f32 v[140:141], v[140:141], v[100:101]
    v_pk_mul_f32 v[142:143], v[142:143], v[102:103]
    v_cvt_pk_bf16_f32 v152, v136, v137
    v_cvt_pk_bf16_f32 v153, v138, v139
    v_cvt_pk_bf16_f32 v154, v140, v141
    v_cvt_pk_bf16_f32 v155, v142, v143
    s_add_u32 s7, s36, 100352
    buffer_store_dwordx4 v[152:155], v21, s[16:19], s7 offen sc1
    v_pk_fma_f32 v[136:137], v[120:121], v[128:129], v[130:131]
    v_pk_fma_f32 v[138:139], v[122:123], v[128:129], v[130:131]
    v_pk_fma_f32 v[140:141], v[124:125], v[128:129], v[130:131]
    v_pk_fma_f32 v[142:143], v[126:127], v[128:129], v[130:131]
    s_add_u32 s99, s44, 5120
    buffer_load_dwordx4 a[80:83], v21, s[16:19], s99 offen offset:0 sc1
    v_min_f32 v136, s62, v136
    v_min_f32 v137, s62, v137
    v_min_f32 v138, s62, v138
    v_min_f32 v139, s62, v139
    v_min_f32 v140, s62, v140
    v_min_f32 v141, s62, v141
    v_min_f32 v142, s62, v142
    v_min_f32 v143, s62, v143
    v_exp_f32 v136, v136
    v_exp_f32 v137, v137
    v_exp_f32 v138, v138
    v_exp_f32 v139, v139
    v_exp_f32 v140, v140
    v_exp_f32 v141, v141
    v_exp_f32 v142, v142
    v_exp_f32 v143, v143
    v_pk_fma_f32 v[136:137], v[136:137], v[136:137], v[136:137]
    v_pk_fma_f32 v[138:139], v[138:139], v[138:139], v[138:139]
    v_pk_fma_f32 v[140:141], v[140:141], v[140:141], v[140:141]
    v_pk_fma_f32 v[142:143], v[142:143], v[142:143], v[142:143]
    v_pk_add_f32 v[144:145], v[136:137], v[132:133]
    v_pk_add_f32 v[146:147], v[138:139], v[132:133]
    v_pk_add_f32 v[148:149], v[140:141], v[132:133]
    v_pk_add_f32 v[150:151], v[142:143], v[132:133]
    buffer_load_dwordx4 a[84:87], v21, s[16:19], s99 offen offset:1024 sc1
    v_rcp_f32 v144, v144
    v_rcp_f32 v145, v145
    v_rcp_f32 v146, v146
    v_rcp_f32 v147, v147
    v_rcp_f32 v148, v148
    v_rcp_f32 v149, v149
    v_rcp_f32 v150, v150
    v_rcp_f32 v151, v151
    v_pk_mul_f32 v[136:137], v[136:137], v[144:145]
    v_pk_mul_f32 v[138:139], v[138:139], v[146:147]
    v_pk_mul_f32 v[140:141], v[140:141], v[148:149]
    v_pk_mul_f32 v[142:143], v[142:143], v[150:151]
    v_pk_mul_f32 v[136:137], v[136:137], v[120:121]
    v_pk_mul_f32 v[138:139], v[138:139], v[122:123]
    v_pk_mul_f32 v[140:141], v[140:141], v[124:125]
    v_pk_mul_f32 v[142:143], v[142:143], v[126:127]
    v_cvt_pk_bf16_f32 v156, v136, v137
    v_cvt_pk_bf16_f32 v157, v138, v139
    v_cvt_pk_bf16_f32 v158, v140, v141
    v_cvt_pk_bf16_f32 v159, v142, v143
    s_add_u32 s7, s36, 149504
    buffer_store_dwordx4 v[156:159], v21, s[16:19], s7 offen sc1
    buffer_load_dwordx4 a[88:91], v21, s[16:19], s99 offen offset:2048 sc1
    buffer_load_dwordx4 a[92:95], v21, s[16:19], s99 offen offset:3072 sc1
    s_add_u32 s99, s44, 9216
    buffer_load_dwordx4 a[96:99], v21, s[16:19], s99 offen offset:0 sc1
    s_add_u32 s99, s44, 20480
    buffer_load_dwordx4 a[100:103], v21, s[16:19], s99 offen offset:0 sc1
    buffer_load_dwordx4 a[104:107], v21, s[16:19], s99 offen offset:1024 sc1
    buffer_load_dwordx4 a[108:111], v21, s[16:19], s99 offen offset:2048 sc1
    buffer_load_dwordx4 a[112:115], v21, s[16:19], s99 offen offset:3072 sc1
    s_add_u32 s99, s44, 24576
    buffer_load_dwordx4 a[116:119], v21, s[16:19], s99 offen offset:0 sc1
    s_add_u32 s99, s44, 35840
    buffer_load_dwordx4 a[120:123], v21, s[16:19], s99 offen offset:0 sc1
    buffer_load_dwordx4 a[124:127], v21, s[16:19], s99 offen offset:1024 sc1
    buffer_load_dwordx4 a[128:131], v21, s[16:19], s99 offen offset:2048 sc1
    buffer_load_dwordx4 a[132:135], v21, s[16:19], s99 offen offset:3072 sc1
    s_add_u32 s99, s44, 39936
    buffer_load_dwordx4 a[136:139], v21, s[16:19], s99 offen offset:0 sc1
    s_add_u32 s99, s44, 51200
    buffer_load_dwordx4 a[140:143], v21, s[16:19], s99 offen offset:0 sc1
    s_waitcnt vmcnt(14)
    s_barrier
    s_cmp_lg_u32 s3, 0
    s_cbranch_scc1 L_nf_25
    s_lshl_b32 s7, s4, 3
    s_add_u32 s7, s7, s5
    s_lshl_b32 s7, s7, 7
    s_add_u32 s7, s7, 81920
    s_mov_b64 exec, 1
    buffer_store_dword v22, v23, s[16:19], s7 offen sc1
    s_mov_b64 exec, -1
L_nf_25:
    buffer_load_dwordx4 a[144:147], v21, s[16:19], s99 offen offset:1024 sc1
    buffer_load_dwordx4 a[148:151], v21, s[16:19], s99 offen offset:2048 sc1
    buffer_load_dwordx4 a[152:155], v21, s[16:19], s99 offen offset:3072 sc1
    s_add_u32 s99, s44, 55296
    buffer_load_dwordx4 a[156:159], v21, s[16:19], s99 offen offset:0 sc1
    s_add_u32 s99, s44, 10240
    buffer_load_dwordx4 a[160:163], v21, s[16:19], s99 offen offset:0 sc1
    buffer_load_dwordx4 a[164:167], v21, s[16:19], s99 offen offset:1024 sc1
    buffer_load_dwordx4 a[168:171], v21, s[16:19], s99 offen offset:2048 sc1
    buffer_load_dwordx4 a[172:175], v21, s[16:19], s99 offen offset:3072 sc1
    s_add_u32 s99, s44, 14336
    buffer_load_dwordx4 a[176:179], v21, s[16:19], s99 offen offset:0 sc1
    s_add_u32 s99, s44, 25600
    buffer_load_dwordx4 a[180:183], v21, s[16:19], s99 offen offset:0 sc1
    buffer_load_dwordx4 a[184:187], v21, s[16:19], s99 offen offset:1024 sc1
    buffer_load_dwordx4 a[188:191], v21, s[16:19], s99 offen offset:2048 sc1
    buffer_load_dwordx4 a[192:195], v21, s[16:19], s99 offen offset:3072 sc1
    s_add_u32 s99, s44, 29696
    buffer_load_dwordx4 a[196:199], v21, s[16:19], s99 offen offset:0 sc1
    s_add_u32 s99, s44, 40960
    buffer_load_dwordx4 a[200:203], v21, s[16:19], s99 offen offset:0 sc1
    buffer_load_dwordx4 a[204:207], v21, s[16:19], s99 offen offset:1024 sc1
    buffer_load_dwordx4 a[208:211], v21, s[16:19], s99 offen offset:2048 sc1
    buffer_load_dwordx4 a[212:215], v21, s[16:19], s99 offen offset:3072 sc1
    s_add_u32 s99, s44, 45056
    buffer_load_dwordx4 a[216:219], v21, s[16:19], s99 offen offset:0 sc1
    s_add_u32 s99, s44, 56320
    buffer_load_dwordx4 a[220:223], v21, s[16:19], s99 offen offset:0 sc1
    buffer_load_dwordx4 a[224:227], v21, s[16:19], s99 offen offset:1024 sc1
    buffer_load_dwordx4 a[228:231], v21, s[16:19], s99 offen offset:2048 sc1
    buffer_load_dwordx4 a[232:235], v21, s[16:19], s99 offen offset:3072 sc1
    s_add_u32 s99, s44, 60416
    buffer_load_dwordx4 a[236:239], v21, s[16:19], s99 offen offset:0 sc1
    s_add_u32 s99, s45, 0
    s_add_u32 m0, s48, 0
    s_nop 0
    buffer_load_dwordx4 v21, s[16:19], s99 offen offset:0 sc1 lds
    buffer_load_dwordx4 v21, s[16:19], s99 offen offset:1024 sc1 lds
    buffer_load_dwordx4 v21, s[16:19], s99 offen offset:2048 sc1 lds
    buffer_load_dwordx4 v21, s[16:19], s99 offen offset:3072 sc1 lds
    buffer_load_dword v248, v250, s[16:19], 0 offen sc1
    s_waitcnt vmcnt(0)
    v_cmp_ne_u32 vcc, 0, v248
    s_mov_b32 s98, 0
    s_nop 0
    s_cmp_eq_u64 vcc, -1
    s_cbranch_scc1 L_ok_26
L_spin_27:
    buffer_load_dword v248, v250, s[16:19], 0 offen sc1
    s_add_u32 s98, s98, 1
    s_waitcnt vmcnt(0)
    v_cmp_ne_u32 vcc, 0, v248
    s_cmp_gt_u32 s98, 0x40000
    s_cbranch_scc1 L_ok_26
    s_cmp_eq_u64 vcc, -1
    s_cbranch_scc0 L_spin_27
L_ok_26:
    s_add_u32 s7, s40, 0
    buffer_load_dwordx4 v[132:135], v21, s[16:19], s7 offen sc1
    s_add_u32 s7, s40, 49152
    buffer_load_dwordx4 v[136:139], v21, s[16:19], s7 offen sc1
    s_add_u32 s7, s40, 98304
    buffer_load_dwordx4 v[140:143], v21, s[16:19], s7 offen sc1
    s_add_u32 s7, s40, 147456
    buffer_load_dwordx4 v[144:147], v21, s[16:19], s7 offen sc1
    s_add_u32 s7, s40, 196608
    buffer_load_dwordx4 v[148:151], v21, s[16:19], s7 offen sc1
    s_add_u32 s7, s40, 3072
    buffer_load_dwordx4 v[152:155], v21, s[16:19], s7 offen sc1
    s_add_u32 s7, s40, 52224
    buffer_load_dwordx4 v[156:159], v21, s[16:19], s7 offen sc1
    s_add_u32 s7, s40, 101376
    buffer_load_dwordx4 v[160:163], v21, s[16:19], s7 offen sc1
    s_add_u32 s7, s40, 150528
    buffer_load_dwordx4 v[164:167], v21, s[16:19], s7 offen sc1
    s_add_u32 s7, s40, 199680
    buffer_load_dwordx4 v[168:171], v21, s[16:19], s7 offen sc1
    s_add_u32 s7, s40, 6144
    buffer_load_dwordx4 v[172:175], v21, s[16:19], s7 offen sc1
    s_add_u32 s7, s40, 55296
    buffer_load_dwordx4 v[176:179], v21, s[16:19], s7 offen sc1
    s_add_u32 s7, s40, 104448
    buffer_load_dwordx4 v[180:183], v21, s[16:19], s7 offen sc1
    s_add_u32 s7, s40, 153600
    buffer_load_dwordx4 v[184:187], v21, s[16:19], s7 offen sc1
    s_add_u32 s7, s40, 202752
    buffer_load_dwordx4 v[188:191], v21, s[16:19], s7 offen sc1
    s_add_u32 s7, s40, 9216
    buffer_load_dwordx4 v[192:195], v21, s[16:19], s7 offen sc1
    s_add_u32 s7, s40, 58368
    buffer_load_dwordx4 v[196:199], v21, s[16:19], s7 offen sc1
    s_add_u32 s7, s40, 107520
    buffer_load_dwordx4 v[200:203], v21, s[16:19], s7 offen sc1
    s_add_u32 s7, s40, 156672
    buffer_load_dwordx4 v[204:207], v21, s[16:19], s7 offen sc1
    s_add_u32 s7, s40, 205824
    buffer_load_dwordx4 v[208:211], v21, s[16:19], s7 offen sc1
    s_waitcnt vmcnt(19)
    v_mfma_f32_16x16x32_bf16 v[32:35], a[0:3], v[132:135], 0
    s_add_u32 s7, s40, 1024
    buffer_load_dwordx4 v[212:215], v21, s[16:19], s7 offen sc1
    v_mfma_f32_16x16x32_bf16 v[36:39], a[4:7], v[132:135], 0
    v_mfma_f32_16x16x32_bf16 v[40:43], a[8:11], v[132:135], 0
    v_mfma_f32_16x16x32_bf16 v[44:47], a[12:15], v[132:135], 0
    v_mfma_f32_16x16x32_bf16 v[48:51], a[16:19], v[132:135], 0
    s_add_u32 s7, s40, 50176
    buffer_load_dwordx4 v[216:219], v21, s[16:19], s7 offen sc1
    s_waitcnt vmcnt(20)
    v_mfma_f32_16x16x32_bf16 v[52:55], a[0:3], v[136:139], 0
    v_mfma_f32_16x16x32_bf16 v[56:59], a[4:7], v[136:139], 0
    v_mfma_f32_16x16x32_bf16 v[60:63], a[8:11], v[136:139], 0
    v_mfma_f32_16x16x32_bf16 v[64:67], a[12:15], v[136:139], 0
    s_add_u32 s7, s40, 99328
    buffer_load_dwordx4 v[220:223], v21, s[16:19], s7 offen sc1
    v_mfma_f32_16x16x32_bf16 v[68:71], a[16:19], v[136:139], 0
    s_waitcnt vmcnt(20)
    v_mfma_f32_16x16x32_bf16 v[72:75], a[0:3], v[140:143], 0
    v_mfma_f32_16x16x32_bf16 v[76:79], a[4:7], v[140:143], 0
    v_mfma_f32_16x16x32_bf16 v[80:83], a[8:11], v[140:143], 0
    s_add_u32 s7, s40, 148480
    buffer_load_dwordx4 v[224:227], v21, s[16:19], s7 offen sc1
    v_mfma_f32_16x16x32_bf16 v[84:87], a[12:15], v[140:143], 0
    v_mfma_f32_16x16x32_bf16 v[88:91], a[16:19], v[140:143], 0
    s_waitcnt vmcnt(20)
    v_mfma_f32_16x16x32_bf16 v[92:95], a[0:3], v[144:147], 0
    v_mfma_f32_16x16x32_bf16 v[96:99], a[4:7], v[144:147], 0
    s_add_u32 s7, s40, 197632
    buffer_load_dwordx4 v[228:231], v21, s[16:19], s7 offen sc1
    v_mfma_f32_16x16x32_bf16 v[100:103], a[8:11], v[144:147], 0
    v_mfma_f32_16x16x32_bf16 v[104:107], a[12:15], v[144:147], 0
    v_mfma_f32_16x16x32_bf16 v[108:111], a[16:19], v[144:147], 0
    s_waitcnt vmcnt(20)
    v_mfma_f32_16x16x32_bf16 v[112:115], a[0:3], v[148:151], 0
    s_add_u32 s7, s40, 4096
    buffer_load_dwordx4 a[240:243], v21, s[16:19], s7 offen sc1
    v_mfma_f32_16x16x32_bf16 v[116:119], a[4:7], v[148:151], 0
    v_mfma_f32_16x16x32_bf16 v[120:123], a[8:11], v[148:151], 0
    v_mfma_f32_16x16x32_bf16 v[124:127], a[12:15], v[148:151], 0
    v_mfma_f32_16x16x32_bf16 v[128:131], a[16:19], v[148:151], 0
    s_waitcnt vmcnt(20)
    v_mfma_f32_16x16x32_bf16 v[32:35], a[20:23], v[152:155], v[32:35]
    s_add_u32 s7, s40, 53248
    buffer_load_dwordx4 a[244:247], v21, s[16:19], s7 offen sc1
    v_mfma_f32_16x16x32_bf16 v[36:39], a[24:27], v[152:155], v[36:39]
    v_mfma_f32_16x16x32_bf16 v[40:43], a[28:31], v[152:155], v[40:43]
    v_mfma_f32_16x16x32_bf16 v[44:47], a[32:35], v[152:155], v[44:47]
    v_mfma_f32_16x16x32_bf16 v[48:51], a[36:39], v[152:155], v[48:51]
    s_add_u32 s7, s40, 102400
    buffer_load_dwordx4 a[248:251], v21, s[16:19], s7 offen sc1
    s_waitcnt vmcnt(21)
    v_mfma_f32_16x16x32_bf16 v[52:55], a[20:23], v[156:159], v[52:55]
    v_mfma_f32_16x16x32_bf16 v[56:59], a[24:27], v[156:159], v[56:59]
    v_mfma_f32_16x16x32_bf16 v[60:63], a[28:31], v[156:159], v[60:63]
    v_mfma_f32_16x16x32_bf16 v[64:67], a[32:35], v[156:159], v[64:67]
    s_add_u32 s7, s40, 151552
    buffer_load_dwordx4 a[252:255], v21, s[16:19], s7 offen sc1
    v_mfma_f32_16x16x32_bf16 v[68:71], a[36:39], v[156:159], v[68:71]
    s_waitcnt vmcnt(21)
    v_mfma_f32_16x16x32_bf16 v[72:75], a[20:23], v[160:163], v[72:75]
    v_mfma_f32_16x16x32_bf16 v[76:79], a[24:27], v[160:163], v[76:79]
    v_mfma_f32_16x16x32_bf16 v[80:83], a[28:31], v[160:163], v[80:83]
    s_add_u32 s7, s40, 200704
    buffer_load_dwordx4 v[132:135], v21, s[16:19], s7 offen sc1
    v_mfma_f32_16x16x32_bf16 v[84:87], a[32:35], v[160:163], v[84:87]
    v_mfma_f32_16x16x32_bf16 v[88:91], a[36:39], v[160:163], v[88:91]
    s_waitcnt vmcnt(21)
    v_mfma_f32_16x16x32_bf16 v[92:95], a[20:23], v[164:167], v[92:95]
    v_mfma_f32_16x16x32_bf16 v[96:99], a[24:27], v[164:167], v[96:99]
    s_add_u32 s7, s40, 7168
    buffer_load_dwordx4 v[136:139], v21, s[16:19], s7 offen sc1
    v_mfma_f32_16x16x32_bf16 v[100:103], a[28:31], v[164:167], v[100:103]
    v_mfma_f32_16x16x32_bf16 v[104:107], a[32:35], v[164:167], v[104:107]
    v_mfma_f32_16x16x32_bf16 v[108:111], a[36:39], v[164:167], v[108:111]
    s_waitcnt vmcnt(21)
    v_mfma_f32_16x16x32_bf16 v[112:115], a[20:23], v[168:171], v[112:115]
    s_add_u32 s7, s40, 56320
    buffer_load_dwordx4 v[140:143], v21, s[16:19], s7 offen sc1
    v_mfma_f32_16x16x32_bf16 v[116:119], a[24:27], v[168:171], v[116:119]
    v_mfma_f32_16x16x32_bf16 v[120:123], a[28:31], v[168:171], v[120:123]
    v_mfma_f32_16x16x32_bf16 v[124:127], a[32:35], v[168:171], v[124:127]
    v_mfma_f32_16x16x32_bf16 v[128:131], a[36:39], v[168:171], v[128:131]
    s_waitcnt vmcnt(21)
    v_mfma_f32_16x16x32_bf16 v[32:35], a[40:43], v[172:175], v[32:35]
    s_add_u32 s7, s40, 105472
    buffer_load_dwordx4 v[144:147], v21, s[16:19], s7 offen sc1
    v_mfma_f32_16x16x32_bf16 v[36:39], a[44:47], v[172:175], v[36:39]
    v_mfma_f32_16x16x32_bf16 v[40:43], a[48:51], v[172:175], v[40:43]
    v_mfma_f32_16x16x32_bf16 v[44:47], a[52:55], v[172:175], v[44:47]
    v_mfma_f32_16x16x32_bf16 v[48:51], a[56:59], v[172:175], v[48:51]
    s_add_u32 s7, s40, 154624
    buffer_load_dwordx4 v[148:151], v21, s[16:19], s7 offen sc1
    s_waitcnt vmcnt(22)
    v_mfma_f32_16x16x32_bf16 v[52:55], a[40:43], v[176:179], v[52:55]
    v_mfma_f32_16x16x32_bf16 v[56:59], a[44:47], v[176:179], v[56:59]
    v_mfma_f32_16x16x32_bf16 v[60:63], a[48:51], v[176:179], v[60:63]
    v_mfma_f32_16x16x32_bf16 v[64:67], a[52:55], v[176:179], v[64:67]
    s_add_u32 s7, s40, 203776
    buffer_load_dwordx4 a[0:3], v21, s[16:19], s7 offen sc1
    v_mfma_f32_16x16x32_bf16 v[68:71], a[56:59], v[176:179], v[68:71]
    s_waitcnt vmcnt(22)
    v_mfma_f32_16x16x32_bf16 v[72:75], a[40:43], v[180:183], v[72:75]
    v_mfma_f32_16x16x32_bf16 v[76:79], a[44:47], v[180:183], v[76:79]
    v_mfma_f32_16x16x32_bf16 v[80:83], a[48:51], v[180:183], v[80:83]
    s_add_u32 s7, s40, 10240
    buffer_load_dwordx4 a[4:7], v21, s[16:19], s7 offen sc1
    v_mfma_f32_16x16x32_bf16 v[84:87], a[52:55], v[180:183], v[84:87]
    v_mfma_f32_16x16x32_bf16 v[88:91], a[56:59], v[180:183], v[88:91]
    s_waitcnt vmcnt(22)
    v_mfma_f32_16x16x32_bf16 v[92:95], a[40:43], v[184:187], v[92:95]
    v_mfma_f32_16x16x32_bf16 v[96:99], a[44:47], v[184:187], v[96:99]
    s_add_u32 s7, s40, 59392
    buffer_load_dwordx4 a[8:11], v21, s[16:19], s7 offen sc1
    v_mfma_f32_16x16x32_bf16 v[100:103], a[48:51], v[184:187], v[100:103]
    v_mfma_f32_16x16x32_bf16 v[104:107], a[52:55], v[184:187], v[104:107]
    v_mfma_f32_16x16x32_bf16 v[108:111], a[56:59], v[184:187], v[108:111]
    s_waitcnt vmcnt(22)
    v_mfma_f32_16x16x32_bf16 v[112:115], a[40:43], v[188:191], v[112:115]
    s_add_u32 s7, s40, 108544
    buffer_load_dwordx4 a[12:15], v21, s[16:19], s7 offen sc1
    v_mfma_f32_16x16x32_bf16 v[116:119], a[44:47], v[188:191], v[116:119]
    v_mfma_f32_16x16x32_bf16 v[120:123], a[48:51], v[188:191], v[120:123]
    v_mfma_f32_16x16x32_bf16 v[124:127], a[52:55], v[188:191], v[124:127]
    v_mfma_f32_16x16x32_bf16 v[128:131], a[56:59], v[188:191], v[128:131]
    s_waitcnt vmcnt(22)
    v_mfma_f32_16x16x32_bf16 v[32:35], a[60:63], v[192:195], v[32:35]
    s_add_u32 s7, s40, 157696
    buffer_load_dwordx4 a[16:19], v21, s[16:19], s7 offen sc1
    v_mfma_f32_16x16x32_bf16 v[36:39], a[64:67], v[192:195], v[36:39]
    v_mfma_f32_16x16x32_bf16 v[40:43], a[68:71], v[192:195], v[40:43]
    v_mfma_f32_16x16x32_bf16 v[44:47], a[72:75], v[192:195], v[44:47]
    v_mfma_f32_16x16x32_bf16 v[48:51], a[76:79], v[192:195], v[48:51]
    s_add_u32 s7, s40, 206848
    buffer_load_dwordx4 v[152:155], v21, s[16:19], s7 offen sc1
    s_waitcnt vmcnt(23)
    v_mfma_f32_16x16x32_bf16 v[52:55], a[60:63], v[196:199], v[52:55]
    v_mfma_f32_16x16x32_bf16 v[56:59], a[64:67], v[196:199], v[56:59]
    v_mfma_f32_16x16x32_bf16 v[60:63], a[68:71], v[196:199], v[60:63]
    v_mfma_f32_16x16x32_bf16 v[64:67], a[72:75], v[196:199], v[64:67]
    s_add_u32 s7, s40, 2048
    buffer_load_dwordx4 v[156:159], v21, s[16:19], s7 offen sc1
    v_mfma_f32_16x16x32_bf16 v[68:71], a[76:79], v[196:199], v[68:71]
    s_waitcnt vmcnt(23)
    v_mfma_f32_16x16x32_bf16 v[72:75], a[60:63], v[200:203], v[72:75]
    v_mfma_f32_16x16x32_bf16 v[76:79], a[64:67], v[200:203], v[76:79]
    v_mfma_f32_16x16x32_bf16 v[80:83], a[68:71], v[200:203], v[80:83]
    s_add_u32 s7, s40, 51200
    buffer_load_dwordx4 v[160:163], v21, s[16:19], s7 offen sc1
    v_mfma_f32_16x16x32_bf16 v[84:87], a[72:75], v[200:203], v[84:87]
    v_mfma_f32_16x16x32_bf16 v[88:91], a[76:79], v[200:203], v[88:91]
    s_waitcnt vmcnt(23)
    v_mfma_f32_16x16x32_bf16 v[92:95], a[60:63], v[204:207], v[92:95]
    v_mfma_f32_16x16x32_bf16 v[96:99], a[64:67], v[204:207], v[96:99]
    s_add_u32 s7, s40, 100352
    buffer_load_dwordx4 v[164:167], v21, s[16:19], s7 offen sc1
    v_mfma_f32_16x16x32_bf16 v[100:103], a[68:71], v[204:207], v[100:103]
    v_mfma_f32_16x16x32_bf16 v[104:107], a[72:75], v[204:207], v[104:107]
    v_mfma_f32_16x16x32_bf16 v[108:111], a[76:79], v[204:207], v[108:111]
    s_waitcnt vmcnt(23)
    v_mfma_f32_16x16x32_bf16 v[112:115], a[60:63], v[208:211], v[112:115]
    s_add_u32 s7, s40, 149504
    buffer_load_dwordx4 v[168:171], v21, s[16:19], s7 offen sc1
    v_mfma_f32_16x16x32_bf16 v[116:119], a[64:67], v[208:211], v[116:119]
    v_mfma_f32_16x16x32_bf16 v[120:123], a[68:71], v[208:211], v[120:123]
    v_mfma_f32_16x16x32_bf16 v[124:127], a[72:75], v[208:211], v[124:127]
    v_mfma_f32_16x16x32_bf16 v[128:131], a[76:79], v[208:211], v[128:131]
    s_waitcnt vmcnt(23)
    v_mfma_f32_16x16x32_bf16 v[32:35], a[80:83], v[212:215], v[32:35]
    s_add_u32 s7, s40, 198656
    buffer_load_dwordx4 a[20:23], v21, s[16:19], s7 offen sc1
    v_mfma_f32_16x16x32_bf16 v[36:39], a[84:87], v[212:215], v[36:39]
    v_mfma_f32_16x16x32_bf16 v[40:43], a[88:91], v[212:215], v[40:43]
    v_mfma_f32_16x16x32_bf16 v[44:47], a[92:95], v[212:215], v[44:47]
    v_mfma_f32_16x16x32_bf16 v[48:51], a[96:99], v[212:215], v[48:51]
    s_add_u32 s7, s40, 5120
    buffer_load_dwordx4 a[24:27], v21, s[16:19], s7 offen sc1
    s_waitcnt vmcnt(24)
    v_mfma_f32_16x16x32_bf16 v[52:55], a[80:83], v[216:219], v[52:55]
    v_mfma_f32_16x16x32_bf16 v[56:59], a[84:87], v[216:219], v[56:59]
    v_mfma_f32_16x16x32_bf16 v[60:63], a[88:91], v[216:219], v[60:63]
    v_mfma_f32_16x16x32_bf16 v[64:67], a[92:95], v[216:219], v[64:67]
    s_add_u32 s7, s40, 54272
    buffer_load_dwordx4 a[28:31], v21, s[16:19], s7 offen sc1
    v_mfma_f32_16x16x32_bf16 v[68:71], a[96:99], v[216:219], v[68:71]
    s_waitcnt vmcnt(24)
    v_mfma_f32_16x16x32_bf16 v[72:75], a[80:83], v[220:223], v[72:75]
    v_mfma_f32_16x16x32_bf16 v[76:79], a[84:87], v[220:223], v[76:79]
    v_mfma_f32_16x16x32_bf16 v[80:83], a[88:91], v[220:223], v[80:83]
    s_add_u32 s7, s40, 103424
    buffer_load_dwordx4 a[32:35], v21, s[16:19], s7 offen sc1
    v_mfma_f32_16x16x32_bf16 v[84:87], a[92:95], v[220:223], v[84:87]
    v_mfma_f32_16x16x32_bf16 v[88:91], a[96:99], v[220:223], v[88:91]
    s_waitcnt vmcnt(24)
    v_mfma_f32_16x16x32_bf16 v[92:95], a[80:83], v[224:227], v[92:95]
    v_mfma_f32_16x16x32_bf16 v[96:99], a[84:87], v[224:227], v[96:99]
    s_add_u32 s7, s40, 152576
    buffer_load_dwordx4 a[36:39], v21, s[16:19], s7 offen sc1
    v_mfma_f32_16x16x32_bf16 v[100:103], a[88:91], v[224:227], v[100:103]
    v_mfma_f32_16x16x32_bf16 v[104:107], a[92:95], v[224:227], v[104:107]
    v_mfma_f32_16x16x32_bf16 v[108:111], a[96:99], v[224:227], v[108:111]
    s_waitcnt vmcnt(24)
    v_mfma_f32_16x16x32_bf16 v[112:115], a[80:83], v[228:231], v[112:115]
    s_add_u32 s7, s40, 201728
    buffer_load_dwordx4 v[172:175], v21, s[16:19], s7 offen sc1
    v_mfma_f32_16x16x32_bf16 v[116:119], a[84:87], v[228:231], v[116:119]
    v_mfma_f32_16x16x32_bf16 v[120:123], a[88:91], v[228:231], v[120:123]
    v_mfma_f32_16x16x32_bf16 v[124:127], a[92:95], v[228:231], v[124:127]
    v_mfma_f32_16x16x32_bf16 v[128:131], a[96:99], v[228:231], v[128:131]
    s_waitcnt vmcnt(24)
    v_mfma_f32_16x16x32_bf16 v[32:35], a[100:103], a[240:243], v[32:35]
    s_add_u32 s7, s40, 8192
    buffer_load_dwordx4 v[176:179], v21, s[16:19], s7 offen sc1
    v_mfma_f32_16x16x32_bf16 v[36:39], a[104:107], a[240:243], v[36:39]
    v_mfma_f32_16x16x32_bf16 v[40:43], a[108:111], a[240:243], v[40:43]
    v_mfma_f32_16x16x32_bf16 v[44:47], a[112:115], a[240:243], v[44:47]
    v_mfma_f32_16x16x32_bf16 v[48:51], a[116:119], a[240:243], v[48:51]
    s_add_u32 s7, s40, 57344
    buffer_load_dwordx4 v[180:183], v21, s[16:19], s7 offen sc1
    s_waitcnt vmcnt(25)
    v_mfma_f32_16x16x32_bf16 v[52:55], a[100:103], a[244:247], v[52:55]
    v_mfma_f32_16x16x32_bf16 v[56:59], a[104:107], a[244:247], v[56:59]
    v_mfma_f32_16x16x32_bf16 v[60:63], a[108:111], a[244:247], v[60:63]
    v_mfma_f32_16x16x32_bf16 v[64:67], a[112:115], a[244:247], v[64:67]
    s_add_u32 s7, s40, 106496
    buffer_load_dwordx4 v[184:187], v21, s[16:19], s7 offen sc1
    v_mfma_f32_16x16x32_bf16 v[68:71], a[116:119], a[244:247], v[68:71]
    s_waitcnt vmcnt(25)
    v_mfma_f32_16x16x32_bf16 v[72:75], a[100:103], a[248:251], v[72:75]
    v_mfma_f32_16x16x32_bf16 v[76:79], a[104:107], a[248:251], v[76:79]
    v_mfma_f32_16x16x32_bf16 v[80:83], a[108:111], a[248:251], v[80:83]
    s_add_u32 s7, s40, 155648
    buffer_load_dwordx4 v[188:191], v21, s[16:19], s7 offen sc1
    v_mfma_f32_16x16x32_bf16 v[84:87], a[112:115], a[248:251], v[84:87]
    v_mfma_f32_16x16x32_bf16 v[88:91], a[116:119], a[248:251], v[88:91]
    s_waitcnt vmcnt(25)
    v_mfma_f32_16x16x32_bf16 v[92:95], a[100:103], a[252:255], v[92:95]
    v_mfma_f32_16x16x32_bf16 v[96:99], a[104:107], a[252:255], v[96:99]
    s_add_u32 s7, s40, 204800
    buffer_load_dwordx4 a[40:43], v21, s[16:19], s7 offen sc1
    v_mfma_f32_16x16x32_bf16 v[100:103], a[108:111], a[252:255], v[100:103]
    v_mfma_f32_16x16x32_bf16 v[104:107], a[112:115], a[252:255], v[104:107]
    v_mfma_f32_16x16x32_bf16 v[108:111], a[116:119], a[252:255], v[108:111]
    s_waitcnt vmcnt(25)
    v_mfma_f32_16x16x32_bf16 v[112:115], a[100:103], v[132:135], v[112:115]
    s_add_u32 s99, s45, 4096
    s_add_u32 m0, s48, 4096
    v_mfma_f32_16x16x32_bf16 v[116:119], a[104:107], v[132:135], v[116:119]
    buffer_load_dwordx4 v21, s[16:19], s99 offen offset:0 sc1 lds
    v_mfma_f32_16x16x32_bf16 v[120:123], a[108:111], v[132:135], v[120:123]
    v_mfma_f32_16x16x32_bf16 v[124:127], a[112:115], v[132:135], v[124:127]
    v_mfma_f32_16x16x32_bf16 v[128:131], a[116:119], v[132:135], v[128:131]
    s_waitcnt vmcnt(25)
    v_mfma_f32_16x16x32_bf16 v[32:35], a[120:123], v[136:139], v[32:35]
    buffer_load_dwordx4 v21, s[16:19], s99 offen offset:1024 sc1 lds
    v_mfma_f32_16x16x32_bf16 v[36:39], a[124:127], v[136:139], v[36:39]
    v_mfma_f32_16x16x32_bf16 v[40:43], a[128:131], v[136:139], v[40:43]
    v_mfma_f32_16x16x32_bf16 v[44:47], a[132:135], v[136:139], v[44:47]
    v_mfma_f32_16x16x32_bf16 v[48:51], a[136:139], v[136:139], v[48:51]
    buffer_load_dwordx4 v21, s[16:19], s99 offen offset:2048 sc1 lds
    s_waitcnt vmcnt(26)
    v_mfma_f32_16x16x32_bf16 v[52:55], a[120:123], v[140:143], v[52:55]
    v_mfma_f32_16x16x32_bf16 v[56:59], a[124:127], v[140:143], v[56:59]
    v_mfma_f32_16x16x32_bf16 v[60:63], a[128:131], v[140:143], v[60:63]
    v_mfma_f32_16x16x32_bf16 v[64:67], a[132:135], v[140:143], v[64:67]
    buffer_load_dwordx4 v21, s[16:19], s99 offen offset:3072 sc1 lds
    v_mfma_f32_16x16x32_bf16 v[68:71], a[136:139], v[140:143], v[68:71]
    s_waitcnt vmcnt(26)
    v_mfma_f32_16x16x32_bf16 v[72:75], a[120:123], v[144:147], v[72:75]
    v_mfma_f32_16x16x32_bf16 v[76:79], a[124:127], v[144:147], v[76:79]
    v_mfma_f32_16x16x32_bf16 v[80:83], a[128:131], v[144:147], v[80:83]
    s_add_u32 s99, s45, 8192
    s_add_u32 m0, s48, 8192
    v_mfma_f32_16x16x32_bf16 v[84:87], a[132:135], v[144:147], v[84:87]
    buffer_load_dwordx4 v21, s[16:19], s99 offen offset:0 sc1 lds
    v_mfma_f32_16x16x32_bf16 v[88:91], a[136:139], v[144:147], v[88:91]
    s_waitcnt vmcnt(26)
    v_mfma_f32_16x16x32_bf16 v[92:95], a[120:123], v[148:151], v[92:95]
    v_mfma_f32_16x16x32_bf16 v[96:99], a[124:127], v[148:151], v[96:99]
    buffer_load_dwordx4 v21, s[16:19], s99 offen offset:1024 sc1 lds
    v_mfma_f32_16x16x32_bf16 v[100:103], a[128:131], v[148:151], v[100:103]
    v_mfma_f32_16x16x32_bf16 v[104:107], a[132:135], v[148:151], v[104:107]
    v_mfma_f32_16x16x32_bf16 v[108:111], a[136:139], v[148:151], v[108:111]
    s_waitcnt vmcnt(26)
    v_mfma_f32_16x16x32_bf16 v[112:115], a[120:123], a[0:3], v[112:115]
    buffer_load_dwordx4 v21, s[16:19], s99 offen offset:2048 sc1 lds
    v_mfma_f32_16x16x32_bf16 v[116:119], a[124:127], a[0:3], v[116:119]
    v_mfma_f32_16x16x32_bf16 v[120:123], a[128:131], a[0:3], v[120:123]
    v_mfma_f32_16x16x32_bf16 v[124:127], a[132:135], a[0:3], v[124:127]
    v_mfma_f32_16x16x32_bf16 v[128:131], a[136:139], a[0:3], v[128:131]
    s_waitcnt vmcnt(26)
    v_mfma_f32_16x16x32_bf16 v[32:35], a[140:143], a[4:7], v[32:35]
    buffer_load_dwordx4 v21, s[16:19], s99 offen offset:3072 sc1 lds
    v_mfma_f32_16x16x32_bf16 v[36:39], a[144:147], a[4:7], v[36:39]
    v_mfma_f32_16x16x32_bf16 v[40:43], a[148:151], a[4:7], v[40:43]
    v_mfma_f32_16x16x32_bf16 v[44:47], a[152:155], a[4:7], v[44:47]
    v_mfma_f32_16x16x32_bf16 v[48:51], a[156:159], a[4:7], v[48:51]
    s_add_u32 s99, s45, 12288
    s_add_u32 m0, s48, 12288
    s_nop 0
    buffer_load_dwordx4 v21, s[16:19], s99 offen offset:0 sc1 lds
    s_waitcnt vmcnt(27)
    v_mfma_f32_16x16x32_bf16 v[52:55], a[140:143], a[8:11], v[52:55]
    v_mfma_f32_16x16x32_bf16 v[56:59], a[144:147], a[8:11], v[56:59]
    v_mfma_f32_16x16x32_bf16 v[60:63], a[148:151], a[8:11], v[60:63]
    v_mfma_f32_16x16x32_bf16 v[64:67], a[152:155], a[8:11], v[64:67]
    buffer_load_dwordx4 v21, s[16:19], s99 offen offset:1024 sc1 lds
    v_mfma_f32_16x16x32_bf16 v[68:71], a[156:159], a[8:11], v[68:71]
    s_waitcnt vmcnt(27)
    v_mfma_f32_16x16x32_bf16 v[72:75], a[140:143], a[12:15], v[72:75]
    v_mfma_f32_16x16x32_bf16 v[76:79], a[144:147], a[12:15], v[76:79]
    v_mfma_f32_16x16x32_bf16 v[80:83], a[148:151], a[12:15], v[80:83]
    buffer_load_dwordx4 v21, s[16:19], s99 offen offset:2048 sc1 lds
    v_mfma_f32_16x16x32_bf16 v[84:87], a[152:155], a[12:15], v[84:87]
    v_mfma_f32_16x16x32_bf16 v[88:91], a[156:159], a[12:15], v[88:91]
    s_waitcnt vmcnt(27)
    v_mfma_f32_16x16x32_bf16 v[92:95], a[140:143], a[16:19], v[92:95]
    v_mfma_f32_16x16x32_bf16 v[96:99], a[144:147], a[16:19], v[96:99]
    buffer_load_dwordx4 v21, s[16:19], s99 offen offset:3072 sc1 lds
    v_mfma_f32_16x16x32_bf16 v[100:103], a[148:151], a[16:19], v[100:103]
    v_mfma_f32_16x16x32_bf16 v[104:107], a[152:155], a[16:19], v[104:107]
    v_mfma_f32_16x16x32_bf16 v[108:111], a[156:159], a[16:19], v[108:111]
    s_waitcnt vmcnt(27)
    v_mfma_f32_16x16x32_bf16 v[112:115], a[140:143], v[152:155], v[112:115]
    s_add_u32 s99, s45, 16384
    s_add_u32 m0, s48, 16384
    v_mfma_f32_16x16x32_bf16 v[116:119], a[144:147], v[152:155], v[116:119]
    buffer_load_dwordx4 v21, s[16:19], s99 offen offset:0 sc1 lds
    v_mfma_f32_16x16x32_bf16 v[120:123], a[148:151], v[152:155], v[120:123]
    v_mfma_f32_16x16x32_bf16 v[124:127], a[152:155], v[152:155], v[124:127]
    v_mfma_f32_16x16x32_bf16 v[128:131], a[156:159], v[152:155], v[128:131]
    s_waitcnt vmcnt(27)
    v_mfma_f32_16x16x32_bf16 v[32:35], a[160:163], v[156:159], v[32:35]
    buffer_load_dwordx4 v21, s[16:19], s99 offen offset:1024 sc1 lds
    v_mfma_f32_16x16x32_bf16 v[36:39], a[164:167], v[156:159], v[36:39]
    v_mfma_f32_16x16x32_bf16 v[40:43], a[168:171], v[156:159], v[40:43]
    v_mfma_f32_16x16x32_bf16 v[44:47], a[172:175], v[156:159], v[44:47]
    v_mfma_f32_16x16x32_bf16 v[48:51], a[176:179], v[156:159], v[48:51]
    buffer_load_dwordx4 v21, s[16:19], s99 offen offset:2048 sc1 lds
    s_waitcnt vmcnt(28)
    v_mfma_f32_16x16x32_bf16 v[52:55], a[160:163], v[160:163], v[52:55]
    v_mfma_f32_16x16x32_bf16 v[56:59], a[164:167], v[160:163], v[56:59]
    v_mfma_f32_16x16x32_bf16 v[60:63], a[168:171], v[160:163], v[60:63]
    v_mfma_f32_16x16x32_bf16 v[64:67], a[172:175], v[160:163], v[64:67]
    buffer_load_dwordx4 v21, s[16:19], s99 offen offset:3072 sc1 lds
    v_mfma_f32_16x16x32_bf16 v[68:71], a[176:179], v[160:163], v[68:71]
    s_waitcnt vmcnt(28)
    v_mfma_f32_16x16x32_bf16 v[72:75], a[160:163], v[164:167], v[72:75]
    v_mfma_f32_16x16x32_bf16 v[76:79], a[164:167], v[164:167], v[76:79]
    v_mfma_f32_16x16x32_bf16 v[80:83], a[168:171], v[164:167], v[80:83]
    s_add_u32 s99, s45, 20480
    s_add_u32 m0, s48, 20480
    v_mfma_f32_16x16x32_bf16 v[84:87], a[172:175], v[164:167], v[84:87]
    buffer_load_dwordx4 v21, s[16:19], s99 offen offset:0 sc1 lds
    v_mfma_f32_16x16x32_bf16 v[88:91], a[176:179], v[164:167], v[88:91]
    s_waitcnt vmcnt(28)
    v_mfma_f32_16x16x32_bf16 v[92:95], a[160:163], v[168:171], v[92:95]
    v_mfma_f32_16x16x32_bf16 v[96:99], a[164:167], v[168:171], v[96:99]
    buffer_load_dwordx4 v21, s[16:19], s99 offen offset:1024 sc1 lds
    v_mfma_f32_16x16x32_bf16 v[100:103], a[168:171], v[168:171], v[100:103]
    v_mfma_f32_16x16x32_bf16 v[104:107], a[172:175], v[168:171], v[104:107]
    v_mfma_f32_16x16x32_bf16 v[108:111], a[176:179], v[168:171], v[108:111]
    s_waitcnt vmcnt(28)
    v_mfma_f32_16x16x32_bf16 v[112:115], a[160:163], a[20:23], v[112:115]
    buffer_load_dwordx4 v21, s[16:19], s99 offen offset:2048 sc1 lds
    v_mfma_f32_16x16x32_bf16 v[116:119], a[164:167], a[20:23], v[116:119]
    v_mfma_f32_16x16x32_bf16 v[120:123], a[168:171], a[20:23], v[120:123]
    v_mfma_f32_16x16x32_bf16 v[124:127], a[172:175], a[20:23], v[124:127]
    v_mfma_f32_16x16x32_bf16 v[128:131], a[176:179], a[20:23], v[128:131]
    buffer_load_dword v248, v251, s[16:19], 0 offen sc1
    s_waitcnt vmcnt(29)
    v_mfma_f32_16x16x32_bf16 v[32:35], a[180:183], a[24:27], v[32:35]
    buffer_load_dwordx4 v21, s[16:19], s99 offen offset:3072 sc1 lds
    v_mfma_f32_16x16x32_bf16 v[36:39], a[184:187], a[24:27], v[36:39]
    v_mfma_f32_16x16x32_bf16 v[40:43], a[188:191], a[24:27], v[40:43]
    v_mfma_f32_16x16x32_bf16 v[44:47], a[192:195], a[24:27], v[44:47]
    v_mfma_f32_16x16x32_bf16 v[48:51], a[196:199], a[24:27], v[48:51]
    s_add_u32 s99, s45, 24576
    s_add_u32 m0, s48, 24576
    s_nop 0
    buffer_load_dwordx4 v21, s[16:19], s99 offen offset:0 sc1 lds
    s_waitcnt vmcnt(30)
    v_mfma_f32_16x16x32_bf16 v[52:55], a[180:183], a[28:31], v[52:55]
    v_mfma_f32_16x16x32_bf16 v[56:59], a[184:187], a[28:31], v[56:59]
    v_mfma_f32_16x16x32_bf16 v[60:63], a[188:191], a[28:31], v[60:63]
    v_mfma_f32_16x16x32_bf16 v[64:67], a[192:195], a[28:31], v[64:67]
    s_add_u32 s7, s40, 11264
    buffer_load_dwordx4 a[44:47], v21, s[16:19], s7 offen sc1
    v_mfma_f32_16x16x32_bf16 v[68:71], a[196:199], a[28:31], v[68:71]
    s_waitcnt vmcnt(30)
    v_mfma_f32_16x16x32_bf16 v[72:75], a[180:183], a[32:35], v[72:75]
    v_mfma_f32_16x16x32_bf16 v[76:79], a[184:187], a[32:35], v[76:79]
    v_mfma_f32_16x16x32_bf16 v[80:83], a[188:191], a[32:35], v[80:83]
    s_add_u32 s7, s40, 60416
    buffer_load_dwordx4 a[48:51], v21, s[16:19], s7 offen sc1
    v_mfma_f32_16x16x32_bf16 v[84:87], a[192:195], a[32:35], v[84:87]
    v_mfma_f32_16x16x32_bf16 v[88:91], a[196:199], a[32:35], v[88:91]
    s_waitcnt vmcnt(30)
    v_mfma_f32_16x16x32_bf16 v[92:95], a[180:183], a[36:39], v[92:95]
    v_mfma_f32_16x16x32_bf16 v[96:99], a[184:187], a[36:39], v[96:99]
    s_add_u32 s7, s40, 109568
    buffer_load_dwordx4 a[52:55], v21, s[16:19], s7 offen sc1
    v_mfma_f32_16x16x32_bf16 v[100:103], a[188:191], a[36:39], v[100:103]
    v_mfma_f32_16x16x32_bf16 v[104:107], a[192:195], a[36:39], v[104:107]
    v_mfma_f32_16x16x32_bf16 v[108:111], a[196:199], a[36:39], v[108:111]
    s_waitcnt vmcnt(30)
    v_mfma_f32_16x16x32_bf16 v[112:115], a[180:183], v[172:175], v[112:115]
    s_add_u32 s7, s40, 158720
    buffer_load_dwordx4 a[56:59], v21, s[16:19], s7 offen sc1
    v_mfma_f32_16x16x32_bf16 v[116:119], a[184:187], v[172:175], v[116:119]
    v_mfma_f32_16x16x32_bf16 v[120:123], a[188:191], v[172:175], v[120:123]
    v_mfma_f32_16x16x32_bf16 v[124:127], a[192:195], v[172:175], v[124:127]
    v_mfma_f32_16x16x32_bf16 v[128:131], a[196:199], v[172:175], v[128:131]
    s_waitcnt vmcnt(30)
    v_mfma_f32_16x16x32_bf16 v[32:35], a[200:203], v[176:179], v[32:35]
    s_add_u32 s7, s40, 207872
    buffer_load_dwordx4 v[192:195], v21, s[16:19], s7 offen sc1
    v_mfma_f32_16x16x32_bf16 v[36:39], a[204:207], v[176:179], v[36:39]
    v_mfma_f32_16x16x32_bf16 v[40:43], a[208:211], v[176:179], v[40:43]
    v_mfma_f32_16x16x32_bf16 v[44:47], a[212:215], v[176:179], v[44:47]
    v_mfma_f32_16x16x32_bf16 v[48:51], a[216:219], v[176:179], v[48:51]
    s_waitcnt vmcnt(30)
    v_mfma_f32_16x16x32_bf16 v[52:55], a[200:203], v[180:183], v[52:55]
    v_mfma_f32_16x16x32_bf16 v[56:59], a[204:207], v[180:183], v[56:59]
    v_mfma_f32_16x16x32_bf16 v[60:63], a[208:211], v[180:183], v[60:63]
    v_mfma_f32_16x16x32_bf16 v[64:67], a[212:215], v[180:183], v[64:67]
    v_mfma_f32_16x16x32_bf16 v[68:71], a[216:219], v[180:183], v[68:71]
    s_waitcnt vmcnt(29)
    v_mfma_f32_16x16x32_bf16 v[72:75], a[200:203], v[184:187], v[72:75]
    v_mfma_f32_16x16x32_bf16 v[76:79], a[204:207], v[184:187], v[76:79]
    v_mfma_f32_16x16x32_bf16 v[80:83], a[208:211], v[184:187], v[80:83]
    v_mfma_f32_16x16x32_bf16 v[84:87], a[212:215], v[184:187], v[84:87]
    v_mfma_f32_16x16x32_bf16 v[88:91], a[216:219], v[184:187], v[88:91]
    s_waitcnt vmcnt(28)
    v_mfma_f32_16x16x32_bf16 v[92:95], a[200:203], v[188:191], v[92:95]
    v_mfma_f32_16x16x32_bf16 v[96:99], a[204:207], v[188:191], v[96:99]
    v_mfma_f32_16x16x32_bf16 v[100:103], a[208:211], v[188:191], v[100:103]
    v_mfma_f32_16x16x32_bf16 v[104:107], a[212:215], v[188:191], v[104:107]
    v_mfma_f32_16x16x32_bf16 v[108:111], a[216:219], v[188:191], v[108:111]
    s_waitcnt vmcnt(27)
    v_mfma_f32_16x16x32_bf16 v[112:115], a[200:203], a[40:43], v[112:115]
    v_mfma_f32_16x16x32_bf16 v[116:119], a[204:207], a[40:43], v[116:119]
    v_mfma_f32_16x16x32_bf16 v[120:123], a[208:211], a[40:43], v[120:123]
    v_mfma_f32_16x16x32_bf16 v[124:127], a[212:215], a[40:43], v[124:127]
    v_mfma_f32_16x16x32_bf16 v[128:131], a[216:219], a[40:43], v[128:131]
    s_waitcnt vmcnt(7)
    v_cmp_ne_u32 vcc, 0, v248
    s_mov_b32 s98, 0
    s_nop 0
    s_cmp_eq_u64 vcc, -1
    s_cbranch_scc1 L_ok_28
L_spin_29:
    buffer_load_dword v248, v251, s[16:19], 0 offen sc1
    s_add_u32 s98, s98, 1
    s_waitcnt vmcnt(0)
    v_cmp_ne_u32 vcc, 0, v248
    s_cmp_gt_u32 s98, 0x40000
    s_cbranch_scc1 L_ok_28
    s_cmp_eq_u64 vcc, -1
    s_cbranch_scc0 L_spin_29
L_ok_28:
    buffer_load_dword v234, v253, s[16:19], s42 offen offset:0 sc1
    buffer_load_dword v235, v253, s[16:19], s42 offen offset:64 sc1
    buffer_load_dword v236, v253, s[16:19], s42 offen offset:128 sc1
    buffer_load_dword v237, v253, s[16:19], s42 offen offset:192 sc1
    buffer_load_dword v238, v253, s[16:19], s42 offen offset:256 sc1
    s_waitcnt vmcnt(10)
    s_waitcnt vmcnt(9)
    v_mfma_f32_16x16x32_bf16 v[32:35], a[220:223], a[44:47], v[32:35]
    ds_read_b128 v[196:199], v255 offset:0
    ds_read_b128 v[200:203], v255 offset:1024
    v_mfma_f32_16x16x32_bf16 v[36:39], a[224:227], a[44:47], v[36:39]
    ds_read_b128 v[204:207], v255 offset:2048
    ds_read_b128 v[208:211], v255 offset:3072
    v_mfma_f32_16x16x32_bf16 v[40:43], a[228:231], a[44:47], v[40:43]
    ds_read_b128 a[60:63], v255 offset:4096
    s_add_u32 s7, s41, 0
    v_mfma_f32_16x16x32_bf16 v[44:47], a[232:235], a[44:47], v[44:47]
    buffer_load_dwordx4 a[64:67], v21, s[16:19], s7 offen sc1
    v_mfma_f32_16x16x32_bf16 v[48:51], a[236:239], a[44:47], v[48:51]
    s_add_u32 s7, s41, 20480
    buffer_load_dwordx4 a[68:71], v21, s[16:19], s7 offen sc1
    s_waitcnt vmcnt(10)
    v_mfma_f32_16x16x32_bf16 v[52:55], a[220:223], a[48:51], v[52:55]
    v_mfma_f32_16x16x32_bf16 v[56:59], a[224:227], a[48:51], v[56:59]
    v_mfma_f32_16x16x32_bf16 v[60:63], a[228:231], a[48:51], v[60:63]
    v_mfma_f32_16x16x32_bf16 v[64:67], a[232:235], a[48:51], v[64:67]
    s_add_u32 s7, s41, 40960
    buffer_load_dwordx4 a[72:75], v21, s[16:19], s7 offen sc1
    v_mfma_f32_16x16x32_bf16 v[68:71], a[236:239], a[48:51], v[68:71]
    s_waitcnt vmcnt(10)
    v_mfma_f32_16x16x32_bf16 v[72:75], a[220:223], a[52:55], v[72:75]
    v_mfma_f32_16x16x32_bf16 v[76:79], a[224:227], a[52:55], v[76:79]
    v_mfma_f32_16x16x32_bf16 v[80:83], a[228:231], a[52:55], v[80:83]
    s_add_u32 s7, s41, 61440
    buffer_load_dwordx4 a[76:79], v21, s[16:19], s7 offen sc1
    v_mfma_f32_16x16x32_bf16 v[84:87], a[232:235], a[52:55], v[84:87]
    v_mfma_f32_16x16x32_bf16 v[88:91], a[236:239], a[52:55], v[88:91]
    s_waitcnt vmcnt(10)
    v_mfma_f32_16x16x32_bf16 v[92:95], a[220:223], a[56:59], v[92:95]
    v_mfma_f32_16x16x32_bf16 v[96:99], a[224:227], a[56:59], v[96:99]
    s_add_u32 s7, s41, 81920
    buffer_load_dwordx4 v[212:215], v21, s[16:19], s7 offen sc1
    v_mfma_f32_16x16x32_bf16 v[100:103], a[228:231], a[56:59], v[100:103]
    v_mfma_f32_16x16x32_bf16 v[104:107], a[232:235], a[56:59], v[104:107]
    v_mfma_f32_16x16x32_bf16 v[108:111], a[236:239], a[56:59], v[108:111]
    s_waitcnt vmcnt(10)
    v_mfma_f32_16x16x32_bf16 v[112:115], a[220:223], v[192:195], v[112:115]
    s_add_u32 s7, s41, 1024
    buffer_load_dwordx4 v[216:219], v21, s[16:19], s7 offen sc1
    v_mfma_f32_16x16x32_bf16 v[116:119], a[224:227], v[192:195], v[116:119]
    v_mfma_f32_16x16x32_bf16 v[120:123], a[228:231], v[192:195], v[120:123]
    v_mfma_f32_16x16x32_bf16 v[124:127], a[232:235], v[192:195], v[124:127]
    v_mfma_f32_16x16x32_bf16 v[128:131], a[236:239], v[192:195], v[128:131]
    s_waitcnt vmcnt(10)
    v_pk_mul_f32 v[32:33], v[32:33], v[234:235] op_sel_hi:[1,0]
    v_pk_mul_f32 v[34:35], v[34:35], v[234:235] op_sel_hi:[1,0]
    v_pk_mul_f32 v[36:37], v[36:37], v[234:235] op_sel_hi:[1,0]
    v_pk_mul_f32 v[38:39], v[38:39], v[234:235] op_sel_hi:[1,0]
    v_pk_mul_f32 v[40:41], v[40:41], v[234:235] op_sel_hi:[1,0]
    v_pk_mul_f32 v[42:43], v[42:43], v[234:235] op_sel_hi:[1,0]
    v_pk_mul_f32 v[44:45], v[44:45], v[234:235] op_sel_hi:[1,0]
    v_pk_mul_f32 v[46:47], v[46:47], v[234:235] op_sel_hi:[1,0]
    v_pk_mul_f32 v[48:49], v[48:49], v[234:235] op_sel_hi:[1,0]
    v_pk_mul_f32 v[50:51], v[50:51], v[234:235] op_sel_hi:[1,0]
    s_waitcnt vmcnt(9)
    v_pk_mul_f32 v[52:53], v[52:53], v[234:235] op_sel:[0,1] op_sel_hi:[1,1]
    v_pk_mul_f32 v[54:55], v[54:55], v[234:235] op_sel:[0,1] op_sel_hi:[1,1]
    v_pk_mul_f32 v[56:57], v[56:57], v[234:235] op_sel:[0,1] op_sel_hi:[1,1]
    v_pk_mul_f32 v[58:59], v[58:59], v[234:235] op_sel:[0,1] op_sel_hi:[1,1]
    v_pk_mul_f32 v[60:61], v[60:61], v[234:235] op_sel:[0,1] op_sel_hi:[1,1]
    v_pk_mul_f32 v[62:63], v[62:63], v[234:235] op_sel:[0,1] op_sel_hi:[1,1]
    v_pk_mul_f32 v[64:65], v[64:65], v[234:235] op_sel:[0,1] op_sel_hi:[1,1]
    v_pk_mul_f32 v[66:67], v[66:67], v[234:235] op_sel:[0,1] op_sel_hi:[1,1]
    v_pk_mul_f32 v[68:69], v[68:69], v[234:235] op_sel:[0,1] op_sel_hi:[1,1]
    v_pk_mul_f32 v[70:71], v[70:71], v[234:235] op_sel:[0,1] op_sel_hi:[1,1]
    s_waitcnt vmcnt(8)
    v_pk_mul_f32 v[72:73], v[72:73], v[236:237] op_sel_hi:[1,0]
    v_pk_mul_f32 v[74:75], v[74:75], v[236:237] op_sel_hi:[1,0]
    v_pk_mul_f32 v[76:77], v[76:77], v[236:237] op_sel_hi:[1,0]
    v_pk_mul_f32 v[78:79], v[78:79], v[236:237] op_sel_hi:[1,0]
    v_pk_mul_f32 v[80:81], v[80:81], v[236:237] op_sel_hi:[1,0]
    v_pk_mul_f32 v[82:83], v[82:83], v[236:237] op_sel_hi:[1,0]
    v_pk_mul_f32 v[84:85], v[84:85], v[236:237] op_sel_hi:[1,0]
    v_pk_mul_f32 v[86:87], v[86:87], v[236:237] op_sel_hi:[1,0]
    v_pk_mul_f32 v[88:89], v[88:89], v[236:237] op_sel_hi:[1,0]
    v_pk_mul_f32 v[90:91], v[90:91], v[236:237] op_sel_hi:[1,0]
    s_waitcnt vmcnt(7)
    v_pk_mul_f32 v[92:93], v[92:93], v[236:237] op_sel:[0,1] op_sel_hi:[1,1]
    v_pk_mul_f32 v[94:95], v[94:95], v[236:237] op_sel:[0,1] op_sel_hi:[1,1]
    v_pk_mul_f32 v[96:97], v[96:97], v[236:237] op_sel:[0,1] op_sel_hi:[1,1]
    v_pk_mul_f32 v[98:99], v[98:99], v[236:237] op_sel:[0,1] op_sel_hi:[1,1]
    v_pk_mul_f32 v[100:101], v[100:101], v[236:237] op_sel:[0,1] op_sel_hi:[1,1]
    v_pk_mul_f32 v[102:103], v[102:103], v[236:237] op_sel:[0,1] op_sel_hi:[1,1]
    v_pk_mul_f32 v[104:105], v[104:105], v[236:237] op_sel:[0,1] op_sel_hi:[1,1]
    v_pk_mul_f32 v[106:107], v[106:107], v[236:237] op_sel:[0,1] op_sel_hi:[1,1]
    v_pk_mul_f32 v[108:109], v[108:109], v[236:237] op_sel:[0,1] op_sel_hi:[1,1]
    v_pk_mul_f32 v[110:111], v[110:111], v[236:237] op_sel:[0,1] op_sel_hi:[1,1]
    s_waitcnt vmcnt(6)
    s_waitcnt lgkmcnt(0)
    v_pk_mul_f32 v[112:113], v[112:113], v[238:239] op_sel_hi:[1,0]
    v_pk_mul_f32 v[114:115], v[114:115], v[238:239] op_sel_hi:[1,0]
    v_pk_mul_f32 v[116:117], v[116:117], v[238:239] op_sel_hi:[1,0]
    v_pk_mul_f32 v[118:119], v[118:119], v[238:239] op_sel_hi:[1,0]
    v_pk_mul_f32 v[120:121], v[120:121], v[238:239] op_sel_hi:[1,0]
    v_pk_mul_f32 v[122:123], v[122:123], v[238:239] op_sel_hi:[1,0]
    v_pk_mul_f32 v[124:125], v[124:125], v[238:239] op_sel_hi:[1,0]
    v_pk_mul_f32 v[126:127], v[126:127], v[238:239] op_sel_hi:[1,0]
    v_pk_mul_f32 v[128:129], v[128:129], v[238:239] op_sel_hi:[1,0]
    v_pk_mul_f32 v[130:131], v[130:131], v[238:239] op_sel_hi:[1,0]
    s_waitcnt vmcnt(5)
    v_mfma_f32_16x16x32_bf16 v[32:35], v[196:199], a[64:67], v[32:35]
    ds_read_b128 v[220:223], v255 offset:5120
    ds_read_b128 v[224:227], v255 offset:6144
    v_mfma_f32_16x16x32_bf16 v[36:39], v[200:203], a[64:67], v[36:39]
    ds_read_b128 v[228:231], v255 offset:7168
    ds_read_b128 a[80:83], v255 offset:8192
    v_mfma_f32_16x16x32_bf16 v[40:43], v[204:207], a[64:67], v[40:43]
    ds_read_b128 a[84:87], v255 offset:9216
    s_add_u32 s7, s41, 21504
    v_mfma_f32_16x16x32_bf16 v[44:47], v[208:211], a[64:67], v[44:47]
    buffer_load_dwordx4 a[88:91], v21, s[16:19], s7 offen sc1
    v_mfma_f32_16x16x32_bf16 v[48:51], a[60:63], a[64:67], v[48:51]
    s_add_u32 s7, s41, 41984
    buffer_load_dwordx4 a[92:95], v21, s[16:19], s7 offen sc1
    s_waitcnt vmcnt(6)
    v_mfma_f32_16x16x32_bf16 v[52:55], v[196:199], a[68:71], v[52:55]
    v_mfma_f32_16x16x32_bf16 v[56:59], v[200:203], a[68:71], v[56:59]
    v_mfma_f32_16x16x32_bf16 v[60:63], v[204:207], a[68:71], v[60:63]
    v_mfma_f32_16x16x32_bf16 v[64:67], v[208:211], a[68:71], v[64:67]
    s_add_u32 s7, s41, 62464
    buffer_load_dwordx4 a[96:99], v21, s[16:19], s7 offen sc1
    v_mfma_f32_16x16x32_bf16 v[68:71], a[60:63], a[68:71], v[68:71]
    s_waitcnt vmcnt(6)
    v_mfma_f32_16x16x32_bf16 v[72:75], v[196:199], a[72:75], v[72:75]
    v_mfma_f32_16x16x32_bf16 v[76:79], v[200:203], a[72:75], v[76:79]
    v_mfma_f32_16x16x32_bf16 v[80:83], v[204:207], a[72:75], v[80:83]
    s_add_u32 s7, s41, 82944
    buffer_load_dwordx4 a[240:243], v21, s[16:19], s7 offen sc1
    v_mfma_f32_16x16x32_bf16 v[84:87], v[208:211], a[72:75], v[84:87]
    v_mfma_f32_16x16x32_bf16 v[88:91], a[60:63], a[72:75], v[88:91]
    s_waitcnt vmcnt(6)
    v_mfma_f32_16x16x32_bf16 v[92:95], v[196:199], a[76:79], v[92:95]
    v_mfma_f32_16x16x32_bf16 v[96:99], v[200:203], a[76:79], v[96:99]
    s_add_u32 s7, s41, 2048
    buffer_load_dwordx4 a[244:247], v21, s[16:19], s7 offen sc1
    v_mfma_f32_16x16x32_bf16 v[100:103], v[204:207], a[76:79], v[100:103]
    v_mfma_f32_16x16x32_bf16 v[104:107], v[208:211], a[76:79], v[104:107]
    v_mfma_f32_16x16x32_bf16 v[108:111], a[60:63], a[76:79], v[108:111]
    s_waitcnt vmcnt(6)
    v_mfma_f32_16x16x32_bf16 v[112:115], v[196:199], v[212:215], v[112:115]
    s_add_u32 s7, s41, 22528
    buffer_load_dwordx4 a[248:251], v21, s[16:19], s7 offen sc1
    v_mfma_f32_16x16x32_bf16 v[116:119], v[200:203], v[212:215], v[116:119]
    v_mfma_f32_16x16x32_bf16 v[120:123], v[204:207], v[212:215], v[120:123]
    v_mfma_f32_16x16x32_bf16 v[124:127], v[208:211], v[212:215], v[124:127]
    v_mfma_f32_16x16x32_bf16 v[128:131], a[60:63], v[212:215], v[128:131]
    s_waitcnt lgkmcnt(0)
    s_waitcnt vmcnt(6)
    v_mfma_f32_16x16x32_bf16 v[32:35], v[220:223], v[216:219], v[32:35]
    ds_read_b128 a[252:255], v255 offset:10240
    ds_read_b128 v[132:135], v255 offset:11264
    v_mfma_f32_16x16x32_bf16 v[36:39], v[224:227], v[216:219], v[36:39]
    ds_read_b128 a[100:103], v255 offset:12288
    ds_read_b128 a[104:107], v255 offset:13312
    v_mfma_f32_16x16x32_bf16 v[40:43], v[228:231], v[216:219], v[40:43]
    ds_read_b128 a[108:111], v255 offset:14336
    s_add_u32 s7, s41, 43008
    v_mfma_f32_16x16x32_bf16 v[44:47], a[80:83], v[216:219], v[44:47]
    buffer_load_dwordx4 a[112:115], v21, s[16:19], s7 offen sc1
    v_mfma_f32_16x16x32_bf16 v[48:51], a[84:87], v[216:219], v[48:51]
    s_add_u32 s7, s41, 63488
    buffer_load_dwordx4 a[116:119], v21, s[16:19], s7 offen sc1
    s_waitcnt vmcnt(7)
    v_mfma_f32_16x16x32_bf16 v[52:55], v[220:223], a[88:91], v[52:55]
    v_mfma_f32_16x16x32_bf16 v[56:59], v[224:227], a[88:91], v[56:59]
    v_mfma_f32_16x16x32_bf16 v[60:63], v[228:231], a[88:91], v[60:63]
    v_mfma_f32_16x16x32_bf16 v[64:67], a[80:83], a[88:91], v[64:67]
    s_add_u32 s7, s41, 83968
    buffer_load_dwordx4 v[136:139], v21, s[16:19], s7 offen sc1
    v_mfma_f32_16x16x32_bf16 v[68:71], a[84:87], a[88:91], v[68:71]
    s_waitcnt vmcnt(7)
    v_mfma_f32_16x16x32_bf16 v[72:75], v[220:223], a[92:95], v[72:75]
    v_mfma_f32_16x16x32_bf16 v[76:79], v[224:227], a[92:95], v[76:79]
    v_mfma_f32_16x16x32_bf16 v[80:83], v[228:231], a[92:95], v[80:83]
    s_add_u32 s7, s41, 3072
    buffer_load_dwordx4 v[140:143], v21, s[16:19], s7 offen sc1
    v_mfma_f32_16x16x32_bf16 v[84:87], a[80:83], a[92:95], v[84:87]
    v_mfma_f32_16x16x32_bf16 v[88:91], a[84:87], a[92:95], v[88:91]
    s_waitcnt vmcnt(7)
    v_mfma_f32_16x16x32_bf16 v[92:95], v[220:223], a[96:99], v[92:95]
    v_mfma_f32_16x16x32_bf16 v[96:99], v[224:227], a[96:99], v[96:99]
    s_add_u32 s7, s41, 23552
    buffer_load_dwordx4 v[144:147], v21, s[16:19], s7 offen sc1
    v_mfma_f32_16x16x32_bf16 v[100:103], v[228:231], a[96:99], v[100:103]
    v_mfma_f32_16x16x32_bf16 v[104:107], a[80:83], a[96:99], v[104:107]
    v_mfma_f32_16x16x32_bf16 v[108:111], a[84:87], a[96:99], v[108:111]
    s_waitcnt vmcnt(7)
    v_mfma_f32_16x16x32_bf16 v[112:115], v[220:223], a[240:243], v[112:115]
    s_add_u32 s7, s41, 44032
    buffer_load_dwordx4 v[148:151], v21, s[16:19], s7 offen sc1
    v_mfma_f32_16x16x32_bf16 v[116:119], v[224:227], a[240:243], v[116:119]
    v_mfma_f32_16x16x32_bf16 v[120:123], v[228:231], a[240:243], v[120:123]
    v_mfma_f32_16x16x32_bf16 v[124:127], a[80:83], a[240:243], v[124:127]
    v_mfma_f32_16x16x32_bf16 v[128:131], a[84:87], a[240:243], v[128:131]
    s_waitcnt lgkmcnt(0)
    s_waitcnt vmcnt(7)
    v_mfma_f32_16x16x32_bf16 v[32:35], a[252:255], a[244:247], v[32:35]
    ds_read_b128 a[0:3], v255 offset:15360
    ds_read_b128 a[120:123], v255 offset:16384
    v_mfma_f32_16x16x32_bf16 v[36:39], v[132:135], a[244:247], v[36:39]
    ds_read_b128 a[124:127], v255 offset:17408
    ds_read_b128 a[128:131], v255 offset:18432
    v_mfma_f32_16x16x32_bf16 v[40:43], a[100:103], a[244:247], v[40:43]
    ds_read_b128 a[132:135], v255 offset:19456
    s_add_u32 s7, s41, 64512
    v_mfma_f32_16x16x32_bf16 v[44:47], a[104:107], a[244:247], v[44:47]
    buffer_load_dwordx4 a[136:139], v21, s[16:19], s7 offen sc1
    v_mfma_f32_16x16x32_bf16 v[48:51], a[108:111], a[244:247], v[48:51]
    s_add_u32 s7, s41, 84992
    buffer_load_dwordx4 a[4:7], v21, s[16:19], s7 offen sc1
    s_waitcnt vmcnt(8)
    v_mfma_f32_16x16x32_bf16 v[52:55], a[252:255], a[248:251], v[52:55]
    v_mfma_f32_16x16x32_bf16 v[56:59], v[132:135], a[248:251], v[56:59]
    v_mfma_f32_16x16x32_bf16 v[60:63], a[100:103], a[248:251], v[60:63]
    v_mfma_f32_16x16x32_bf16 v[64:67], a[104:107], a[248:251], v[64:67]
    s_add_u32 s7, s41, 4096
    buffer_load_dwordx2 a[8:9], v252, s[16:19], s7 offen sc1
    v_mfma_f32_16x16x32_bf16 v[68:71], a[108:111], a[248:251], v[68:71]
    buffer_load_dwordx2 a[10:11], v252, s[16:19], s7 offen offset:512 sc1
    s_waitcnt vmcnt(9)
    v_mfma_f32_16x16x32_bf16 v[72:75], a[252:255], a[112:115], v[72:75]
    v_mfma_f32_16x16x32_bf16 v[76:79], v[132:135], a[112:115], v[76:79]
    v_mfma_f32_16x16x32_bf16 v[80:83], a[100:103], a[112:115], v[80:83]
    s_add_u32 s7, s41, 24576
    buffer_load_dwordx2 a[12:13], v252, s[16:19], s7 offen sc1
    v_mfma_f32_16x16x32_bf16 v[84:87], a[104:107], a[112:115], v[84:87]
    buffer_load_dwordx2 a[14:15], v252, s[16:19], s7 offen offset:512 sc1
    v_mfma_f32_16x16x32_bf16 v[88:91], a[108:111], a[112:115], v[88:91]
    s_waitcnt vmcnt(10)
    v_mfma_f32_16x16x32_bf16 v[92:95], a[252:255], a[116:119], v[92:95]
    v_mfma_f32_16x16x32_bf16 v[96:99], v[132:135], a[116:119], v[96:99]
    s_add_u32 s7, s41, 45056
    buffer_load_dwordx2 a[16:17], v252, s[16:19], s7 offen sc1
    v_mfma_f32_16x16x32_bf16 v[100:103], a[100:103], a[116:119], v[100:103]
    buffer_load_dwordx2 a[18:19], v252, s[16:19], s7 offen offset:512 sc1
    v_mfma_f32_16x16x32_bf16 v[104:107], a[104:107], a[116:119], v[104:107]
    v_mfma_f32_16x16x32_bf16 v[108:111], a[108:111], a[116:119], v[108:111]
    s_waitcnt vmcnt(11)
    v_mfma_f32_16x16x32_bf16 v[112:115], a[252:255], v[136:139], v[112:115]
    s_add_u32 s7, s41, 65536
    buffer_load_dwordx2 v[152:153], v252, s[16:19], s7 offen sc1
    v_mfma_f32_16x16x32_bf16 v[116:119], v[132:135], v[136:139], v[116:119]
    buffer_load_dwordx2 v[154:155], v252, s[16:19], s7 offen offset:512 sc1
    v_mfma_f32_16x16x32_bf16 v[120:123], a[100:103], v[136:139], v[120:123]
    v_mfma_f32_16x16x32_bf16 v[124:127], a[104:107], v[136:139], v[124:127]
    v_mfma_f32_16x16x32_bf16 v[128:131], a[108:111], v[136:139], v[128:131]
    s_waitcnt lgkmcnt(0)
    s_waitcnt vmcnt(12)
    v_mfma_f32_16x16x32_bf16 v[32:35], a[0:3], v[140:143], v[32:35]
    ds_read_b128 a[140:143], v255 offset:20480
    ds_read_b128 a[144:147], v255 offset:21504
    v_mfma_f32_16x16x32_bf16 v[36:39], a[120:123], v[140:143], v[36:39]
    ds_read_b128 a[148:151], v255 offset:22528
    ds_read_b128 a[152:155], v255 offset:23552
    v_mfma_f32_16x16x32_bf16 v[40:43], a[124:127], v[140:143], v[40:43]
    ds_read_b128 a[156:159], v255 offset:24576
    s_add_u32 s7, s41, 86016
    v_mfma_f32_16x16x32_bf16 v[44:47], a[128:131], v[140:143], v[44:47]
    buffer_load_dwordx2 v[156:157], v252, s[16:19], s7 offen sc1
    buffer_load_dwordx2 v[158:159], v252, s[16:19], s7 offen offset:512 sc1
    v_mfma_f32_16x16x32_bf16 v[48:51], a[132:135], v[140:143], v[48:51]
    s_waitcnt vmcnt(13)
    v_mfma_f32_16x16x32_bf16 v[52:55], a[0:3], v[144:147], v[52:55]
    v_mfma_f32_16x16x32_bf16 v[56:59], a[120:123], v[144:147], v[56:59]
    v_mfma_f32_16x16x32_bf16 v[60:63], a[124:127], v[144:147], v[60:63]
    v_mfma_f32_16x16x32_bf16 v[64:67], a[128:131], v[144:147], v[64:67]
    v_mfma_f32_16x16x32_bf16 v[68:71], a[132:135], v[144:147], v[68:71]
    s_waitcnt vmcnt(12)
    v_mfma_f32_16x16x32_bf16 v[72:75], a[0:3], v[148:151], v[72:75]
    v_mfma_f32_16x16x32_bf16 v[76:79], a[120:123], v[148:151], v[76:79]
    v_mfma_f32_16x16x32_bf16 v[80:83], a[124:127], v[148:151], v[80:83]
    v_mfma_f32_16x16x32_bf16 v[84:87], a[128:131], v[148:151], v[84:87]
    v_mfma_f32_16x16x32_bf16 v[88:91], a[132:135], v[148:151], v[88:91]
    s_waitcnt vmcnt(11)
    v_mfma_f32_16x16x32_bf16 v[92:95], a[0:3], a[136:139], v[92:95]
    v_mfma_f32_16x16x32_bf16 v[96:99], a[120:123], a[136:139], v[96:99]
    v_mfma_f32_16x16x32_bf16 v[100:103], a[124:127], a[136:139], v[100:103]
    v_mfma_f32_16x16x32_bf16 v[104:107], a[128:131], a[136:139], v[104:107]
    v_mfma_f32_16x16x32_bf16 v[108:111], a[132:135], a[136:139], v[108:111]
    s_waitcnt vmcnt(10)
    v_mfma_f32_16x16x32_bf16 v[112:115], a[0:3], a[4:7], v[112:115]
    v_mfma_f32_16x16x32_bf16 v[116:119], a[120:123], a[4:7], v[116:119]
    v_mfma_f32_16x16x32_bf16 v[120:123], a[124:127], a[4:7], v[120:123]
    v_mfma_f32_16x16x32_bf16 v[124:127], a[128:131], a[4:7], v[124:127]
    v_mfma_f32_16x16x32_bf16 v[128:131], a[132:135], a[4:7], v[128:131]
    s_waitcnt lgkmcnt(0)
    s_waitcnt vmcnt(8)
    v_mfma_f32_16x16x32_bf16 v[32:35], a[140:143], a[8:11], v[32:35]
    v_mfma_f32_16x16x32_bf16 v[36:39], a[144:147], a[8:11], v[36:39]
    v_mfma_f32_16x16x32_bf16 v[40:43], a[148:151], a[8:11], v[40:43]
    v_mfma_f32_16x16x32_bf16 v[44:47], a[152:155], a[8:11], v[44:47]
    v_mfma_f32_16x16x32_bf16 v[48:51], a[156:159], a[8:11], v[48:51]
    s_waitcnt vmcnt(6)
    v_mfma_f32_16x16x32_bf16 v[52:55], a[140:143], a[12:15], v[52:55]
    s_nop 1
    ds_write_b128 v254, v[32:35] offset:0
    v_mfma_f32_16x16x32_bf16 v[56:59], a[144:147], a[12:15], v[56:59]
    ds_write_b128 v254, v[36:39] offset:32
    v_mfma_f32_16x16x32_bf16 v[60:63], a[148:151], a[12:15], v[60:63]
    ds_write_b128 v254, v[40:43] offset:64
    v_mfma_f32_16x16x32_bf16 v[64:67], a[152:155], a[12:15], v[64:67]
    ds_write_b128 v254, v[44:47] offset:96
    v_mfma_f32_16x16x32_bf16 v[68:71], a[156:159], a[12:15], v[68:71]
    s_waitcnt vmcnt(4)
    ds_write_b128 v254, v[48:51] offset:128
    v_mfma_f32_16x16x32_bf16 v[72:75], a[140:143], a[16:19], v[72:75]
    ds_write_b128 v254, v[52:55] offset:2560
    v_mfma_f32_16x16x32_bf16 v[76:79], a[144:147], a[16:19], v[76:79]
    ds_write_b128 v254, v[56:59] offset:2592
    v_mfma_f32_16x16x32_bf16 v[80:83], a[148:151], a[16:19], v[80:83]
    ds_write_b128 v254, v[60:63] offset:2624
    v_mfma_f32_16x16x32_bf16 v[84:87], a[152:155], a[16:19], v[84:87]
    ds_write_b128 v254, v[64:67] offset:2656
    v_mfma_f32_16x16x32_bf16 v[88:91], a[156:159], a[16:19], v[88:91]
    s_waitcnt vmcnt(2)
    ds_write_b128 v254, v[68:71] offset:2688
    v_mfma_f32_16x16x32_bf16 v[92:95], a[140:143], v[152:155], v[92:95]
    ds_write_b128 v254, v[72:75] offset:5120
    v_mfma_f32_16x16x32_bf16 v[96:99], a[144:147], v[152:155], v[96:99]
    ds_write_b128 v254, v[76:79] offset:5152
    v_mfma_f32_16x16x32_bf16 v[100:103], a[148:151], v[152:155], v[100:103]
    ds_write_b128 v254, v[80:83] offset:5184
    v_mfma_f32_16x16x32_bf16 v[104:107], a[152:155], v[152:155], v[104:107]
    ds_write_b128 v254, v[84:87] offset:5216
    v_mfma_f32_16x16x32_bf16 v[108:111], a[156:159], v[152:155], v[108:111]
    s_waitcnt vmcnt(0)
    ds_write_b128 v254, v[88:91] offset:5248
    v_mfma_f32_16x16x32_bf16 v[112:115], a[140:143], v[156:159], v[112:115]
    ds_write_b128 v254, v[92:95] offset:7680
    v_mfma_f32_16x16x32_bf16 v[116:119], a[144:147], v[156:159], v[116:119]
    ds_write_b128 v254, v[96:99] offset:7712
    v_mfma_f32_16x16x32_bf16 v[120:123], a[148:151], v[156:159], v[120:123]
    ds_write_b128 v254, v[100:103] offset:7744
    v_mfma_f32_16x16x32_bf16 v[124:127], a[152:155], v[156:159], v[124:127]
    ds_write_b128 v254, v[104:107] offset:7776
    v_mfma_f32_16x16x32_bf16 v[128:131], a[156:159], v[156:159], v[128:131]
    ds_write_b128 v254, v[108:111] offset:7808
    ds_write_b128 v254, v[112:115] offset:10240
    ds_write_b128 v254, v[116:119] offset:10272
    s_nop 0
    ds_write_b128 v254, v[120:123] offset:10304
    s_nop 0
    ds_write_b128 v254, v[124:127] offset:10336
    s_nop 0
    ds_write_b128 v254, v[128:131] offset:10368
    s_waitcnt lgkmcnt(0)
    s_barrier
    v_add_u32 v31, 81920, v247
    ds_read2st64_b32 v[128:129], v247 offset0:0 offset1:160
    ds_read2st64_b32 v[130:131], v31 offset0:0 offset1:160
    v_add_u32 v30, 81920, v244
    ds_read_b128 v[32:35], v244 offset:0
    ds_read_b128 v[36:39], v244 offset:12800
    ds_read_b128 v[40:43], v244 offset:40960
    ds_read_b128 v[44:47], v244 offset:53760
    ds_read_b128 v[48:51], v30 offset:0
    ds_read_b128 v[52:55], v30 offset:12800
    ds_read_b128 v[56:59], v30 offset:40960
    ds_read_b128 v[60:63], v30 offset:53760
    s_waitcnt lgkmcnt(8)
    v_pk_add_f32 v[128:129], v[128:129], v[130:131]
    v_add_f32 v128, v128, v129
    v_cvt_pk_bf16_f32 v128, v128, v128
    buffer_store_short v128, v243, s[24:27], s43 offen nt
    v_add_u32 v30, 81920, v245
    ds_read_b128 v[64:67], v245 offset:0
    ds_read_b128 v[68:71], v245 offset:12800
    ds_read_b128 v[72:75], v245 offset:40960
    ds_read_b128 v[76:79], v245 offset:53760
    ds_read_b128 v[80:83], v30 offset:0
    ds_read_b128 v[84:87], v30 offset:12800
    ds_read_b128 v[88:91], v30 offset:40960
    ds_read_b128 v[92:95], v30 offset:53760
    s_waitcnt lgkmcnt(12)
    v_pk_add_f32 v[32:33], v[32:33], v[40:41]
    v_pk_add_f32 v[34:35], v[34:35], v[42:43]
    v_pk_add_f32 v[36:37], v[36:37], v[44:45]
    v_pk_add_f32 v[38:39], v[38:39], v[46:47]
    s_waitcnt lgkmcnt(8)
    v_pk_add_f32 v[48:49], v[48:49], v[56:57]
    v_pk_add_f32 v[50:51], v[50:51], v[58:59]
    v_pk_add_f32 v[52:53], v[52:53], v[60:61]
    v_pk_add_f32 v[54:55], v[54:55], v[62:63]
    v_pk_add_f32 v[32:33], v[32:33], v[48:49]
    v_pk_add_f32 v[34:35], v[34:35], v[50:51]
    v_pk_add_f32 v[36:37], v[36:37], v[52:53]
    v_pk_add_f32 v[38:39], v[38:39], v[54:55]
    v_cvt_pk_bf16_f32 v40, v32, v33
    v_cvt_pk_bf16_f32 v41, v34, v35
    v_cvt_pk_bf16_f32 v42, v36, v37
    v_cvt_pk_bf16_f32 v43, v38, v39
    buffer_store_dwordx4 v[40:43], v240, s[24:27], s43 offen nt
    v_add_u32 v30, 81920, v246
    ds_read_b128 v[96:99], v246 offset:0
    ds_read_b128 v[100:103], v246 offset:12800
    ds_read_b128 v[104:107], v246 offset:40960
    ds_read_b128 v[108:111], v246 offset:53760
    ds_read_b128 v[112:115], v30 offset:0
    ds_read_b128 v[116:119], v30 offset:12800
    ds_read_b128 v[120:123], v30 offset:40960
    ds_read_b128 v[124:127], v30 offset:53760
    s_waitcnt lgkmcnt(12)
    v_pk_add_f32 v[64:65], v[64:65], v[72:73]
    v_pk_add_f32 v[66:67], v[66:67], v[74:75]
    v_pk_add_f32 v[68:69], v[68:69], v[76:77]
    v_pk_add_f32 v[70:71], v[70:71], v[78:79]
    s_waitcnt lgkmcnt(8)
    v_pk_add_f32 v[80:81], v[80:81], v[88:89]
    v_pk_add_f32 v[82:83], v[82:83], v[90:91]
    v_pk_add_f32 v[84:85], v[84:85], v[92:93]
    v_pk_add_f32 v[86:87], v[86:87], v[94:95]
    v_pk_add_f32 v[64:65], v[64:65], v[80:81]
    v_pk_add_f32 v[66:67], v[66:67], v[82:83]
    v_pk_add_f32 v[68:69], v[68:69], v[84:85]
    v_pk_add_f32 v[70:71], v[70:71], v[86:87]
    v_cvt_pk_bf16_f32 v72, v64, v65
    v_cvt_pk_bf16_f32 v73, v66, v67
    v_cvt_pk_bf16_f32 v74, v68, v69
    v_cvt_pk_bf16_f32 v75, v70, v71
    buffer_store_dwordx4 v[72:75], v241, s[24:27], s43 offen nt
    s_waitcnt lgkmcnt(4)
    v_pk_add_f32 v[96:97], v[96:97], v[104:105]
    v_pk_add_f32 v[98:99], v[98:99], v[106:107]
    v_pk_add_f32 v[100:101], v[100:101], v[108:109]
    v_pk_add_f32 v[102:103], v[102:103], v[110:111]
    s_waitcnt lgkmcnt(0)
    v_pk_add_f32 v[112:113], v[112:113], v[120:121]
    v_pk_add_f32 v[114:115], v[114:115], v[122:123]
    v_pk_add_f32 v[116:117], v[116:117], v[124:125]
    v_pk_add_f32 v[118:119], v[118:119], v[126:127]
    v_pk_add_f32 v[96:97], v[96:97], v[112:113]
    v_pk_add_f32 v[98:99], v[98:99], v[114:115]
    v_pk_add_f32 v[100:101], v[100:101], v[116:117]
    v_pk_add_f32 v[102:103], v[102:103], v[118:119]
    v_cvt_pk_bf16_f32 v104, v96, v97
    v_cvt_pk_bf16_f32 v105, v98, v99
    v_cvt_pk_bf16_f32 v106, v100, v101
    v_cvt_pk_bf16_f32 v107, v102, v103
    buffer_store_dwordx4 v[104:107], v242, s[24:27], s43 offen nt
    s_endpgm
L_end:
    s_endpgm
.section .rodata,"a"
.p2align 6
.amdhsa_kernel gated_mix__linear_attn_block__dense_activation_mish__prompt_kernel
  .amdhsa_next_free_vgpr 512
  .amdhsa_next_free_sgpr 102
  .amdhsa_accum_offset 256
  .amdhsa_group_segment_fixed_size 0
  .amdhsa_kernarg_size 88
  .amdhsa_user_sgpr_count 2
  .amdhsa_user_sgpr_kernarg_segment_ptr 1
  .amdhsa_system_sgpr_workgroup_id_x 1
  .amdhsa_float_denorm_mode_32 3
.end_amdhsa_kernel
```
